```python
import torch

def _softmax(x, axis=-1):
    return torch.softmax(x, dim=axis)
def _gelu(x):
    return torch.nn.functional.gelu(x, approximate="tanh")
def _silu(x):
    return torch.nn.functional.silu(x)
def _sigmoid(x):
    return torch.sigmoid(x)
def _layernorm(x, axis=-1, eps=1e-5):
    m = x.mean(dim=axis, keepdim=True)
    v = x.var(dim=axis, keepdim=True, unbiased=False)
    return (x - m) / torch.sqrt(v + eps)
def _scatter_add(tgt, idx, src, axis=0):
    return tgt.clone().index_add_(axis, idx, src)
def _segment_sum(src, seg, n):
    out = torch.zeros((n,) + src.shape[1:], dtype=src.dtype)
    return out.index_add_(0, seg, src)
def _pad(x, pw):
    flat = tuple(v for pair in reversed(pw) for v in pair)
    return torch.nn.functional.pad(x, flat)

kernel_name = 'interleave_layers__sliding_local_dilated__mixer_channel_mlp__prompt'

def setup_inputs():

    _w = (lambda a: (lambda t: t.to(torch.bfloat16) if t.is_floating_point() else t)(torch.as_tensor(a)))
    def _A_setup():
        B, S, D = 1, 2048, 576
        return {
            "x": _w((lambda *s: torch.randn(*s, dtype=torch.bfloat16) * 0.05)(B, S, D)),
            "wqkv": _w((lambda *s: torch.randn(*s, dtype=torch.bfloat16) * 0.05)(D, 3 * D)),
            "wo": _w((lambda *s: torch.randn(*s, dtype=torch.bfloat16) * 0.05)(D, D)),
        }
    _A_in = _A_setup()

    def _B_setup():
        B, S, D, F = 1, 2048, 576, 4608
        return {
            "x": _w((lambda *s: torch.randn(*s, dtype=torch.bfloat16) * 0.05)(B, S, D)),
            "w1": _w((lambda *s: torch.randn(*s, dtype=torch.bfloat16) * 3.2)(D, F) * (D ** -0.5)),
            "b1": _w((lambda *s: torch.randn(*s, dtype=torch.bfloat16) * 0.8)(F)),
            "w2": _w((lambda *s: torch.randn(*s, dtype=torch.bfloat16) * 0.2)(F, D) * (F ** -0.5)),
            "b2": _w((lambda *s: torch.randn(*s, dtype=torch.bfloat16) * 0.2)(D)),
        }
    _B_in = _B_setup()

    return {
        "A_x": _A_in["x"],
        "A_wqkv": _A_in["wqkv"],
        "A_wo": _A_in["wo"],
        "B_x": _B_in["x"],
        "B_w1": _B_in["w1"],
        "B_b1": _B_in["b1"],
        "B_w2": _B_in["w2"],
        "B_b2": _B_in["b2"],
    }

def reference(A_x, A_wqkv, A_wo, B_x, B_w1, B_b1, B_w2, B_b2):
    def _A_ref(x, wqkv, wo):
        B, S, D = x.shape
        H = 32; Dh = D // H
        W, dil = 8, 2
        qkv = (lambda x, *d: x.permute(*d))((x @ wqkv).reshape(B, S, 3, H, Dh), 2, 0, 3, 1, 4)
        q, k, v = qkv[0], qkv[1], qkv[2]
        scale = Dh ** -0.5
        pos = torch.arange(S)
        off = torch.arange(W) * dil
        idx = pos[:, None] - off[None, :]
        mask = idx >= 0
        idx_c = torch.where(mask, idx, 0).reshape(-1)
        kg = k[:, :, idx_c, :].reshape(B, H, S, W, Dh)
        vg = v[:, :, idx_c, :].reshape(B, H, S, W, Dh)
        logits = torch.einsum("bhsd,bhswd->bhsw", q, kg) * scale
        logits = torch.where(mask[None, None, :, :], logits, -1e9)
        attn = _softmax(logits, axis=-1)
        o = torch.einsum("bhsw,bhswd->bhsd", attn, vg)
        return (lambda x, *d: x.permute(*d))(o, 0, 2, 1, 3).reshape(B, S, D) @ wo

    def _B_ref(x, w1, b1, w2, b2):
        y = _layernorm(x, axis=-1)
        h = _gelu(torch.einsum("bsd,df->bsf", y, w1) + b1)
        return torch.einsum("bsf,fd->bsd", h, w2) + b2

    x = A_x
    x = x + _A_ref(_layernorm(x, axis=-1), A_wqkv, A_wo)
    x = x + _B_ref(_layernorm(x, axis=-1), B_w1, B_b1, B_w2, B_b2)
    x = x + _A_ref(_layernorm(x, axis=-1), A_wqkv, A_wo)
    x = x + _B_ref(_layernorm(x, axis=-1), B_w1, B_b1, B_w2, B_b2)
    return x
```

```asm
; @launch kernel=p_kernel grid=(505,1,1) block=(576,1,1) lds=39168
; @launch kernel=main_kernel grid=(256,1,1) block=(256,1,1) lds=163840
.amdgcn_target "amdgcn-amd-amdhsa--gfx950"
.text
.p2align 8
.globl p_kernel
.type p_kernel,@function
p_kernel:
    s_cmp_ge_u32 s2, 505
    s_cbranch_scc1 L_exit
    s_sub_u32 s2, s2, 1
    s_cselect_b32 s2, 504, s2
    s_load_dwordx16 s[4:19], s[0:1], 0
    s_load_dwordx2 s[24:25], s[0:1], 80
    v_lshrrev_b32 v1, 6, v0
    s_nop 0
    v_readfirstlane_b32 s3, v1
    v_and_b32 v1, 63, v0
    v_lshlrev_b32 v2, 4, v1
    v_lshrrev_b32 v3, 4, v1
    v_and_b32 v4, 15, v1
    v_lshlrev_b32 v5, 4, v0
    s_waitcnt lgkmcnt(0)
    s_mov_b32 s40, s24
    s_mov_b32 s41, s25
    s_mov_b32 s42, 0x4365000
    s_mov_b32 s43, 0x20000
    s_cmp_ge_u32 s2, 32
    s_cbranch_scc1 P_nt
    s_lshr_b32 s20, s2, 3
    s_mul_i32 s20, s20, 576
    v_add_u32 v62, s20, v0
    v_min_u32 v62, 32767, v62
    v_lshlrev_b32 v62, 16, v62
    buffer_load_dword v63, v62, s[40:43], 0 offen
P_nt:
    s_cmp_lt_u32 s2, 256
    s_cbranch_scc1 P_ln
    s_cmp_ge_u32 s2, 504
    s_cbranch_scc1 P_misc
    s_cmp_ge_u32 s2, 328
    s_cbranch_scc1 P_w12
    s_sub_u32 s29, s2, 256
    s_mov_b32 s36, s6
    s_mov_b32 s37, s7
    s_mov_b32 s38, 0x1e6000
    s_mov_b32 s39, 0x20000
    s_mul_i32 s20, s29, 27648
    s_lshl_b32 s21, s3, 10
    s_add_u32 m0, s21, 0
    s_add_u32 s22, s20, 0
    buffer_load_dwordx4 v5, s[36:39], s22 offen nt lds
    s_add_u32 m0, s21, 9216
    s_add_u32 s22, s20, 9216
    buffer_load_dwordx4 v5, s[36:39], s22 offen nt lds
    s_add_u32 m0, s21, 18432
    s_add_u32 s22, s20, 18432
    buffer_load_dwordx4 v5, s[36:39], s22 offen nt lds
    s_mov_b32 s32, s8
    s_mov_b32 s33, s9
    s_mov_b32 s34, 0xa2000
    s_mov_b32 s35, 0x20000
    s_mov_b32 s20, s29
    s_lshr_b32 s21, s20, 2
    s_and_b32 s22, s20, 3
    v_mul_u32_u24 v6, 911, v0
    v_lshrrev_b32 v6, 16, v6
    v_mul_u32_u24 v7, 72, v6
    v_sub_u32 v7, v0, v7
    s_cmp_ge_u32 s21, 16
    s_cbranch_scc1 P_wo_tail
    s_mul_i32 s23, s21, 36
    s_lshl_b32 s26, s22, 2
    s_add_u32 s23, s23, s26
    v_lshrrev_b32 v8, 2, v6
    v_and_b32 v9, 3, v6
    s_branch P_wo_go
P_wo_tail:
    s_sub_u32 s23, s20, 64
    s_mul_i32 s23, s23, 72
    s_add_u32 s23, s23, 16
    v_lshrrev_b32 v8, 1, v6
    v_and_b32 v9, 1, v6
P_wo_go:
    v_mul_u32_u24 v8, 18, v8
    v_add_u32 v8, v8, v9
    v_mul_u32_u24 v8, 1152, v8
    v_lshl_add_u32 v8, v7, 4, v8
    s_mul_i32 s23, s23, 1152
    s_lshl_b32 s26, s3, 10
    s_add_u32 m0, s26, 27648
    s_nop 0
    buffer_load_dwordx4 v8, s[32:35], s23 offen nt lds
    s_mul_i32 s27, s21, 4608
    s_add_u32 s27, s27, 0x240000
    v_lshrrev_b32 v8, 4, v7
    v_lshlrev_b32 v8, 10, v8
    v_and_b32 v9, 15, v7
    v_lshl_add_u32 v8, v9, 4, v8
    s_lshl_b32 s26, s22, 7
    v_mov_b32 v10, s26
    v_lshlrev_b32 v11, 1, v10
    v_cmp_gt_u32 vcc, 64, v7
    s_nop 1
    v_cndmask_b32 v10, v10, v11, vcc
    v_add_u32 v8, v8, v10
    s_mov_b32 s26, 82944
    v_mad_u32_u24 v3, v6, s26, v8
    v_lshlrev_b32 v4, 1, v0
    s_lshr_b32 s22, s29, 2
    s_mul_i32 s54, s22, 43
    s_lshr_b32 s54, s54, 7
    s_mul_i32 s55, s54, 3
    s_sub_u32 s55, s22, s55
    s_mul_i32 s22, s54, 10752
    s_and_b32 s23, s29, 3
    s_mul_i32 s54, s55, 3072
    s_lshl_b32 s28, s23, 8
    s_add_u32 s54, s54, s28
    s_lshl_b32 s55, s55, 9
    s_lshl_b32 s28, s23, 7
    s_add_u32 s55, s55, s28
    s_add_u32 s55, s55, 6144
    v_mov_b32 v15, 0x80000000
    v_add_u32 v6, 0, v0
    v_lshrrev_b32 v7, 6, v6
    v_bfe_u32 v8, v6, 4, 2
    v_and_b32 v9, 15, v6
    v_mul_u32_u24 v10, 36, v7
    v_mul_u32_u24 v11, 1152, v8
    v_lshl_add_u32 v11, v9, 1, v11
    v_lshrrev_b32 v12, 1, v9
    v_mul_u32_u24 v12, 1152, v12
    v_and_b32 v13, 1, v9
    v_lshl_add_u32 v12, v13, 1, v12
    v_add_u32 v12, 32, v12
    v_cmp_eq_u32 vcc, 3, v8
    s_nop 1
    v_cndmask_b32 v11, v11, v12, vcc
    v_cmp_lt_u32 s[44:45], 5, v9
    s_nop 1
    s_and_b64 s[46:47], vcc, s[44:45]
    v_cndmask_b32 v11, v11, 0, s[46:47]
    v_add_u32 v48, v10, v11
    v_mul_u32_u24 v7, 64512, v7
    v_lshl_add_u32 v7, v8, 10, v7
    v_lshl_add_u32 v7, v9, 4, v7
    v_mov_b32 v12, s54
    v_mov_b32 v13, s55
    v_cndmask_b32 v12, v12, v13, vcc
    v_add_u32 v52, v7, v12
    v_cmp_lt_u32 s[44:45], 7, v9
    s_nop 1
    s_and_b64 s[44:45], vcc, s[44:45]
    v_cndmask_b32 v52, v52, v15, s[44:45]
    v_add_u32 v6, 576, v0
    v_lshrrev_b32 v7, 6, v6
    v_bfe_u32 v8, v6, 4, 2
    v_and_b32 v9, 15, v6
    v_mul_u32_u24 v10, 36, v7
    v_mul_u32_u24 v11, 1152, v8
    v_lshl_add_u32 v11, v9, 1, v11
    v_lshrrev_b32 v12, 1, v9
    v_mul_u32_u24 v12, 1152, v12
    v_and_b32 v13, 1, v9
    v_lshl_add_u32 v12, v13, 1, v12
    v_add_u32 v12, 32, v12
    v_cmp_eq_u32 vcc, 3, v8
    s_nop 1
    v_cndmask_b32 v11, v11, v12, vcc
    v_cmp_lt_u32 s[44:45], 5, v9
    s_nop 1
    s_and_b64 s[48:49], vcc, s[44:45]
    v_cndmask_b32 v11, v11, 0, s[48:49]
    v_add_u32 v49, v10, v11
    v_mul_u32_u24 v7, 64512, v7
    v_lshl_add_u32 v7, v8, 10, v7
    v_lshl_add_u32 v7, v9, 4, v7
    v_mov_b32 v12, s54
    v_mov_b32 v13, s55
    v_cndmask_b32 v12, v12, v13, vcc
    v_add_u32 v53, v7, v12
    v_cmp_lt_u32 s[44:45], 7, v9
    s_nop 1
    s_and_b64 s[44:45], vcc, s[44:45]
    v_cndmask_b32 v53, v53, v15, s[44:45]
    v_add_u32 v6, 1152, v0
    v_lshrrev_b32 v7, 6, v6
    v_bfe_u32 v8, v6, 4, 2
    v_and_b32 v9, 15, v6
    v_mul_u32_u24 v10, 36, v7
    v_mul_u32_u24 v11, 1152, v8
    v_lshl_add_u32 v11, v9, 1, v11
    v_lshrrev_b32 v12, 1, v9
    v_mul_u32_u24 v12, 1152, v12
    v_and_b32 v13, 1, v9
    v_lshl_add_u32 v12, v13, 1, v12
    v_add_u32 v12, 32, v12
    v_cmp_eq_u32 vcc, 3, v8
    s_nop 1
    v_cndmask_b32 v11, v11, v12, vcc
    v_cmp_lt_u32 s[44:45], 5, v9
    s_nop 1
    s_and_b64 s[50:51], vcc, s[44:45]
    v_cndmask_b32 v11, v11, 0, s[50:51]
    v_add_u32 v50, v10, v11
    v_mul_u32_u24 v7, 64512, v7
    v_lshl_add_u32 v7, v8, 10, v7
    v_lshl_add_u32 v7, v9, 4, v7
    v_mov_b32 v12, s54
    v_mov_b32 v13, s55
    v_cndmask_b32 v12, v12, v13, vcc
    v_add_u32 v54, v7, v12
    v_cmp_lt_u32 s[44:45], 7, v9
    s_nop 1
    s_and_b64 s[44:45], vcc, s[44:45]
    v_cndmask_b32 v54, v54, v15, s[44:45]
    v_add_u32 v6, 1728, v0
    v_lshrrev_b32 v7, 6, v6
    v_bfe_u32 v8, v6, 4, 2
    v_and_b32 v9, 15, v6
    v_mul_u32_u24 v10, 36, v7
    v_mul_u32_u24 v11, 1152, v8
    v_lshl_add_u32 v11, v9, 1, v11
    v_lshrrev_b32 v12, 1, v9
    v_mul_u32_u24 v12, 1152, v12
    v_and_b32 v13, 1, v9
    v_lshl_add_u32 v12, v13, 1, v12
    v_add_u32 v12, 32, v12
    v_cmp_eq_u32 vcc, 3, v8
    s_nop 1
    v_cndmask_b32 v11, v11, v12, vcc
    v_cmp_lt_u32 s[44:45], 5, v9
    s_nop 1
    s_and_b64 s[52:53], vcc, s[44:45]
    v_cndmask_b32 v11, v11, 0, s[52:53]
    v_add_u32 v51, v10, v11
    v_mul_u32_u24 v7, 64512, v7
    v_lshl_add_u32 v7, v8, 10, v7
    v_lshl_add_u32 v7, v9, 4, v7
    v_mov_b32 v12, s54
    v_mov_b32 v13, s55
    v_cndmask_b32 v12, v12, v13, vcc
    v_add_u32 v55, v7, v12
    v_cmp_lt_u32 s[44:45], 7, v9
    s_nop 1
    s_and_b64 s[44:45], vcc, s[44:45]
    v_cndmask_b32 v55, v55, v15, s[44:45]
    v_cmp_gt_u32 vcc, 2048, v6
    s_nop 1
    v_cndmask_b32 v55, v15, v55, vcc
    v_cndmask_b32 v51, 0, v51, vcc
    s_waitcnt vmcnt(0)
    s_barrier
    ds_read_u16 v16, v48 offset:0
    ds_read_u16 v17, v48 offset:3456
    ds_read_u16 v18, v48 offset:6912
    ds_read_u16 v19, v48 offset:10368
    ds_read_u16 v20, v48 offset:13824
    ds_read_u16 v21, v48 offset:17280
    ds_read_u16 v22, v48 offset:20736
    ds_read_u16 v23, v48 offset:24192
    ds_read_u16 v24, v49 offset:0
    ds_read_u16 v25, v49 offset:3456
    ds_read_u16 v26, v49 offset:6912
    ds_read_u16 v27, v49 offset:10368
    ds_read_u16 v28, v49 offset:13824
    ds_read_u16 v29, v49 offset:17280
    ds_read_u16 v30, v49 offset:20736
    ds_read_u16 v31, v49 offset:24192
    s_waitcnt lgkmcnt(0)
    v_lshl_or_b32 v16, v17, 16, v16
    v_cndmask_b32 v16, v16, 0, s[46:47]
    v_lshl_or_b32 v17, v19, 16, v18
    v_cndmask_b32 v17, v17, 0, s[46:47]
    v_lshl_or_b32 v18, v21, 16, v20
    v_cndmask_b32 v18, v18, 0, s[46:47]
    v_lshl_or_b32 v19, v23, 16, v22
    v_cndmask_b32 v19, v19, 0, s[46:47]
    buffer_store_dwordx4 v[16:19], v52, s[40:43], s22 offen sc1
    v_lshl_or_b32 v24, v25, 16, v24
    v_cndmask_b32 v24, v24, 0, s[48:49]
    v_lshl_or_b32 v25, v27, 16, v26
    v_cndmask_b32 v25, v25, 0, s[48:49]
    v_lshl_or_b32 v26, v29, 16, v28
    v_cndmask_b32 v26, v26, 0, s[48:49]
    v_lshl_or_b32 v27, v31, 16, v30
    v_cndmask_b32 v27, v27, 0, s[48:49]
    buffer_store_dwordx4 v[24:27], v53, s[40:43], s22 offen sc1
    ds_read_u16 v32, v50 offset:0
    ds_read_u16 v33, v50 offset:3456
    ds_read_u16 v34, v50 offset:6912
    ds_read_u16 v35, v50 offset:10368
    ds_read_u16 v36, v50 offset:13824
    ds_read_u16 v37, v50 offset:17280
    ds_read_u16 v38, v50 offset:20736
    ds_read_u16 v39, v50 offset:24192
    ds_read_u16 v40, v51 offset:0
    ds_read_u16 v41, v51 offset:3456
    ds_read_u16 v42, v51 offset:6912
    ds_read_u16 v43, v51 offset:10368
    ds_read_u16 v44, v51 offset:13824
    ds_read_u16 v45, v51 offset:17280
    ds_read_u16 v46, v51 offset:20736
    ds_read_u16 v47, v51 offset:24192
    s_waitcnt lgkmcnt(0)
    v_lshl_or_b32 v32, v33, 16, v32
    v_cndmask_b32 v32, v32, 0, s[50:51]
    v_lshl_or_b32 v33, v35, 16, v34
    v_cndmask_b32 v33, v33, 0, s[50:51]
    v_lshl_or_b32 v34, v37, 16, v36
    v_cndmask_b32 v34, v34, 0, s[50:51]
    v_lshl_or_b32 v35, v39, 16, v38
    v_cndmask_b32 v35, v35, 0, s[50:51]
    buffer_store_dwordx4 v[32:35], v54, s[40:43], s22 offen sc1
    v_lshl_or_b32 v40, v41, 16, v40
    v_cndmask_b32 v40, v40, 0, s[52:53]
    v_lshl_or_b32 v41, v43, 16, v42
    v_cndmask_b32 v41, v41, 0, s[52:53]
    v_lshl_or_b32 v42, v45, 16, v44
    v_cndmask_b32 v42, v42, 0, s[52:53]
    v_lshl_or_b32 v43, v47, 16, v46
    v_cndmask_b32 v43, v43, 0, s[52:53]
    buffer_store_dwordx4 v[40:43], v55, s[40:43], s22 offen sc1
    ds_read_u16 v56, v4 offset:27648
    ds_read_u16 v57, v4 offset:28800
    ds_read_u16 v58, v4 offset:29952
    ds_read_u16 v59, v4 offset:31104
    ds_read_u16 v60, v4 offset:32256
    ds_read_u16 v61, v4 offset:33408
    ds_read_u16 v62, v4 offset:34560
    ds_read_u16 v63, v4 offset:35712
    s_waitcnt lgkmcnt(0)
    v_lshl_or_b32 v56, v57, 16, v56
    v_lshl_or_b32 v57, v59, 16, v58
    v_lshl_or_b32 v58, v61, 16, v60
    v_lshl_or_b32 v59, v63, 16, v62
    buffer_store_dwordx4 v[56:59], v3, s[40:43], s27 offen sc1
    s_endpgm
P_ln:
    s_mov_b32 s36, s4
    s_mov_b32 s37, s5
    s_mov_b32 s38, 0x240000
    s_mov_b32 s39, 0x20000
    s_sub_u32 s20, s2, 0
    v_lshrrev_b32 v1, 3, v0
    v_and_b32 v7, 7, v0
    v_lshlrev_b32 v8, 4, v1
    v_mul_u32_u24 v9, 1152, v7
    v_add_u32 v9, v9, v8
    s_mul_i32 s21, s20, 9216
    buffer_load_dwordx4 v[16:19], v9, s[36:39], s21 offen
    v_lshlrev_b32 v3, 8, v1
    v_lshl_add_u32 v3, v7, 4, v3
    s_lshr_b32 s22, s20, 1
    s_mul_i32 s22, s22, 18432
    s_and_b32 s23, s20, 1
    s_lshl_b32 s23, s23, 7
    s_add_u32 s22, s22, s23
    s_add_u32 s22, s22, 0xd25000
    v_mul_u32_u24 v11, 48, v7
    v_lshrrev_b32 v12, 6, v0
    v_lshl_add_u32 v12, v12, 2, v11
    s_waitcnt vmcnt(0)
    v_lshlrev_b32 v24, 16, v16
    v_and_b32 v25, 0xffff0000, v16
    v_lshlrev_b32 v26, 16, v17
    v_and_b32 v27, 0xffff0000, v17
    v_lshlrev_b32 v28, 16, v18
    v_and_b32 v29, 0xffff0000, v18
    v_lshlrev_b32 v30, 16, v19
    v_and_b32 v31, 0xffff0000, v19
    v_pk_add_f32 v[32:33], v[24:25], v[26:27]
    v_pk_add_f32 v[34:35], v[28:29], v[30:31]
    v_pk_add_f32 v[32:33], v[32:33], v[34:35]
    v_add_f32 v40, v32, v33
    s_nop 1
    v_add_f32_dpp v40, v40, v40 row_ror:8 row_mask:0xf bank_mask:0xf
    v_mov_b32 v41, v40
    s_nop 1
    v_permlane16_swap_b32 v40, v41
    v_add_f32 v40, v40, v41
    v_mov_b32 v41, v40
    s_nop 1
    v_permlane32_swap_b32 v40, v41
    v_add_f32 v40, v40, v41
    ds_write_b32 v12, v40 offset:0
    s_waitcnt lgkmcnt(0)
    s_barrier
    ds_read_b128 v[48:51], v11 offset:0
    ds_read_b128 v[52:55], v11 offset:16
    ds_read_b32 v56, v11 offset:32
    s_waitcnt lgkmcnt(0)
    v_pk_add_f32 v[48:49], v[48:49], v[50:51]
    v_pk_add_f32 v[52:53], v[52:53], v[54:55]
    v_pk_add_f32 v[48:49], v[48:49], v[52:53]
    v_add_f32 v48, v48, v49
    v_add_f32 v48, v48, v56
    v_mul_f32 v42, 0x3ae38e39, v48
    v_sub_f32 v32, v24, v42
    v_sub_f32 v33, v25, v42
    v_sub_f32 v34, v26, v42
    v_sub_f32 v35, v27, v42
    v_sub_f32 v36, v28, v42
    v_sub_f32 v37, v29, v42
    v_sub_f32 v38, v30, v42
    v_sub_f32 v39, v31, v42
    v_mul_f32 v40, v32, v32
    v_fmac_f32 v40, v33, v33
    v_fmac_f32 v40, v34, v34
    v_fmac_f32 v40, v35, v35
    v_fmac_f32 v40, v36, v36
    v_fmac_f32 v40, v37, v37
    v_fmac_f32 v40, v38, v38
    v_fmac_f32 v40, v39, v39
    s_nop 1
    v_add_f32_dpp v40, v40, v40 row_ror:8 row_mask:0xf bank_mask:0xf
    v_mov_b32 v41, v40
    s_nop 1
    v_permlane16_swap_b32 v40, v41
    v_add_f32 v40, v40, v41
    v_mov_b32 v41, v40
    s_nop 1
    v_permlane32_swap_b32 v40, v41
    v_add_f32 v40, v40, v41
    ds_write_b32 v12, v40 offset:512
    s_waitcnt lgkmcnt(0)
    s_barrier
    ds_read_b128 v[48:51], v11 offset:512
    ds_read_b128 v[52:55], v11 offset:528
    ds_read_b32 v56, v11 offset:544
    s_waitcnt lgkmcnt(0)
    v_pk_add_f32 v[48:49], v[48:49], v[50:51]
    v_pk_add_f32 v[52:53], v[52:53], v[54:55]
    v_pk_add_f32 v[48:49], v[48:49], v[52:53]
    v_add_f32 v48, v48, v49
    v_add_f32 v48, v48, v56
    v_mul_f32 v43, 0x3ae38e39, v48
    v_cvt_pk_bf16_f32 v44, v43, v42
    v_lshlrev_b32 v45, 16, v44
    v_and_b32 v44, 0xffff0000, v44
    v_add_f32 v45, 0x3727c5ac, v45
    v_cvt_pk_bf16_f32 v45, v45, v45
    v_and_b32 v45, 0xffff0000, v45
    v_sqrt_f32 v45, v45
    s_nop 0
    v_cvt_pk_bf16_f32 v45, v45, v45
    v_and_b32 v45, 0xffff0000, v45
    v_rcp_f32 v45, v45
    v_sub_f32 v24, v24, v44
    v_sub_f32 v25, v25, v44
    v_sub_f32 v26, v26, v44
    v_sub_f32 v27, v27, v44
    v_sub_f32 v28, v28, v44
    v_sub_f32 v29, v29, v44
    v_sub_f32 v30, v30, v44
    v_sub_f32 v31, v31, v44
    v_cvt_pk_bf16_f32 v32, v24, v25
    v_cvt_pk_bf16_f32 v33, v26, v27
    v_cvt_pk_bf16_f32 v34, v28, v29
    v_cvt_pk_bf16_f32 v35, v30, v31
    v_lshlrev_b32 v24, 16, v32
    v_and_b32 v25, 0xffff0000, v32
    v_lshlrev_b32 v26, 16, v33
    v_and_b32 v27, 0xffff0000, v33
    v_lshlrev_b32 v28, 16, v34
    v_and_b32 v29, 0xffff0000, v34
    v_lshlrev_b32 v30, 16, v35
    v_and_b32 v31, 0xffff0000, v35
    v_mul_f32 v24, v24, v45
    v_mul_f32 v25, v25, v45
    v_mul_f32 v26, v26, v45
    v_mul_f32 v27, v27, v45
    v_mul_f32 v28, v28, v45
    v_mul_f32 v29, v29, v45
    v_mul_f32 v30, v30, v45
    v_mul_f32 v31, v31, v45
    v_cvt_pk_bf16_f32 v32, v24, v25
    v_cvt_pk_bf16_f32 v33, v26, v27
    v_cvt_pk_bf16_f32 v34, v28, v29
    v_cvt_pk_bf16_f32 v35, v30, v31
    buffer_store_dwordx4 v[32:35], v3, s[40:43], s22 offen sc1
    s_endpgm
P_w12:
    v_lshrrev_b32 v5, 3, v1
    v_and_b32 v6, 7, v1
    v_lshlrev_b32 v6, 4, v6
    v_bfe_u32 v7, v1, 2, 2
    v_and_b32 v8, 3, v1
    s_lshl_b32 s21, s3, 12
    s_cmp_ge_u32 s2, 472
    s_cbranch_scc1 P_w2
    s_mov_b32 s36, s12
    s_mov_b32 s37, s13
    s_mov_b32 s38, 0x510000
    s_mov_b32 s39, 0x20000
    s_sub_u32 s28, s2, 328
    s_lshr_b32 s20, s28, 1
    s_and_b32 s28, s28, 1
    s_mul_i32 s29, s28, 9
    s_add_u32 s29, s29, s3
    s_mul_i32 s22, s29, 294912
    s_lshl_b32 s27, s20, 7
    s_add_u32 s22, s22, s27
    v_mul_u32_u24 v9, 9216, v5
    v_add_u32 v9, v9, v6
    s_add_u32 m0, s21, 0
    s_nop 0
    buffer_load_dwordx4 v9, s[36:39], s22 offen nt lds
    s_add_u32 s22, s22, 73728
    s_add_u32 m0, s21, 1024
    s_nop 0
    buffer_load_dwordx4 v9, s[36:39], s22 offen nt lds
    s_add_u32 s22, s22, 73728
    s_add_u32 m0, s21, 2048
    s_nop 0
    buffer_load_dwordx4 v9, s[36:39], s22 offen nt lds
    s_add_u32 s22, s22, 73728
    s_add_u32 m0, s21, 3072
    s_nop 0
    buffer_load_dwordx4 v9, s[36:39], s22 offen nt lds
    s_mov_b32 s32, s14
    s_mov_b32 s33, s15
    s_mov_b32 s34, 0x2400
    s_mov_b32 s35, 0x20000
    v_lshlrev_b32 v5, 1, v1
    buffer_load_ushort v40, v5, s[32:35], s27 offen
    v_lshl_add_u32 v10, v3, 3, v7
    v_lshlrev_b32 v10, 7, v10
    v_lshl_add_u32 v10, v8, 3, v10
    v_add_u32 v10, s21, v10
    s_mul_i32 s23, s20, 73728
    s_lshl_b32 s26, s29, 10
    s_add_u32 s23, s23, s26
    s_add_u32 s23, s23, 0x2e8000
    v_mov_b32 v12, 0x3f803f80
    v_mov_b32 v13, 0x3f803f80
    v_mov_b32 v14, 0x3f803f80
    v_mov_b32 v15, 0x3f803f80
    s_lshl_b32 s26, s3, 8
    s_add_u32 s26, s26, 36864
    v_lshlrev_b32 v11, 4, v3
    v_add_u32 v11, s26, v11
    s_waitcnt vmcnt(0)
    ds_read_b64_tr_b16 v[16:17], v10 offset:0
    ds_read_b64_tr_b16 v[18:19], v10 offset:512
    ds_read_b64_tr_b16 v[20:21], v10 offset:32
    ds_read_b64_tr_b16 v[22:23], v10 offset:544
    ds_read_b64_tr_b16 v[24:25], v10 offset:64
    ds_read_b64_tr_b16 v[26:27], v10 offset:576
    ds_read_b64_tr_b16 v[28:29], v10 offset:96
    ds_read_b64_tr_b16 v[30:31], v10 offset:608
    s_waitcnt lgkmcnt(6)
    s_add_u32 s26, s23, 0
    buffer_store_dwordx4 v[16:19], v2, s[40:43], s26 offen sc1
    s_waitcnt lgkmcnt(4)
    s_add_u32 s26, s23, 18432
    buffer_store_dwordx4 v[20:23], v2, s[40:43], s26 offen sc1
    s_waitcnt lgkmcnt(2)
    s_add_u32 s26, s23, 36864
    buffer_store_dwordx4 v[24:27], v2, s[40:43], s26 offen sc1
    s_waitcnt lgkmcnt(0)
    s_add_u32 s26, s23, 55296
    buffer_store_dwordx4 v[28:31], v2, s[40:43], s26 offen sc1
    v_mfma_f32_16x16x32_bf16 v[48:51], v[16:19], v[12:15], 0
    v_mfma_f32_16x16x32_bf16 v[52:55], v[20:23], v[12:15], 0
    v_mfma_f32_16x16x32_bf16 v[56:59], v[24:27], v[12:15], 0
    v_mfma_f32_16x16x32_bf16 v[60:63], v[28:31], v[12:15], 0
    s_nop 4
    ds_write_b128 v11, v[48:51] offset:0
    ds_write_b128 v11, v[52:55] offset:64
    ds_write_b128 v11, v[56:59] offset:128
    ds_write_b128 v11, v[60:63] offset:192
    s_waitcnt lgkmcnt(0)
    s_barrier
    s_cmp_lg_u32 s3, 0
    s_cbranch_scc1 P_end
    v_lshlrev_b32 v11, 2, v1
    ds_read_b32 v48, v11 offset:36864
    ds_read_b32 v49, v11 offset:37120
    ds_read_b32 v50, v11 offset:37376
    ds_read_b32 v51, v11 offset:37632
    ds_read_b32 v52, v11 offset:37888
    ds_read_b32 v53, v11 offset:38144
    ds_read_b32 v54, v11 offset:38400
    ds_read_b32 v55, v11 offset:38656
    ds_read_b32 v56, v11 offset:38912
    s_waitcnt lgkmcnt(0)
    v_add_f32 v48, v48, v49
    v_add_f32 v48, v48, v50
    v_add_f32 v48, v48, v51
    v_add_f32 v48, v48, v52
    v_add_f32 v48, v48, v53
    v_add_f32 v48, v48, v54
    v_add_f32 v48, v48, v55
    v_add_f32 v48, v48, v56
    v_sub_f32 v48, 0, v48
    v_cvt_pk_bf16_f32 v60, v48, v48
    v_and_b32 v49, 0xffff0000, v60
    v_sub_f32 v49, v48, v49
    v_cvt_pk_bf16_f32 v49, v49, v49
    v_and_b32 v49, 0xffff, v49
    v_lshl_or_b32 v61, v40, 16, v49
    s_lshl_b32 s27, s20, 10
    s_lshl_b32 s28, s28, 3
    s_add_u32 s27, s27, s28
    s_add_u32 s27, s27, 0xd08000
    buffer_store_dwordx2 v[60:61], v2, s[40:43], s27 offen sc1
    s_endpgm
P_w2:
    s_mov_b32 s36, s16
    s_mov_b32 s37, s17
    s_mov_b32 s38, 0x510000
    s_mov_b32 s39, 0x20000
    s_sub_u32 s20, s2, 472
    s_lshr_b32 s22, s20, 2
    s_mul_i32 s22, s22, 14
    s_add_u32 s20, s20, s22
    s_add_u32 s20, s20, 14
    s_mul_i32 s22, s20, 36864
    s_lshl_b32 s23, s3, 7
    s_add_u32 s22, s22, s23
    v_mul_u32_u24 v9, 1152, v5
    v_add_u32 v9, v9, v6
    s_add_u32 m0, s21, 0
    s_nop 0
    buffer_load_dwordx4 v9, s[36:39], s22 offen nt lds
    s_add_u32 s22, s22, 9216
    s_add_u32 m0, s21, 1024
    s_nop 0
    buffer_load_dwordx4 v9, s[36:39], s22 offen nt lds
    s_add_u32 s22, s22, 9216
    s_add_u32 m0, s21, 2048
    s_nop 0
    buffer_load_dwordx4 v9, s[36:39], s22 offen nt lds
    s_add_u32 s22, s22, 9216
    s_add_u32 m0, s21, 3072
    s_nop 0
    buffer_load_dwordx4 v9, s[36:39], s22 offen nt lds
    v_lshl_add_u32 v10, v3, 2, v7
    v_lshlrev_b32 v10, 7, v10
    v_lshl_add_u32 v10, v8, 3, v10
    v_add_u32 v10, s21, v10
    s_mul_i32 s26, s20, 3641
    s_lshr_b32 s26, s26, 16
    s_mul_i32 s27, s26, 18
    s_sub_u32 s27, s20, s27
    s_mul_i32 s23, s26, 663552
    s_mul_i32 s26, s3, 73728
    s_add_u32 s23, s23, s26
    s_lshl_b32 s27, s27, 10
    s_add_u32 s23, s23, s27
    s_add_u32 s23, s23, 0x7f8000
    s_waitcnt vmcnt(0)
    ds_read_b64_tr_b16 v[16:17], v10 offset:0
    ds_read_b64_tr_b16 v[18:19], v10 offset:2048
    ds_read_b64_tr_b16 v[20:21], v10 offset:32
    ds_read_b64_tr_b16 v[22:23], v10 offset:2080
    ds_read_b64_tr_b16 v[24:25], v10 offset:64
    ds_read_b64_tr_b16 v[26:27], v10 offset:2112
    ds_read_b64_tr_b16 v[28:29], v10 offset:96
    ds_read_b64_tr_b16 v[30:31], v10 offset:2144
    s_waitcnt lgkmcnt(6)
    s_add_u32 s26, s23, 0
    buffer_store_dwordx4 v[16:19], v2, s[40:43], s26 offen sc1
    s_waitcnt lgkmcnt(4)
    s_add_u32 s26, s23, 18432
    buffer_store_dwordx4 v[20:23], v2, s[40:43], s26 offen sc1
    s_waitcnt lgkmcnt(2)
    s_add_u32 s26, s23, 36864
    buffer_store_dwordx4 v[24:27], v2, s[40:43], s26 offen sc1
    s_waitcnt lgkmcnt(0)
    s_add_u32 s26, s23, 55296
    buffer_store_dwordx4 v[28:31], v2, s[40:43], s26 offen sc1
    s_endpgm
P_misc:
    v_mov_b32 v16, 0
    v_mov_b32 v17, 0
    v_mov_b32 v18, 0
    v_mov_b32 v19, 0
    v_lshlrev_b32 v5, 4, v0
    s_add_u32 s36, s24, 0xd1c000
    s_addc_u32 s37, s25, 0
    s_mov_b32 s38, 0x9000
    s_mov_b32 s39, 0x20000
    s_mov_b32 s22, 128
    v_mul_lo_u32 v6, v0, s22
    buffer_store_dwordx4 v[16:19], v6, s[36:39], 0 offen sc1
    s_getpc_b64 s[20:21]
P_pc:
    s_add_u32 s36, s20, main_kernel-P_pc
    s_addc_u32 s37, s21, 0
    s_mov_b32 s38, L_code_end-main_kernel
    s_mov_b32 s39, 0x20000
    s_mov_b32 s22, 0
    buffer_load_dwordx4 v[20:23], v5, s[36:39], s22 offen
    s_add_u32 s22, s22, 9216
    buffer_load_dwordx4 v[24:27], v5, s[36:39], s22 offen
    s_add_u32 s22, s22, 9216
    buffer_load_dwordx4 v[28:31], v5, s[36:39], s22 offen
    s_add_u32 s22, s22, 9216
    buffer_load_dwordx4 v[32:35], v5, s[36:39], s22 offen
    s_add_u32 s22, s22, 9216
    buffer_load_dwordx4 v[36:39], v5, s[36:39], s22 offen
    s_add_u32 s22, s22, 9216
    buffer_load_dwordx4 v[40:43], v5, s[36:39], s22 offen
    s_add_u32 s22, s22, 9216
    buffer_load_dwordx4 v[44:47], v5, s[36:39], s22 offen
    s_add_u32 s22, s22, 9216
P_end:
L_exit:
    s_endpgm
.p2align 8
.globl main_kernel
.type main_kernel,@function
main_kernel:
    s_cmp_ge_u32 s2, 256
    s_cbranch_scc1 L_exit2
    s_load_dwordx2 s[24:25], s[0:1], 80
    s_load_dwordx4 s[28:31], s[0:1], 56
    s_load_dwordx2 s[32:33], s[0:1], 0
    s_load_dwordx2 s[36:37], s[0:1], 48
    s_mov_b32 s38, 5308416
    s_mov_b32 s39, 0x20000
    s_mov_b32 s34, 2359296
    s_mov_b32 s35, 0x20000
    v_lshrrev_b32 v1, 6, v0
    s_nop 0
    v_readfirstlane_b32 s3, v1
    v_and_b32 v1, 63, v0
    v_lshlrev_b32 v2, 4, v1
    v_lshrrev_b32 v3, 4, v1
    v_and_b32 v4, 15, v1
    s_and_b32 s6, s2, 7
    s_lshr_b32 s7, s2, 3
    s_and_b32 s4, s6, 1
    s_lshl_b32 s4, s4, 2
    s_and_b32 s8, s7, 3
    s_add_u32 s4, s4, s8
    s_lshr_b32 s5, s6, 1
    s_mul_i32 s5, s5, 8
    s_lshr_b32 s8, s7, 2
    s_add_u32 s5, s5, s8
    s_mov_b32 s44, 0xd25000
    s_mov_b32 s45, 0
    s_mov_b32 s46, 8
    s_mov_b32 s27, 1
    s_mov_b32 s97, 1152
    s_mul_i32 s47, s5, 73728
    s_mul_i32 s6, s5, 2048
    s_lshr_b32 s6, s6, 12
    s_mul_i32 s6, s6, 2
    s_sub_u32 s6, s5, s6
    s_mul_i32 s6, s6, 3
    s_mul_i32 s48, s6, 3072
    s_add_u32 s48, s48, s44
    s_mul_i32 s54, s6, 10752
    s_add_u32 s6, s6, 1
    s_cmp_eq_u32 s6, 6
    s_cselect_b32 s6, 0, s6
    s_mul_i32 s49, s6, 3072
    s_add_u32 s49, s49, s44
    s_mul_i32 s55, s6, 10752
    s_add_u32 s6, s6, 1
    s_cmp_eq_u32 s6, 6
    s_cselect_b32 s6, 0, s6
    s_mul_i32 s50, s6, 3072
    s_add_u32 s50, s50, s44
    s_mul_i32 s56, s6, 10752
    s_add_u32 s6, s6, 1
    s_cmp_eq_u32 s6, 6
    s_cselect_b32 s6, 0, s6
    s_mul_i32 s51, s6, 3072
    s_add_u32 s51, s51, s44
    s_mul_i32 s57, s6, 10752
    s_add_u32 s6, s6, 1
    s_cmp_eq_u32 s6, 6
    s_cselect_b32 s6, 0, s6
    s_mul_i32 s52, s6, 3072
    s_add_u32 s52, s52, s44
    s_mul_i32 s58, s6, 10752
    s_add_u32 s6, s6, 1
    s_cmp_eq_u32 s6, 6
    s_cselect_b32 s6, 0, s6
    s_mul_i32 s53, s6, 3072
    s_add_u32 s53, s53, s44
    s_mul_i32 s59, s6, 10752
    s_mul_i32 s8, s3, 18432
    s_add_u32 s8, s8, s47
    v_add_u32 v7, s8, v2
    s_min_u32 s9, s3, 2
    s_lshl_b32 s11, s9, 10
    s_add_u32 s8, s47, s11
    s_sub_u32 s8, s8, 18432
    s_cmp_eq_u32 s5, 0
    s_cselect_b32 s8, 0x80000000, s8
    v_add_u32 v8, s8, v2
    s_add_u32 s11, s11, 20480
    s_mul_i32 s10, s3, 18432
    s_add_u32 s10, s10, 38912
    v_add_u32 v5, 20480, v2
    v_add_u32 v6, 66560, v2
    s_lshl_b32 s12, s4, 2
    s_add_u32 s12, s12, s3
    s_mul_i32 s12, s12, 64512
    v_add_u32 v9, s12, v2
    v_add_u32 v10, 3072, v9
    v_add_u32 v11, 6144, v9
    s_add_u32 s12, s12, 9216
    v_lshlrev_b32 v12, 28, v4
    v_and_b32 v12, 0x80000000, v12
    v_lshl_add_u32 v12, v4, 4, v12
    v_lshl_add_u32 v12, v3, 7, v12
    v_add_u32 v12, s12, v12
    s_waitcnt lgkmcnt(0)
    s_mov_b32 s40, s24
    s_mov_b32 s41, s25
    s_mov_b32 s42, 0x4365000
    s_mov_b32 s43, 0x20000
    s_add_u32 s20, s24, 0xd1c000
    s_addc_u32 s21, s25, 0
    s_lshl_b32 s22, s5, 2
    s_add_u32 s22, s22, s3
    s_mul_i32 s22, s22, 128
    s_add_u32 m0, s10, 0
    s_nop 0
    buffer_load_dwordx4 v7, s[40:43], s48 offen offset:0 sc1 lds
    s_add_u32 m0, s10, 0
    s_nop 0
    buffer_load_dwordx4 v7, s[40:43], s48 offen offset:1024 sc1 lds
    s_add_u32 m0, s10, 0
    s_nop 0
    buffer_load_dwordx4 v7, s[40:43], s48 offen offset:2048 sc1 lds
    s_add_u32 m0, s11, 0
    s_nop 0
    buffer_load_dwordx4 v8, s[40:43], s48 offen sc1 lds
    buffer_load_dwordx4 a[0:3], v9, s[40:43], s54 offen offset:0
    buffer_load_dwordx4 a[4:7], v9, s[40:43], s54 offen offset:1024
    buffer_load_dwordx4 a[8:11], v9, s[40:43], s54 offen offset:2048
    buffer_load_dwordx4 a[12:15], v12, s[40:43], s54 offen offset:0
    s_add_u32 m0, s10, 3072
    s_nop 0
    buffer_load_dwordx4 v7, s[40:43], s49 offen offset:0 sc1 lds
    s_add_u32 m0, s10, 3072
    s_nop 0
    buffer_load_dwordx4 v7, s[40:43], s49 offen offset:1024 sc1 lds
    s_add_u32 m0, s10, 3072
    s_nop 0
    buffer_load_dwordx4 v7, s[40:43], s49 offen offset:2048 sc1 lds
    s_add_u32 m0, s11, 3072
    s_nop 0
    buffer_load_dwordx4 v8, s[40:43], s49 offen sc1 lds
    buffer_load_dwordx4 a[16:19], v10, s[40:43], s54 offen offset:0
    buffer_load_dwordx4 a[20:23], v10, s[40:43], s54 offen offset:1024
    buffer_load_dwordx4 a[24:27], v10, s[40:43], s54 offen offset:2048
    buffer_load_dwordx4 a[28:31], v12, s[40:43], s54 offen offset:512
    buffer_load_dwordx4 a[32:35], v11, s[40:43], s54 offen offset:0
    buffer_load_dwordx4 a[36:39], v11, s[40:43], s54 offen offset:1024
    buffer_load_dwordx4 a[40:43], v11, s[40:43], s54 offen offset:2048
    buffer_load_dwordx4 a[44:47], v12, s[40:43], s54 offen offset:1024
    s_mul_i32 s62, s3, 18432
    s_add_u32 s62, s62, s47
    s_add_u32 s62, s62, s44
    s_mul_i32 s63, s4, 2304
    s_add_u32 s63, s63, s62
    v_and_b32 v220, 1, v3
    v_lshlrev_b32 v220, 9, v220
    v_lshl_add_u32 v220, v4, 4, v220
    v_lshrrev_b32 v221, 5, v1
    v_lshl_add_u32 v220, v221, 8, v220
    v_mov_b32 v221, 0x80000000
    v_cmp_eq_u32 vcc, 0, v3
    s_nop 1
    v_cndmask_b32 v221, v221, v220, vcc
    v_cndmask_b32 v222, 0, -1, vcc
    s_add_u32 s65, s63, 0x6c0000
    s_sub_u32 s64, s63, s44
    s_mul_i32 s6, s4, 144
    s_sub_u32 s7, s62, s44
    s_add_u32 s6, s6, s7
    v_lshrrev_b32 v206, 4, v220
    v_and_b32 v206, 0x30, v206
    v_mad_u32_u24 v206, v4, s97, v206
    s_cmp_eq_u32 s45, 0
    s_cselect_b32 s64, s6, s64
    s_cselect_b32 s6, 64, 1024
    s_cselect_b64 s[8:9], -1, 0
    v_cndmask_b32 v206, v220, v206, s[8:9]
    v_add_u32 v207, s6, v206
    v_add_u32 v223, s6, v207
    v_cndmask_b32 v223, v221, v223, vcc
    v_and_b32 v13, 1, v4
    v_cmp_eq_u32 s[70:71], 1, v13
    v_lshl_add_u32 v14, v3, 2, v13
    v_cmp_ge_u32 s[72:73], v4, v14
    v_add_u32 v14, 2, v14
    v_cmp_ge_u32 s[74:75], v4, v14
    v_mov_b32 v13, 0xffff
    v_mov_b32 v14, 0xffff0000
    v_cndmask_b32 v13, v13, v14, s[70:71]
    v_cndmask_b32 v132, v13, 0, s[72:73]
    v_cndmask_b32 v133, v13, 0, s[74:75]
    v_cndmask_b32 v134, 0, v13, s[72:73]
    v_cndmask_b32 v135, 0, v13, s[74:75]
    s_cmp_eq_u32 s5, 0
    s_cselect_b32 s14, 0xcf7ce18f, 0
    v_mov_b32 v136, s14
    v_mov_b32 v137, s14
    v_mov_b32 v138, s14
    v_mov_b32 v139, s14
    s_lshl_b32 s14, s3, 11
    v_lshlrev_b32 v141, 9, v3
    v_lshl_add_u32 v141, v4, 1, v141
    v_add_u32 v141, s14, v141
    v_and_b32 v142, 1, v4
    v_mul_u32_u24 v142, 160, v142
    v_lshl_add_u32 v142, v3, 3, v142
    s_add_u32 s14, s14, 512
    v_add_u32 v142, s14, v142
    s_lshr_b32 s14, s3, 1
    s_lshl_b32 s14, s14, 10
    s_and_b32 s15, s3, 1
    s_lshl_b32 s15, s15, 3
    s_add_u32 s14, s14, s15
    s_add_u32 s14, s14, 8192
    v_add_u32 v143, s14, v2
    s_lshl_b32 s14, s3, 2
    s_add_u32 s14, s14, 10240
    v_add_u32 v144, s14, v2
    s_mul_i32 s14, s3, 3072
    s_add_u32 s14, s14, 8192
    v_add_u32 v145, s14, v2
    s_mul_i32 s60, s4, 82944
    s_add_u32 s60, s60, 0x240000
    s_mul_i32 s14, s3, 9216
    s_add_u32 s61, s60, s14
    s_add_u32 s61, s61, 46080
    s_mul_i32 s14, s3, 18432
    s_add_u32 s14, s14, 20480
    s_mul_i32 s13, s3, 12288
    s_add_u32 s60, s60, s13
    s_add_u32 s13, s13, 112640
    s_lshl_b32 s6, s5, 2
    s_add_u32 s6, s6, s3
    s_mul_i32 s7, s6, 57
    s_lshr_b32 s7, s7, 9
    s_mul_i32 s8, s7, 9
    s_sub_u32 s8, s6, s8
    s_mul_i32 s9, s4, 18
    s_add_u32 s9, s9, s7
    s_mul_i32 s9, s9, 36864
    s_lshl_b32 s12, s8, 7
    s_add_u32 s76, s9, s12
    s_add_u32 s77, s76, 9216
    s_add_u32 s78, s76, 18432
    s_add_u32 s79, s76, 27648
    s_mul_i32 s12, s4, 9
    s_add_u32 s12, s12, s8
    s_mul_i32 s12, s12, 73728
    s_lshl_b32 s7, s7, 10
    s_add_u32 s12, s12, s7
    s_add_u32 s12, s12, 0x7f8000
    s_cmp_lt_u32 s6, 126
    s_cselect_b32 s26, s12, 0x80000000
    v_lshrrev_b32 v236, 3, v1
    v_and_b32 v237, 7, v1
    v_lshlrev_b32 v237, 4, v237
    v_mad_u32_u24 v236, v236, s97, v237
    s_waitcnt vmcnt(16)
    s_barrier
    ds_read_b128 v[92:95], v5 offset:0
    ds_read_b128 v[96:99], v5 offset:18432
    ds_read_b128 v[100:103], v5 offset:36864
    ds_read_b128 v[104:107], v6 offset:9216
    ds_read_b128 v[108:111], v6 offset:27648
    s_waitcnt lgkmcnt(0)
    s_waitcnt vmcnt(12)
    v_mfma_f32_16x16x32_bf16 v[32:35], a[4:7], v[92:95], 0
    ds_read_b128 v[112:115], v5 offset:1024
    v_mfma_f32_16x16x32_bf16 v[52:55], v[92:95], a[8:11], 0
    s_add_u32 m0, s10, 6144
    s_nop 0
    buffer_load_dwordx4 v7, s[40:43], s50 offen offset:0 sc1 lds
    v_mfma_f32_16x16x32_bf16 v[72:75], a[12:15], v[92:95], 0
    ds_read_b128 v[116:119], v5 offset:19456
    v_mfma_f32_16x16x32_bf16 v[36:39], a[4:7], v[96:99], 0
    v_mfma_f32_16x16x32_bf16 v[56:59], v[96:99], a[8:11], 0
    s_add_u32 m0, s11, 6144
    s_nop 0
    buffer_load_dwordx4 v8, s[40:43], s50 offen sc1 lds
    ds_read_b128 v[120:123], v5 offset:37888
    v_mfma_f32_16x16x32_bf16 v[76:79], a[12:15], v[96:99], 0
    v_mfma_f32_16x16x32_bf16 v[16:19], a[0:3], v[96:99], 0
    ds_read_b128 v[124:127], v6 offset:10240
    v_mfma_f32_16x16x32_bf16 v[40:43], a[4:7], v[100:103], 0
    buffer_load_dwordx4 a[48:51], v9, s[40:43], s55 offen offset:0
    v_mfma_f32_16x16x32_bf16 v[60:63], v[100:103], a[8:11], 0
    ds_read_b128 v[128:131], v6 offset:28672
    v_mfma_f32_16x16x32_bf16 v[80:83], a[12:15], v[100:103], 0
    v_mfma_f32_16x16x32_bf16 v[20:23], a[0:3], v[100:103], 0
    buffer_load_dwordx4 a[52:55], v9, s[40:43], s55 offen offset:1024
    v_mfma_f32_16x16x32_bf16 v[44:47], a[4:7], v[104:107], 0
    v_mfma_f32_16x16x32_bf16 v[64:67], v[104:107], a[8:11], 0
    v_mfma_f32_16x16x32_bf16 v[84:87], a[12:15], v[104:107], 0
    buffer_load_dwordx4 a[56:59], v9, s[40:43], s55 offen offset:2048
    v_mfma_f32_16x16x32_bf16 v[24:27], a[0:3], v[104:107], 0
    v_mfma_f32_16x16x32_bf16 v[48:51], a[4:7], v[108:111], 0
    v_mfma_f32_16x16x32_bf16 v[68:71], v[108:111], a[8:11], 0
    buffer_load_dwordx4 a[60:63], v12, s[40:43], s55 offen offset:0
    v_mfma_f32_16x16x32_bf16 v[88:91], a[12:15], v[108:111], 0
    v_mfma_f32_16x16x32_bf16 v[28:31], a[0:3], v[108:111], 0
    s_waitcnt lgkmcnt(0)
    s_waitcnt vmcnt(10)
    v_mfma_f32_16x16x32_bf16 v[32:35], a[20:23], v[112:115], v[32:35]
    ds_read_b128 v[92:95], v5 offset:2048
    v_mfma_f32_16x16x32_bf16 v[52:55], v[112:115], a[24:27], v[52:55]
    s_add_u32 m0, s10, 6144
    s_nop 0
    buffer_load_dwordx4 v7, s[40:43], s50 offen offset:1024 sc1 lds
    v_mfma_f32_16x16x32_bf16 v[72:75], a[28:31], v[112:115], v[72:75]
    ds_read_b128 v[96:99], v5 offset:20480
    v_mfma_f32_16x16x32_bf16 v[36:39], a[20:23], v[116:119], v[36:39]
    v_mfma_f32_16x16x32_bf16 v[56:59], v[116:119], a[24:27], v[56:59]
    buffer_load_dwordx4 a[64:67], v10, s[40:43], s55 offen offset:0
    ds_read_b128 v[100:103], v5 offset:38912
    v_mfma_f32_16x16x32_bf16 v[76:79], a[28:31], v[116:119], v[76:79]
    v_mfma_f32_16x16x32_bf16 v[16:19], a[16:19], v[116:119], v[16:19]
    ds_read_b128 v[104:107], v6 offset:11264
    v_mfma_f32_16x16x32_bf16 v[40:43], a[20:23], v[120:123], v[40:43]
    v_mfma_f32_16x16x32_bf16 v[60:63], v[120:123], a[24:27], v[60:63]
    buffer_load_dwordx4 a[68:71], v10, s[40:43], s55 offen offset:1024
    ds_read_b128 v[108:111], v6 offset:29696
    v_mfma_f32_16x16x32_bf16 v[80:83], a[28:31], v[120:123], v[80:83]
    v_mfma_f32_16x16x32_bf16 v[20:23], a[16:19], v[120:123], v[20:23]
    v_mfma_f32_16x16x32_bf16 v[44:47], a[20:23], v[124:127], v[44:47]
    buffer_load_dwordx4 a[72:75], v10, s[40:43], s55 offen offset:2048
    v_mfma_f32_16x16x32_bf16 v[64:67], v[124:127], a[24:27], v[64:67]
    v_mfma_f32_16x16x32_bf16 v[84:87], a[28:31], v[124:127], v[84:87]
    v_mfma_f32_16x16x32_bf16 v[24:27], a[16:19], v[124:127], v[24:27]
    v_mfma_f32_16x16x32_bf16 v[48:51], a[20:23], v[128:131], v[48:51]
    buffer_load_dwordx4 a[76:79], v12, s[40:43], s55 offen offset:512
    v_mfma_f32_16x16x32_bf16 v[68:71], v[128:131], a[24:27], v[68:71]
    v_mfma_f32_16x16x32_bf16 v[88:91], a[28:31], v[128:131], v[88:91]
    v_mfma_f32_16x16x32_bf16 v[28:31], a[16:19], v[128:131], v[28:31]
    s_barrier
    s_waitcnt lgkmcnt(0)
    s_waitcnt vmcnt(11)
    v_mfma_f32_16x16x32_bf16 v[32:35], a[36:39], v[92:95], v[32:35]
    ds_read_b128 v[112:115], v5 offset:3072
    v_mfma_f32_16x16x32_bf16 v[52:55], v[92:95], a[40:43], v[52:55]
    s_add_u32 m0, s10, 6144
    s_nop 0
    buffer_load_dwordx4 v7, s[40:43], s50 offen offset:2048 sc1 lds
    v_mfma_f32_16x16x32_bf16 v[72:75], a[44:47], v[92:95], v[72:75]
    ds_read_b128 v[116:119], v5 offset:21504
    v_mfma_f32_16x16x32_bf16 v[36:39], a[36:39], v[96:99], v[36:39]
    v_mfma_f32_16x16x32_bf16 v[56:59], v[96:99], a[40:43], v[56:59]
    buffer_load_dwordx4 a[80:83], v11, s[40:43], s55 offen offset:0
    ds_read_b128 v[120:123], v5 offset:39936
    v_mfma_f32_16x16x32_bf16 v[76:79], a[44:47], v[96:99], v[76:79]
    v_mfma_f32_16x16x32_bf16 v[16:19], a[32:35], v[96:99], v[16:19]
    ds_read_b128 v[124:127], v6 offset:12288
    v_mfma_f32_16x16x32_bf16 v[40:43], a[36:39], v[100:103], v[40:43]
    v_mfma_f32_16x16x32_bf16 v[60:63], v[100:103], a[40:43], v[60:63]
    buffer_load_dwordx4 a[84:87], v11, s[40:43], s55 offen offset:1024
    ds_read_b128 v[128:131], v6 offset:30720
    v_mfma_f32_16x16x32_bf16 v[80:83], a[44:47], v[100:103], v[80:83]
    v_mfma_f32_16x16x32_bf16 v[20:23], a[32:35], v[100:103], v[20:23]
    v_mfma_f32_16x16x32_bf16 v[44:47], a[36:39], v[104:107], v[44:47]
    buffer_load_dwordx4 a[88:91], v11, s[40:43], s55 offen offset:2048
    v_mfma_f32_16x16x32_bf16 v[64:67], v[104:107], a[40:43], v[64:67]
    v_mfma_f32_16x16x32_bf16 v[84:87], a[44:47], v[104:107], v[84:87]
    v_mfma_f32_16x16x32_bf16 v[24:27], a[32:35], v[104:107], v[24:27]
    v_mfma_f32_16x16x32_bf16 v[48:51], a[36:39], v[108:111], v[48:51]
    buffer_load_dwordx4 a[92:95], v12, s[40:43], s55 offen offset:1024
    v_mfma_f32_16x16x32_bf16 v[68:71], v[108:111], a[40:43], v[68:71]
    v_mfma_f32_16x16x32_bf16 v[88:91], a[44:47], v[108:111], v[88:91]
    v_mfma_f32_16x16x32_bf16 v[28:31], a[32:35], v[108:111], v[28:31]
    s_waitcnt lgkmcnt(0)
    s_waitcnt vmcnt(10)
    v_mfma_f32_16x16x32_bf16 v[32:35], a[52:55], v[112:115], v[32:35]
    ds_read_b128 v[92:95], v5 offset:4096
    v_mfma_f32_16x16x32_bf16 v[52:55], v[112:115], a[56:59], v[52:55]
    s_add_u32 m0, s10, 9216
    s_nop 0
    buffer_load_dwordx4 v7, s[40:43], s51 offen offset:0 sc1 lds
    v_mfma_f32_16x16x32_bf16 v[72:75], a[60:63], v[112:115], v[72:75]
    ds_read_b128 v[96:99], v5 offset:22528
    v_mfma_f32_16x16x32_bf16 v[36:39], a[52:55], v[116:119], v[36:39]
    v_mfma_f32_16x16x32_bf16 v[56:59], v[116:119], a[56:59], v[56:59]
    s_add_u32 m0, s11, 9216
    s_nop 0
    buffer_load_dwordx4 v8, s[40:43], s51 offen sc1 lds
    ds_read_b128 v[100:103], v5 offset:40960
    v_mfma_f32_16x16x32_bf16 v[76:79], a[60:63], v[116:119], v[76:79]
    v_mfma_f32_16x16x32_bf16 v[16:19], a[48:51], v[116:119], v[16:19]
    ds_read_b128 v[104:107], v6 offset:13312
    v_mfma_f32_16x16x32_bf16 v[40:43], a[52:55], v[120:123], v[40:43]
    buffer_load_dwordx4 a[96:99], v9, s[40:43], s56 offen offset:0
    v_mfma_f32_16x16x32_bf16 v[60:63], v[120:123], a[56:59], v[60:63]
    ds_read_b128 v[108:111], v6 offset:31744
    v_mfma_f32_16x16x32_bf16 v[80:83], a[60:63], v[120:123], v[80:83]
    v_mfma_f32_16x16x32_bf16 v[20:23], a[48:51], v[120:123], v[20:23]
    buffer_load_dwordx4 a[100:103], v9, s[40:43], s56 offen offset:1024
    v_mfma_f32_16x16x32_bf16 v[44:47], a[52:55], v[124:127], v[44:47]
    v_mfma_f32_16x16x32_bf16 v[64:67], v[124:127], a[56:59], v[64:67]
    v_mfma_f32_16x16x32_bf16 v[84:87], a[60:63], v[124:127], v[84:87]
    buffer_load_dwordx4 a[104:107], v9, s[40:43], s56 offen offset:2048
    v_mfma_f32_16x16x32_bf16 v[24:27], a[48:51], v[124:127], v[24:27]
    v_mfma_f32_16x16x32_bf16 v[48:51], a[52:55], v[128:131], v[48:51]
    v_mfma_f32_16x16x32_bf16 v[68:71], v[128:131], a[56:59], v[68:71]
    buffer_load_dwordx4 a[108:111], v12, s[40:43], s56 offen offset:0
    v_mfma_f32_16x16x32_bf16 v[88:91], a[60:63], v[128:131], v[88:91]
    v_mfma_f32_16x16x32_bf16 v[28:31], a[48:51], v[128:131], v[28:31]
    s_waitcnt lgkmcnt(0)
    s_waitcnt vmcnt(11)
    v_mfma_f32_16x16x32_bf16 v[32:35], a[68:71], v[92:95], v[32:35]
    ds_read_b128 v[112:115], v5 offset:5120
    v_mfma_f32_16x16x32_bf16 v[52:55], v[92:95], a[72:75], v[52:55]
    s_add_u32 m0, s10, 9216
    s_nop 0
    buffer_load_dwordx4 v7, s[40:43], s51 offen offset:1024 sc1 lds
    v_mfma_f32_16x16x32_bf16 v[72:75], a[76:79], v[92:95], v[72:75]
    ds_read_b128 v[116:119], v5 offset:23552
    v_mfma_f32_16x16x32_bf16 v[36:39], a[68:71], v[96:99], v[36:39]
    v_mfma_f32_16x16x32_bf16 v[56:59], v[96:99], a[72:75], v[56:59]
    buffer_load_dwordx4 a[112:115], v10, s[40:43], s56 offen offset:0
    ds_read_b128 v[120:123], v5 offset:41984
    v_mfma_f32_16x16x32_bf16 v[76:79], a[76:79], v[96:99], v[76:79]
    v_mfma_f32_16x16x32_bf16 v[16:19], a[64:67], v[96:99], v[16:19]
    ds_read_b128 v[124:127], v6 offset:14336
    v_mfma_f32_16x16x32_bf16 v[40:43], a[68:71], v[100:103], v[40:43]
    v_mfma_f32_16x16x32_bf16 v[60:63], v[100:103], a[72:75], v[60:63]
    buffer_load_dwordx4 a[116:119], v10, s[40:43], s56 offen offset:1024
    ds_read_b128 v[128:131], v6 offset:32768
    v_mfma_f32_16x16x32_bf16 v[80:83], a[76:79], v[100:103], v[80:83]
    v_mfma_f32_16x16x32_bf16 v[20:23], a[64:67], v[100:103], v[20:23]
    v_mfma_f32_16x16x32_bf16 v[44:47], a[68:71], v[104:107], v[44:47]
    buffer_load_dwordx4 a[120:123], v10, s[40:43], s56 offen offset:2048
    v_mfma_f32_16x16x32_bf16 v[64:67], v[104:107], a[72:75], v[64:67]
    v_mfma_f32_16x16x32_bf16 v[84:87], a[76:79], v[104:107], v[84:87]
    v_mfma_f32_16x16x32_bf16 v[24:27], a[64:67], v[104:107], v[24:27]
    v_mfma_f32_16x16x32_bf16 v[48:51], a[68:71], v[108:111], v[48:51]
    buffer_load_dwordx4 a[124:127], v12, s[40:43], s56 offen offset:512
    v_mfma_f32_16x16x32_bf16 v[68:71], v[108:111], a[72:75], v[68:71]
    v_mfma_f32_16x16x32_bf16 v[88:91], a[76:79], v[108:111], v[88:91]
    v_mfma_f32_16x16x32_bf16 v[28:31], a[64:67], v[108:111], v[28:31]
    s_waitcnt vmcnt(15)
    s_barrier
    s_waitcnt lgkmcnt(0)
    s_waitcnt vmcnt(11)
    v_mfma_f32_16x16x32_bf16 v[32:35], a[84:87], v[112:115], v[32:35]
    ds_read_b128 v[92:95], v5 offset:6144
    v_mfma_f32_16x16x32_bf16 v[52:55], v[112:115], a[88:91], v[52:55]
    s_add_u32 m0, s10, 9216
    s_nop 0
    buffer_load_dwordx4 v7, s[40:43], s51 offen offset:2048 sc1 lds
    v_mfma_f32_16x16x32_bf16 v[72:75], a[92:95], v[112:115], v[72:75]
    ds_read_b128 v[96:99], v5 offset:24576
    v_mfma_f32_16x16x32_bf16 v[36:39], a[84:87], v[116:119], v[36:39]
    v_mfma_f32_16x16x32_bf16 v[56:59], v[116:119], a[88:91], v[56:59]
    buffer_load_dwordx4 a[128:131], v11, s[40:43], s56 offen offset:0
    ds_read_b128 v[100:103], v5 offset:43008
    v_mfma_f32_16x16x32_bf16 v[76:79], a[92:95], v[116:119], v[76:79]
    v_mfma_f32_16x16x32_bf16 v[16:19], a[80:83], v[116:119], v[16:19]
    ds_read_b128 v[104:107], v6 offset:15360
    v_mfma_f32_16x16x32_bf16 v[40:43], a[84:87], v[120:123], v[40:43]
    v_mfma_f32_16x16x32_bf16 v[60:63], v[120:123], a[88:91], v[60:63]
    buffer_load_dwordx4 a[132:135], v11, s[40:43], s56 offen offset:1024
    ds_read_b128 v[108:111], v6 offset:33792
    v_mfma_f32_16x16x32_bf16 v[80:83], a[92:95], v[120:123], v[80:83]
    v_mfma_f32_16x16x32_bf16 v[20:23], a[80:83], v[120:123], v[20:23]
    v_mfma_f32_16x16x32_bf16 v[44:47], a[84:87], v[124:127], v[44:47]
    buffer_load_dwordx4 a[136:139], v11, s[40:43], s56 offen offset:2048
    v_mfma_f32_16x16x32_bf16 v[64:67], v[124:127], a[88:91], v[64:67]
    v_mfma_f32_16x16x32_bf16 v[84:87], a[92:95], v[124:127], v[84:87]
    v_mfma_f32_16x16x32_bf16 v[24:27], a[80:83], v[124:127], v[24:27]
    v_mfma_f32_16x16x32_bf16 v[48:51], a[84:87], v[128:131], v[48:51]
    buffer_load_dwordx4 a[140:143], v12, s[40:43], s56 offen offset:1024
    v_mfma_f32_16x16x32_bf16 v[68:71], v[128:131], a[88:91], v[68:71]
    v_mfma_f32_16x16x32_bf16 v[88:91], a[92:95], v[128:131], v[88:91]
    v_mfma_f32_16x16x32_bf16 v[28:31], a[80:83], v[128:131], v[28:31]
    s_waitcnt lgkmcnt(0)
    s_waitcnt vmcnt(10)
    v_mfma_f32_16x16x32_bf16 v[32:35], a[100:103], v[92:95], v[32:35]
    ds_read_b128 v[112:115], v5 offset:7168
    v_mfma_f32_16x16x32_bf16 v[52:55], v[92:95], a[104:107], v[52:55]
    s_add_u32 m0, s10, 12288
    s_nop 0
    buffer_load_dwordx4 v7, s[40:43], s52 offen offset:0 sc1 lds
    v_mfma_f32_16x16x32_bf16 v[72:75], a[108:111], v[92:95], v[72:75]
    ds_read_b128 v[116:119], v5 offset:25600
    v_mfma_f32_16x16x32_bf16 v[36:39], a[100:103], v[96:99], v[36:39]
    v_mfma_f32_16x16x32_bf16 v[56:59], v[96:99], a[104:107], v[56:59]
    s_add_u32 m0, s11, 12288
    s_nop 0
    buffer_load_dwordx4 v8, s[40:43], s52 offen sc1 lds
    ds_read_b128 v[120:123], v5 offset:44032
    v_mfma_f32_16x16x32_bf16 v[76:79], a[108:111], v[96:99], v[76:79]
    v_mfma_f32_16x16x32_bf16 v[16:19], a[96:99], v[96:99], v[16:19]
    ds_read_b128 v[124:127], v6 offset:16384
    v_mfma_f32_16x16x32_bf16 v[40:43], a[100:103], v[100:103], v[40:43]
    buffer_load_dwordx4 a[144:147], v9, s[40:43], s57 offen offset:0
    v_mfma_f32_16x16x32_bf16 v[60:63], v[100:103], a[104:107], v[60:63]
    ds_read_b128 v[128:131], v6 offset:34816
    v_mfma_f32_16x16x32_bf16 v[80:83], a[108:111], v[100:103], v[80:83]
    v_mfma_f32_16x16x32_bf16 v[20:23], a[96:99], v[100:103], v[20:23]
    buffer_load_dwordx4 a[148:151], v9, s[40:43], s57 offen offset:1024
    v_mfma_f32_16x16x32_bf16 v[44:47], a[100:103], v[104:107], v[44:47]
    v_mfma_f32_16x16x32_bf16 v[64:67], v[104:107], a[104:107], v[64:67]
    v_mfma_f32_16x16x32_bf16 v[84:87], a[108:111], v[104:107], v[84:87]
    buffer_load_dwordx4 a[152:155], v9, s[40:43], s57 offen offset:2048
    v_mfma_f32_16x16x32_bf16 v[24:27], a[96:99], v[104:107], v[24:27]
    v_mfma_f32_16x16x32_bf16 v[48:51], a[100:103], v[108:111], v[48:51]
    v_mfma_f32_16x16x32_bf16 v[68:71], v[108:111], a[104:107], v[68:71]
    buffer_load_dwordx4 a[156:159], v12, s[40:43], s57 offen offset:0
    v_mfma_f32_16x16x32_bf16 v[88:91], a[108:111], v[108:111], v[88:91]
    v_mfma_f32_16x16x32_bf16 v[28:31], a[96:99], v[108:111], v[28:31]
    s_waitcnt lgkmcnt(0)
    s_waitcnt vmcnt(11)
    v_mfma_f32_16x16x32_bf16 v[32:35], a[116:119], v[112:115], v[32:35]
    ds_read_b128 v[92:95], v5 offset:8192
    v_mfma_f32_16x16x32_bf16 v[52:55], v[112:115], a[120:123], v[52:55]
    s_add_u32 m0, s10, 12288
    s_nop 0
    buffer_load_dwordx4 v7, s[40:43], s52 offen offset:1024 sc1 lds
    v_mfma_f32_16x16x32_bf16 v[72:75], a[124:127], v[112:115], v[72:75]
    ds_read_b128 v[96:99], v5 offset:26624
    v_mfma_f32_16x16x32_bf16 v[36:39], a[116:119], v[116:119], v[36:39]
    v_mfma_f32_16x16x32_bf16 v[56:59], v[116:119], a[120:123], v[56:59]
    buffer_load_dwordx4 a[160:163], v10, s[40:43], s57 offen offset:0
    ds_read_b128 v[100:103], v5 offset:45056
    v_mfma_f32_16x16x32_bf16 v[76:79], a[124:127], v[116:119], v[76:79]
    v_mfma_f32_16x16x32_bf16 v[16:19], a[112:115], v[116:119], v[16:19]
    ds_read_b128 v[104:107], v6 offset:17408
    v_mfma_f32_16x16x32_bf16 v[40:43], a[116:119], v[120:123], v[40:43]
    v_mfma_f32_16x16x32_bf16 v[60:63], v[120:123], a[120:123], v[60:63]
    buffer_load_dwordx4 a[164:167], v10, s[40:43], s57 offen offset:1024
    ds_read_b128 v[108:111], v6 offset:35840
    v_mfma_f32_16x16x32_bf16 v[80:83], a[124:127], v[120:123], v[80:83]
    v_mfma_f32_16x16x32_bf16 v[20:23], a[112:115], v[120:123], v[20:23]
    v_mfma_f32_16x16x32_bf16 v[44:47], a[116:119], v[124:127], v[44:47]
    buffer_load_dwordx4 a[168:171], v10, s[40:43], s57 offen offset:2048
    v_mfma_f32_16x16x32_bf16 v[64:67], v[124:127], a[120:123], v[64:67]
    v_mfma_f32_16x16x32_bf16 v[84:87], a[124:127], v[124:127], v[84:87]
    v_mfma_f32_16x16x32_bf16 v[24:27], a[112:115], v[124:127], v[24:27]
    v_mfma_f32_16x16x32_bf16 v[48:51], a[116:119], v[128:131], v[48:51]
    buffer_load_dwordx4 a[172:175], v12, s[40:43], s57 offen offset:512
    v_mfma_f32_16x16x32_bf16 v[68:71], v[128:131], a[120:123], v[68:71]
    v_mfma_f32_16x16x32_bf16 v[88:91], a[124:127], v[128:131], v[88:91]
    v_mfma_f32_16x16x32_bf16 v[28:31], a[112:115], v[128:131], v[28:31]
    s_waitcnt vmcnt(15)
    s_barrier
    s_waitcnt lgkmcnt(0)
    s_waitcnt vmcnt(11)
    v_mfma_f32_16x16x32_bf16 v[32:35], a[132:135], v[92:95], v[32:35]
    ds_read_b128 v[112:115], v5 offset:9216
    v_mfma_f32_16x16x32_bf16 v[52:55], v[92:95], a[136:139], v[52:55]
    s_add_u32 m0, s10, 12288
    s_nop 0
    buffer_load_dwordx4 v7, s[40:43], s52 offen offset:2048 sc1 lds
    v_mfma_f32_16x16x32_bf16 v[72:75], a[140:143], v[92:95], v[72:75]
    ds_read_b128 v[116:119], v5 offset:27648
    v_mfma_f32_16x16x32_bf16 v[36:39], a[132:135], v[96:99], v[36:39]
    v_mfma_f32_16x16x32_bf16 v[56:59], v[96:99], a[136:139], v[56:59]
    buffer_load_dwordx4 a[176:179], v11, s[40:43], s57 offen offset:0
    ds_read_b128 v[120:123], v6 offset:0
    v_mfma_f32_16x16x32_bf16 v[76:79], a[140:143], v[96:99], v[76:79]
    v_mfma_f32_16x16x32_bf16 v[16:19], a[128:131], v[96:99], v[16:19]
    ds_read_b128 v[124:127], v6 offset:18432
    v_mfma_f32_16x16x32_bf16 v[40:43], a[132:135], v[100:103], v[40:43]
    v_mfma_f32_16x16x32_bf16 v[60:63], v[100:103], a[136:139], v[60:63]
    buffer_load_dwordx4 a[180:183], v11, s[40:43], s57 offen offset:1024
    ds_read_b128 v[128:131], v6 offset:36864
    v_mfma_f32_16x16x32_bf16 v[80:83], a[140:143], v[100:103], v[80:83]
    v_mfma_f32_16x16x32_bf16 v[20:23], a[128:131], v[100:103], v[20:23]
    v_mfma_f32_16x16x32_bf16 v[44:47], a[132:135], v[104:107], v[44:47]
    buffer_load_dwordx4 a[184:187], v11, s[40:43], s57 offen offset:2048
    v_mfma_f32_16x16x32_bf16 v[64:67], v[104:107], a[136:139], v[64:67]
    v_mfma_f32_16x16x32_bf16 v[84:87], a[140:143], v[104:107], v[84:87]
    v_mfma_f32_16x16x32_bf16 v[24:27], a[128:131], v[104:107], v[24:27]
    v_mfma_f32_16x16x32_bf16 v[48:51], a[132:135], v[108:111], v[48:51]
    buffer_load_dwordx4 a[188:191], v12, s[40:43], s57 offen offset:1024
    v_mfma_f32_16x16x32_bf16 v[68:71], v[108:111], a[136:139], v[68:71]
    v_mfma_f32_16x16x32_bf16 v[88:91], a[140:143], v[108:111], v[88:91]
    v_mfma_f32_16x16x32_bf16 v[28:31], a[128:131], v[108:111], v[28:31]
    s_waitcnt lgkmcnt(0)
    s_waitcnt vmcnt(10)
    v_mfma_f32_16x16x32_bf16 v[32:35], a[148:151], v[112:115], v[32:35]
    ds_read_b128 v[92:95], v5 offset:10240
    v_mfma_f32_16x16x32_bf16 v[52:55], v[112:115], a[152:155], v[52:55]
    s_add_u32 m0, s10, 15360
    s_nop 0
    buffer_load_dwordx4 v7, s[40:43], s53 offen offset:0 sc1 lds
    v_mfma_f32_16x16x32_bf16 v[72:75], a[156:159], v[112:115], v[72:75]
    ds_read_b128 v[96:99], v5 offset:28672
    v_mfma_f32_16x16x32_bf16 v[36:39], a[148:151], v[116:119], v[36:39]
    v_mfma_f32_16x16x32_bf16 v[56:59], v[116:119], a[152:155], v[56:59]
    s_add_u32 m0, s11, 15360
    s_nop 0
    buffer_load_dwordx4 v8, s[40:43], s53 offen sc1 lds
    ds_read_b128 v[100:103], v6 offset:1024
    v_mfma_f32_16x16x32_bf16 v[76:79], a[156:159], v[116:119], v[76:79]
    v_mfma_f32_16x16x32_bf16 v[16:19], a[144:147], v[116:119], v[16:19]
    ds_read_b128 v[104:107], v6 offset:19456
    v_mfma_f32_16x16x32_bf16 v[40:43], a[148:151], v[120:123], v[40:43]
    buffer_load_dwordx4 a[192:195], v9, s[40:43], s58 offen offset:0
    v_mfma_f32_16x16x32_bf16 v[60:63], v[120:123], a[152:155], v[60:63]
    ds_read_b128 v[108:111], v6 offset:37888
    v_mfma_f32_16x16x32_bf16 v[80:83], a[156:159], v[120:123], v[80:83]
    v_mfma_f32_16x16x32_bf16 v[20:23], a[144:147], v[120:123], v[20:23]
    buffer_load_dwordx4 a[196:199], v9, s[40:43], s58 offen offset:1024
    v_mfma_f32_16x16x32_bf16 v[44:47], a[148:151], v[124:127], v[44:47]
    v_mfma_f32_16x16x32_bf16 v[64:67], v[124:127], a[152:155], v[64:67]
    v_mfma_f32_16x16x32_bf16 v[84:87], a[156:159], v[124:127], v[84:87]
    buffer_load_dwordx4 a[200:203], v9, s[40:43], s58 offen offset:2048
    v_mfma_f32_16x16x32_bf16 v[24:27], a[144:147], v[124:127], v[24:27]
    v_mfma_f32_16x16x32_bf16 v[48:51], a[148:151], v[128:131], v[48:51]
    v_mfma_f32_16x16x32_bf16 v[68:71], v[128:131], a[152:155], v[68:71]
    buffer_load_dwordx4 a[204:207], v12, s[40:43], s58 offen offset:0
    v_mfma_f32_16x16x32_bf16 v[88:91], a[156:159], v[128:131], v[88:91]
    v_mfma_f32_16x16x32_bf16 v[28:31], a[144:147], v[128:131], v[28:31]
    s_waitcnt lgkmcnt(0)
    s_waitcnt vmcnt(11)
    v_mfma_f32_16x16x32_bf16 v[32:35], a[164:167], v[92:95], v[32:35]
    ds_read_b128 v[112:115], v5 offset:11264
    v_mfma_f32_16x16x32_bf16 v[52:55], v[92:95], a[168:171], v[52:55]
    s_add_u32 m0, s10, 15360
    s_nop 0
    buffer_load_dwordx4 v7, s[40:43], s53 offen offset:1024 sc1 lds
    v_mfma_f32_16x16x32_bf16 v[72:75], a[172:175], v[92:95], v[72:75]
    ds_read_b128 v[116:119], v5 offset:29696
    v_mfma_f32_16x16x32_bf16 v[36:39], a[164:167], v[96:99], v[36:39]
    v_mfma_f32_16x16x32_bf16 v[56:59], v[96:99], a[168:171], v[56:59]
    buffer_load_dwordx4 a[208:211], v10, s[40:43], s58 offen offset:0
    ds_read_b128 v[120:123], v6 offset:2048
    v_mfma_f32_16x16x32_bf16 v[76:79], a[172:175], v[96:99], v[76:79]
    v_mfma_f32_16x16x32_bf16 v[16:19], a[160:163], v[96:99], v[16:19]
    ds_read_b128 v[124:127], v6 offset:20480
    v_mfma_f32_16x16x32_bf16 v[40:43], a[164:167], v[100:103], v[40:43]
    v_mfma_f32_16x16x32_bf16 v[60:63], v[100:103], a[168:171], v[60:63]
    buffer_load_dwordx4 a[212:215], v10, s[40:43], s58 offen offset:1024
    ds_read_b128 v[128:131], v6 offset:38912
    v_mfma_f32_16x16x32_bf16 v[80:83], a[172:175], v[100:103], v[80:83]
    v_mfma_f32_16x16x32_bf16 v[20:23], a[160:163], v[100:103], v[20:23]
    v_mfma_f32_16x16x32_bf16 v[44:47], a[164:167], v[104:107], v[44:47]
    buffer_load_dwordx4 a[216:219], v10, s[40:43], s58 offen offset:2048
    v_mfma_f32_16x16x32_bf16 v[64:67], v[104:107], a[168:171], v[64:67]
    v_mfma_f32_16x16x32_bf16 v[84:87], a[172:175], v[104:107], v[84:87]
    v_mfma_f32_16x16x32_bf16 v[24:27], a[160:163], v[104:107], v[24:27]
    v_mfma_f32_16x16x32_bf16 v[48:51], a[164:167], v[108:111], v[48:51]
    buffer_load_dwordx4 a[220:223], v12, s[40:43], s58 offen offset:512
    v_mfma_f32_16x16x32_bf16 v[68:71], v[108:111], a[168:171], v[68:71]
    v_mfma_f32_16x16x32_bf16 v[88:91], a[172:175], v[108:111], v[88:91]
    v_mfma_f32_16x16x32_bf16 v[28:31], a[160:163], v[108:111], v[28:31]
    s_waitcnt vmcnt(15)
    s_barrier
    s_waitcnt lgkmcnt(0)
    s_waitcnt vmcnt(11)
    v_mfma_f32_16x16x32_bf16 v[32:35], a[180:183], v[112:115], v[32:35]
    ds_read_b128 v[92:95], v5 offset:12288
    v_mfma_f32_16x16x32_bf16 v[52:55], v[112:115], a[184:187], v[52:55]
    s_add_u32 m0, s10, 15360
    s_nop 0
    buffer_load_dwordx4 v7, s[40:43], s53 offen offset:2048 sc1 lds
    v_mfma_f32_16x16x32_bf16 v[72:75], a[188:191], v[112:115], v[72:75]
    ds_read_b128 v[96:99], v5 offset:30720
    v_mfma_f32_16x16x32_bf16 v[36:39], a[180:183], v[116:119], v[36:39]
    v_mfma_f32_16x16x32_bf16 v[56:59], v[116:119], a[184:187], v[56:59]
    buffer_load_dwordx4 a[224:227], v11, s[40:43], s58 offen offset:0
    ds_read_b128 v[100:103], v6 offset:3072
    v_mfma_f32_16x16x32_bf16 v[76:79], a[188:191], v[116:119], v[76:79]
    v_mfma_f32_16x16x32_bf16 v[16:19], a[176:179], v[116:119], v[16:19]
    ds_read_b128 v[104:107], v6 offset:21504
    v_mfma_f32_16x16x32_bf16 v[40:43], a[180:183], v[120:123], v[40:43]
    v_mfma_f32_16x16x32_bf16 v[60:63], v[120:123], a[184:187], v[60:63]
    buffer_load_dwordx4 a[228:231], v11, s[40:43], s58 offen offset:1024
    ds_read_b128 v[108:111], v6 offset:39936
    v_mfma_f32_16x16x32_bf16 v[80:83], a[188:191], v[120:123], v[80:83]
    v_mfma_f32_16x16x32_bf16 v[20:23], a[176:179], v[120:123], v[20:23]
    v_mfma_f32_16x16x32_bf16 v[44:47], a[180:183], v[124:127], v[44:47]
    buffer_load_dwordx4 a[232:235], v11, s[40:43], s58 offen offset:2048
    v_mfma_f32_16x16x32_bf16 v[64:67], v[124:127], a[184:187], v[64:67]
    v_mfma_f32_16x16x32_bf16 v[84:87], a[188:191], v[124:127], v[84:87]
    v_mfma_f32_16x16x32_bf16 v[24:27], a[176:179], v[124:127], v[24:27]
    v_mfma_f32_16x16x32_bf16 v[48:51], a[180:183], v[128:131], v[48:51]
    buffer_load_dwordx4 a[236:239], v12, s[40:43], s58 offen offset:1024
    v_mfma_f32_16x16x32_bf16 v[68:71], v[128:131], a[184:187], v[68:71]
    v_mfma_f32_16x16x32_bf16 v[88:91], a[188:191], v[128:131], v[88:91]
    v_mfma_f32_16x16x32_bf16 v[28:31], a[176:179], v[128:131], v[28:31]
    s_waitcnt lgkmcnt(0)
    s_waitcnt vmcnt(10)
    v_mfma_f32_16x16x32_bf16 v[32:35], a[196:199], v[92:95], v[32:35]
    ds_read_b128 v[112:115], v5 offset:13312
    v_mfma_f32_16x16x32_bf16 v[52:55], v[92:95], a[200:203], v[52:55]
    buffer_load_dwordx4 a[240:243], v9, s[40:43], s59 offen offset:0
    v_mfma_f32_16x16x32_bf16 v[72:75], a[204:207], v[92:95], v[72:75]
    ds_read_b128 v[116:119], v5 offset:31744
    v_mfma_f32_16x16x32_bf16 v[36:39], a[196:199], v[96:99], v[36:39]
    v_mfma_f32_16x16x32_bf16 v[56:59], v[96:99], a[200:203], v[56:59]
    ds_read_b128 v[120:123], v6 offset:4096
    v_mfma_f32_16x16x32_bf16 v[76:79], a[204:207], v[96:99], v[76:79]
    buffer_load_dwordx4 a[244:247], v9, s[40:43], s59 offen offset:1024
    v_mfma_f32_16x16x32_bf16 v[16:19], a[192:195], v[96:99], v[16:19]
    ds_read_b128 v[124:127], v6 offset:22528
    v_mfma_f32_16x16x32_bf16 v[40:43], a[196:199], v[100:103], v[40:43]
    v_mfma_f32_16x16x32_bf16 v[60:63], v[100:103], a[200:203], v[60:63]
    ds_read_b128 v[128:131], v6 offset:40960
    v_mfma_f32_16x16x32_bf16 v[80:83], a[204:207], v[100:103], v[80:83]
    v_mfma_f32_16x16x32_bf16 v[20:23], a[192:195], v[100:103], v[20:23]
    buffer_load_dwordx4 a[248:251], v9, s[40:43], s59 offen offset:2048
    v_mfma_f32_16x16x32_bf16 v[44:47], a[196:199], v[104:107], v[44:47]
    v_mfma_f32_16x16x32_bf16 v[64:67], v[104:107], a[200:203], v[64:67]
    v_mfma_f32_16x16x32_bf16 v[84:87], a[204:207], v[104:107], v[84:87]
    v_mfma_f32_16x16x32_bf16 v[24:27], a[192:195], v[104:107], v[24:27]
    buffer_load_dwordx4 a[252:255], v12, s[40:43], s59 offen offset:0
    v_mfma_f32_16x16x32_bf16 v[48:51], a[196:199], v[108:111], v[48:51]
    v_mfma_f32_16x16x32_bf16 v[68:71], v[108:111], a[200:203], v[68:71]
    v_mfma_f32_16x16x32_bf16 v[88:91], a[204:207], v[108:111], v[88:91]
    v_mfma_f32_16x16x32_bf16 v[28:31], a[192:195], v[108:111], v[28:31]
    s_waitcnt lgkmcnt(0)
    s_waitcnt vmcnt(9)
    v_mfma_f32_16x16x32_bf16 v[32:35], a[212:215], v[112:115], v[32:35]
    ds_read_b128 v[92:95], v5 offset:14336
    v_mfma_f32_16x16x32_bf16 v[52:55], v[112:115], a[216:219], v[52:55]
    buffer_load_dwordx4 a[0:3], v10, s[40:43], s59 offen offset:0
    v_mfma_f32_16x16x32_bf16 v[72:75], a[220:223], v[112:115], v[72:75]
    ds_read_b128 v[96:99], v5 offset:32768
    v_mfma_f32_16x16x32_bf16 v[36:39], a[212:215], v[116:119], v[36:39]
    v_mfma_f32_16x16x32_bf16 v[56:59], v[116:119], a[216:219], v[56:59]
    ds_read_b128 v[100:103], v6 offset:5120
    v_mfma_f32_16x16x32_bf16 v[76:79], a[220:223], v[116:119], v[76:79]
    buffer_load_dwordx4 a[4:7], v10, s[40:43], s59 offen offset:1024
    v_mfma_f32_16x16x32_bf16 v[16:19], a[208:211], v[116:119], v[16:19]
    ds_read_b128 v[104:107], v6 offset:23552
    v_mfma_f32_16x16x32_bf16 v[40:43], a[212:215], v[120:123], v[40:43]
    v_mfma_f32_16x16x32_bf16 v[60:63], v[120:123], a[216:219], v[60:63]
    ds_read_b128 v[108:111], v6 offset:41984
    v_mfma_f32_16x16x32_bf16 v[80:83], a[220:223], v[120:123], v[80:83]
    v_mfma_f32_16x16x32_bf16 v[20:23], a[208:211], v[120:123], v[20:23]
    buffer_load_dwordx4 a[8:11], v10, s[40:43], s59 offen offset:2048
    v_mfma_f32_16x16x32_bf16 v[44:47], a[212:215], v[124:127], v[44:47]
    v_mfma_f32_16x16x32_bf16 v[64:67], v[124:127], a[216:219], v[64:67]
    v_mfma_f32_16x16x32_bf16 v[84:87], a[220:223], v[124:127], v[84:87]
    v_mfma_f32_16x16x32_bf16 v[24:27], a[208:211], v[124:127], v[24:27]
    buffer_load_dwordx4 a[12:15], v12, s[40:43], s59 offen offset:512
    v_mfma_f32_16x16x32_bf16 v[48:51], a[212:215], v[128:131], v[48:51]
    v_mfma_f32_16x16x32_bf16 v[68:71], v[128:131], a[216:219], v[68:71]
    v_mfma_f32_16x16x32_bf16 v[88:91], a[220:223], v[128:131], v[88:91]
    v_mfma_f32_16x16x32_bf16 v[28:31], a[208:211], v[128:131], v[28:31]
    s_waitcnt vmcnt(12)
    s_barrier
    s_waitcnt lgkmcnt(0)
    s_waitcnt vmcnt(8)
    v_mfma_f32_16x16x32_bf16 v[32:35], a[228:231], v[92:95], v[32:35]
    ds_read_b128 v[112:115], v5 offset:15360
    v_mfma_f32_16x16x32_bf16 v[52:55], v[92:95], a[232:235], v[52:55]
    buffer_load_dwordx4 a[16:19], v11, s[40:43], s59 offen offset:0
    v_mfma_f32_16x16x32_bf16 v[72:75], a[236:239], v[92:95], v[72:75]
    ds_read_b128 v[116:119], v5 offset:33792
    v_mfma_f32_16x16x32_bf16 v[36:39], a[228:231], v[96:99], v[36:39]
    v_mfma_f32_16x16x32_bf16 v[56:59], v[96:99], a[232:235], v[56:59]
    ds_read_b128 v[120:123], v6 offset:6144
    v_mfma_f32_16x16x32_bf16 v[76:79], a[236:239], v[96:99], v[76:79]
    buffer_load_dwordx4 a[20:23], v11, s[40:43], s59 offen offset:1024
    v_mfma_f32_16x16x32_bf16 v[16:19], a[224:227], v[96:99], v[16:19]
    ds_read_b128 v[124:127], v6 offset:24576
    v_mfma_f32_16x16x32_bf16 v[40:43], a[228:231], v[100:103], v[40:43]
    v_mfma_f32_16x16x32_bf16 v[60:63], v[100:103], a[232:235], v[60:63]
    ds_read_b128 v[128:131], v6 offset:43008
    v_mfma_f32_16x16x32_bf16 v[80:83], a[236:239], v[100:103], v[80:83]
    v_mfma_f32_16x16x32_bf16 v[20:23], a[224:227], v[100:103], v[20:23]
    buffer_load_dwordx4 a[24:27], v11, s[40:43], s59 offen offset:2048
    v_mfma_f32_16x16x32_bf16 v[44:47], a[228:231], v[104:107], v[44:47]
    v_mfma_f32_16x16x32_bf16 v[64:67], v[104:107], a[232:235], v[64:67]
    v_mfma_f32_16x16x32_bf16 v[84:87], a[236:239], v[104:107], v[84:87]
    v_mfma_f32_16x16x32_bf16 v[24:27], a[224:227], v[104:107], v[24:27]
    buffer_load_dwordx4 a[28:31], v12, s[40:43], s59 offen offset:1024
    v_mfma_f32_16x16x32_bf16 v[48:51], a[228:231], v[108:111], v[48:51]
    v_mfma_f32_16x16x32_bf16 v[68:71], v[108:111], a[232:235], v[68:71]
    v_mfma_f32_16x16x32_bf16 v[88:91], a[236:239], v[108:111], v[88:91]
    v_mfma_f32_16x16x32_bf16 v[28:31], a[224:227], v[108:111], v[28:31]
    s_waitcnt lgkmcnt(0)
    s_waitcnt vmcnt(8)
    v_mfma_f32_16x16x32_bf16 v[32:35], a[244:247], v[112:115], v[32:35]
    ds_read_b128 v[92:95], v5 offset:16384
    v_mfma_f32_16x16x32_bf16 v[52:55], v[112:115], a[248:251], v[52:55]
    s_add_u32 m0, s13, 0
    s_add_u32 s15, s60, 0
    buffer_load_dwordx4 v2, s[40:43], s15 offen offset:0 lds
    v_mfma_f32_16x16x32_bf16 v[72:75], a[252:255], v[112:115], v[72:75]
    ds_read_b128 v[96:99], v5 offset:34816
    v_mfma_f32_16x16x32_bf16 v[36:39], a[244:247], v[116:119], v[36:39]
    s_add_u32 m0, s13, 0
    s_add_u32 s15, s60, 0
    buffer_load_dwordx4 v2, s[40:43], s15 offen offset:1024 lds
    v_mfma_f32_16x16x32_bf16 v[56:59], v[116:119], a[248:251], v[56:59]
    ds_read_b128 v[100:103], v6 offset:7168
    v_mfma_f32_16x16x32_bf16 v[76:79], a[252:255], v[116:119], v[76:79]
    v_mfma_f32_16x16x32_bf16 v[16:19], a[240:243], v[116:119], v[16:19]
    s_add_u32 m0, s13, 0
    s_add_u32 s15, s60, 0
    buffer_load_dwordx4 v2, s[40:43], s15 offen offset:2048 lds
    ds_read_b128 v[104:107], v6 offset:25600
    v_mfma_f32_16x16x32_bf16 v[40:43], a[244:247], v[120:123], v[40:43]
    v_mfma_f32_16x16x32_bf16 v[60:63], v[120:123], a[248:251], v[60:63]
    s_add_u32 m0, s13, 0
    s_add_u32 s15, s60, 0
    buffer_load_dwordx4 v2, s[40:43], s15 offen offset:3072 lds
    ds_read_b128 v[108:111], v6 offset:44032
    v_mfma_f32_16x16x32_bf16 v[80:83], a[252:255], v[120:123], v[80:83]
    v_mfma_f32_16x16x32_bf16 v[20:23], a[240:243], v[120:123], v[20:23]
    v_mfma_f32_16x16x32_bf16 v[44:47], a[244:247], v[124:127], v[44:47]
    s_add_u32 m0, s13, 4096
    s_add_u32 s15, s60, 4096
    buffer_load_dwordx4 v2, s[40:43], s15 offen offset:0 lds
    v_mfma_f32_16x16x32_bf16 v[64:67], v[124:127], a[248:251], v[64:67]
    v_mfma_f32_16x16x32_bf16 v[84:87], a[252:255], v[124:127], v[84:87]
    s_add_u32 m0, s13, 4096
    s_add_u32 s15, s60, 4096
    buffer_load_dwordx4 v2, s[40:43], s15 offen offset:1024 lds
    v_mfma_f32_16x16x32_bf16 v[24:27], a[240:243], v[124:127], v[24:27]
    v_mfma_f32_16x16x32_bf16 v[48:51], a[244:247], v[128:131], v[48:51]
    v_mfma_f32_16x16x32_bf16 v[68:71], v[128:131], a[248:251], v[68:71]
    s_add_u32 m0, s13, 4096
    s_add_u32 s15, s60, 4096
    buffer_load_dwordx4 v2, s[40:43], s15 offen offset:2048 lds
    v_mfma_f32_16x16x32_bf16 v[88:91], a[252:255], v[128:131], v[88:91]
    v_mfma_f32_16x16x32_bf16 v[28:31], a[240:243], v[128:131], v[28:31]
    s_waitcnt lgkmcnt(0)
    s_waitcnt vmcnt(11)
    v_mfma_f32_16x16x32_bf16 v[32:35], a[4:7], v[92:95], v[32:35]
    ds_read_b128 v[112:115], v5 offset:17408
    v_mfma_f32_16x16x32_bf16 v[52:55], v[92:95], a[8:11], v[52:55]
    s_add_u32 m0, s13, 4096
    s_add_u32 s15, s60, 4096
    buffer_load_dwordx4 v2, s[40:43], s15 offen offset:3072 lds
    v_mfma_f32_16x16x32_bf16 v[72:75], a[12:15], v[92:95], v[72:75]
    ds_read_b128 v[116:119], v5 offset:35840
    v_mfma_f32_16x16x32_bf16 v[36:39], a[4:7], v[96:99], v[36:39]
    s_add_u32 m0, s13, 8192
    s_add_u32 s15, s60, 8192
    buffer_load_dwordx4 v2, s[40:43], s15 offen offset:0 lds
    v_mfma_f32_16x16x32_bf16 v[56:59], v[96:99], a[8:11], v[56:59]
    ds_read_b128 v[120:123], v6 offset:8192
    v_mfma_f32_16x16x32_bf16 v[76:79], a[12:15], v[96:99], v[76:79]
    v_mfma_f32_16x16x32_bf16 v[16:19], a[0:3], v[96:99], v[16:19]
    s_add_u32 m0, s13, 8192
    s_add_u32 s15, s60, 8192
    buffer_load_dwordx4 v2, s[40:43], s15 offen offset:1024 lds
    ds_read_b128 v[124:127], v6 offset:26624
    v_mfma_f32_16x16x32_bf16 v[40:43], a[4:7], v[100:103], v[40:43]
    v_mfma_f32_16x16x32_bf16 v[60:63], v[100:103], a[8:11], v[60:63]
    s_add_u32 m0, s13, 8192
    s_add_u32 s15, s60, 8192
    buffer_load_dwordx4 v2, s[40:43], s15 offen offset:2048 lds
    ds_read_b128 v[128:131], v6 offset:45056
    v_mfma_f32_16x16x32_bf16 v[80:83], a[12:15], v[100:103], v[80:83]
    v_mfma_f32_16x16x32_bf16 v[20:23], a[0:3], v[100:103], v[20:23]
    v_mfma_f32_16x16x32_bf16 v[44:47], a[4:7], v[104:107], v[44:47]
    s_add_u32 m0, s13, 8192
    s_add_u32 s15, s60, 8192
    buffer_load_dwordx4 v2, s[40:43], s15 offen offset:3072 lds
    v_mfma_f32_16x16x32_bf16 v[64:67], v[104:107], a[8:11], v[64:67]
    v_mfma_f32_16x16x32_bf16 v[84:87], a[12:15], v[104:107], v[84:87]
    s_add_u32 m0, s14, 0
    s_add_u32 s15, s61, 0
    buffer_load_dwordx4 v2, s[40:43], s15 offen offset:0 lds
    v_mfma_f32_16x16x32_bf16 v[24:27], a[0:3], v[104:107], v[24:27]
    v_mfma_f32_16x16x32_bf16 v[48:51], a[4:7], v[108:111], v[48:51]
    v_mfma_f32_16x16x32_bf16 v[68:71], v[108:111], a[8:11], v[68:71]
    s_add_u32 m0, s14, 0
    s_add_u32 s15, s61, 0
    buffer_load_dwordx4 v2, s[40:43], s15 offen offset:1024 lds
    v_mfma_f32_16x16x32_bf16 v[88:91], a[12:15], v[108:111], v[88:91]
    v_mfma_f32_16x16x32_bf16 v[28:31], a[0:3], v[108:111], v[28:31]
    s_waitcnt lgkmcnt(0)
    s_waitcnt vmcnt(14)
    v_mfma_f32_16x16x32_bf16 v[32:35], a[20:23], v[112:115], v[32:35]
    v_mfma_f32_16x16x32_bf16 v[52:55], v[112:115], a[24:27], v[52:55]
    s_add_u32 m0, s14, 0
    s_add_u32 s15, s61, 0
    buffer_load_dwordx4 v2, s[40:43], s15 offen offset:2048 lds
    v_mfma_f32_16x16x32_bf16 v[72:75], a[28:31], v[112:115], v[72:75]
    v_mfma_f32_16x16x32_bf16 v[36:39], a[20:23], v[116:119], v[36:39]
    s_add_u32 m0, s14, 0
    s_add_u32 s15, s61, 0
    buffer_load_dwordx4 v2, s[40:43], s15 offen offset:3072 lds
    v_mfma_f32_16x16x32_bf16 v[56:59], v[116:119], a[24:27], v[56:59]
    v_mfma_f32_16x16x32_bf16 v[76:79], a[28:31], v[116:119], v[76:79]
    v_mfma_f32_16x16x32_bf16 v[16:19], a[16:19], v[116:119], v[16:19]
    s_add_u32 m0, s14, 4096
    s_add_u32 s15, s61, 4096
    buffer_load_dwordx4 v2, s[40:43], s15 offen offset:0 lds
    v_mfma_f32_16x16x32_bf16 v[40:43], a[20:23], v[120:123], v[40:43]
    v_mfma_f32_16x16x32_bf16 v[60:63], v[120:123], a[24:27], v[60:63]
    s_add_u32 m0, s14, 4096
    s_add_u32 s15, s61, 4096
    buffer_load_dwordx4 v2, s[40:43], s15 offen offset:1024 lds
    v_mfma_f32_16x16x32_bf16 v[80:83], a[28:31], v[120:123], v[80:83]
    v_mfma_f32_16x16x32_bf16 v[20:23], a[16:19], v[120:123], v[20:23]
    v_mfma_f32_16x16x32_bf16 v[44:47], a[20:23], v[124:127], v[44:47]
    s_add_u32 m0, s14, 4096
    s_add_u32 s15, s61, 4096
    buffer_load_dwordx4 v2, s[40:43], s15 offen offset:2048 lds
    v_mfma_f32_16x16x32_bf16 v[64:67], v[124:127], a[24:27], v[64:67]
    v_mfma_f32_16x16x32_bf16 v[84:87], a[28:31], v[124:127], v[84:87]
    s_add_u32 m0, s14, 4096
    s_add_u32 s15, s61, 4096
    buffer_load_dwordx4 v2, s[40:43], s15 offen offset:3072 lds
    v_mfma_f32_16x16x32_bf16 v[24:27], a[16:19], v[124:127], v[24:27]
    v_mfma_f32_16x16x32_bf16 v[48:51], a[20:23], v[128:131], v[48:51]
    v_mfma_f32_16x16x32_bf16 v[68:71], v[128:131], a[24:27], v[68:71]
    s_add_u32 m0, s14, 8192
    s_add_u32 s15, s61, 8192
    buffer_load_dwordx4 v2, s[40:43], s15 offen offset:0 lds
    v_mfma_f32_16x16x32_bf16 v[88:91], a[28:31], v[128:131], v[88:91]
    v_mfma_f32_16x16x32_bf16 v[28:31], a[16:19], v[128:131], v[28:31]
    s_branch K1_attn
K1_second:
    s_add_u32 m0, s10, 0
    s_nop 0
    buffer_load_dwordx4 v7, s[40:43], s48 offen offset:0 sc1 lds
    s_add_u32 m0, s10, 0
    s_nop 0
    buffer_load_dwordx4 v7, s[40:43], s48 offen offset:1024 sc1 lds
    s_add_u32 m0, s10, 0
    s_nop 0
    buffer_load_dwordx4 v7, s[40:43], s48 offen offset:2048 sc1 lds
    s_add_u32 m0, s11, 0
    s_nop 0
    buffer_load_dwordx4 v8, s[40:43], s48 offen sc1 lds
    s_add_u32 m0, s10, 3072
    s_nop 0
    buffer_load_dwordx4 v7, s[40:43], s49 offen offset:0 sc1 lds
    s_add_u32 m0, s10, 3072
    s_nop 0
    buffer_load_dwordx4 v7, s[40:43], s49 offen offset:1024 sc1 lds
    s_add_u32 m0, s10, 3072
    s_nop 0
    buffer_load_dwordx4 v7, s[40:43], s49 offen offset:2048 sc1 lds
    s_add_u32 m0, s11, 3072
    s_nop 0
    buffer_load_dwordx4 v8, s[40:43], s49 offen sc1 lds
    s_add_u32 m0, s10, 6144
    s_nop 0
    buffer_load_dwordx4 v7, s[40:43], s50 offen offset:0 sc1 lds
    s_add_u32 m0, s10, 6144
    s_nop 0
    buffer_load_dwordx4 v7, s[40:43], s50 offen offset:1024 sc1 lds
    s_add_u32 m0, s10, 6144
    s_nop 0
    buffer_load_dwordx4 v7, s[40:43], s50 offen offset:2048 sc1 lds
    s_add_u32 m0, s11, 6144
    s_nop 0
    buffer_load_dwordx4 v8, s[40:43], s50 offen sc1 lds
    s_waitcnt vmcnt(8)
    s_barrier
    ds_read_b128 v[92:95], v5 offset:0
    ds_read_b128 v[96:99], v5 offset:18432
    ds_read_b128 v[100:103], v5 offset:36864
    ds_read_b128 v[104:107], v6 offset:9216
    ds_read_b128 v[108:111], v6 offset:27648
    s_waitcnt lgkmcnt(0)
    v_mfma_f32_16x16x32_bf16 v[32:35], a[4:7], v[92:95], 0
    ds_read_b128 v[112:115], v5 offset:1024
    v_mfma_f32_16x16x32_bf16 v[52:55], v[92:95], a[8:11], 0
    s_add_u32 m0, s10, 9216
    s_nop 0
    buffer_load_dwordx4 v7, s[40:43], s51 offen offset:0 sc1 lds
    v_mfma_f32_16x16x32_bf16 v[72:75], a[12:15], v[92:95], 0
    ds_read_b128 v[116:119], v5 offset:19456
    v_mfma_f32_16x16x32_bf16 v[36:39], a[4:7], v[96:99], 0
    v_mfma_f32_16x16x32_bf16 v[56:59], v[96:99], a[8:11], 0
    ds_read_b128 v[120:123], v5 offset:37888
    v_mfma_f32_16x16x32_bf16 v[76:79], a[12:15], v[96:99], 0
    v_mfma_f32_16x16x32_bf16 v[16:19], a[0:3], v[96:99], 0
    ds_read_b128 v[124:127], v6 offset:10240
    v_mfma_f32_16x16x32_bf16 v[40:43], a[4:7], v[100:103], 0
    v_mfma_f32_16x16x32_bf16 v[60:63], v[100:103], a[8:11], 0
    ds_read_b128 v[128:131], v6 offset:28672
    v_mfma_f32_16x16x32_bf16 v[80:83], a[12:15], v[100:103], 0
    v_mfma_f32_16x16x32_bf16 v[20:23], a[0:3], v[100:103], 0
    s_add_u32 m0, s11, 9216
    s_nop 0
    buffer_load_dwordx4 v8, s[40:43], s51 offen sc1 lds
    v_mfma_f32_16x16x32_bf16 v[44:47], a[4:7], v[104:107], 0
    v_mfma_f32_16x16x32_bf16 v[64:67], v[104:107], a[8:11], 0
    v_mfma_f32_16x16x32_bf16 v[84:87], a[12:15], v[104:107], 0
    v_mfma_f32_16x16x32_bf16 v[24:27], a[0:3], v[104:107], 0
    v_mfma_f32_16x16x32_bf16 v[48:51], a[4:7], v[108:111], 0
    v_mfma_f32_16x16x32_bf16 v[68:71], v[108:111], a[8:11], 0
    v_mfma_f32_16x16x32_bf16 v[88:91], a[12:15], v[108:111], 0
    v_mfma_f32_16x16x32_bf16 v[28:31], a[0:3], v[108:111], 0
    s_waitcnt lgkmcnt(0)
    v_mfma_f32_16x16x32_bf16 v[32:35], a[20:23], v[112:115], v[32:35]
    ds_read_b128 v[92:95], v5 offset:2048
    v_mfma_f32_16x16x32_bf16 v[52:55], v[112:115], a[24:27], v[52:55]
    s_add_u32 m0, s10, 9216
    s_nop 0
    buffer_load_dwordx4 v7, s[40:43], s51 offen offset:1024 sc1 lds
    v_mfma_f32_16x16x32_bf16 v[72:75], a[28:31], v[112:115], v[72:75]
    ds_read_b128 v[96:99], v5 offset:20480
    v_mfma_f32_16x16x32_bf16 v[36:39], a[20:23], v[116:119], v[36:39]
    v_mfma_f32_16x16x32_bf16 v[56:59], v[116:119], a[24:27], v[56:59]
    buffer_load_dwordx4 a[144:147], v9, s[40:43], s57 offen offset:0
    ds_read_b128 v[100:103], v5 offset:38912
    v_mfma_f32_16x16x32_bf16 v[76:79], a[28:31], v[116:119], v[76:79]
    v_mfma_f32_16x16x32_bf16 v[16:19], a[16:19], v[116:119], v[16:19]
    ds_read_b128 v[104:107], v6 offset:11264
    v_mfma_f32_16x16x32_bf16 v[40:43], a[20:23], v[120:123], v[40:43]
    v_mfma_f32_16x16x32_bf16 v[60:63], v[120:123], a[24:27], v[60:63]
    buffer_load_dwordx4 a[148:151], v9, s[40:43], s57 offen offset:1024
    ds_read_b128 v[108:111], v6 offset:29696
    v_mfma_f32_16x16x32_bf16 v[80:83], a[28:31], v[120:123], v[80:83]
    v_mfma_f32_16x16x32_bf16 v[20:23], a[16:19], v[120:123], v[20:23]
    v_mfma_f32_16x16x32_bf16 v[44:47], a[20:23], v[124:127], v[44:47]
    buffer_load_dwordx4 a[152:155], v9, s[40:43], s57 offen offset:2048
    v_mfma_f32_16x16x32_bf16 v[64:67], v[124:127], a[24:27], v[64:67]
    v_mfma_f32_16x16x32_bf16 v[84:87], a[28:31], v[124:127], v[84:87]
    v_mfma_f32_16x16x32_bf16 v[24:27], a[16:19], v[124:127], v[24:27]
    v_mfma_f32_16x16x32_bf16 v[48:51], a[20:23], v[128:131], v[48:51]
    buffer_load_dwordx4 a[156:159], v12, s[40:43], s57 offen offset:0
    v_mfma_f32_16x16x32_bf16 v[68:71], v[128:131], a[24:27], v[68:71]
    v_mfma_f32_16x16x32_bf16 v[88:91], a[28:31], v[128:131], v[88:91]
    v_mfma_f32_16x16x32_bf16 v[28:31], a[16:19], v[128:131], v[28:31]
    s_waitcnt vmcnt(11)
    s_barrier
    s_waitcnt lgkmcnt(0)
    v_mfma_f32_16x16x32_bf16 v[32:35], a[36:39], v[92:95], v[32:35]
    ds_read_b128 v[112:115], v5 offset:3072
    v_mfma_f32_16x16x32_bf16 v[52:55], v[92:95], a[40:43], v[52:55]
    s_add_u32 m0, s10, 9216
    s_nop 0
    buffer_load_dwordx4 v7, s[40:43], s51 offen offset:2048 sc1 lds
    v_mfma_f32_16x16x32_bf16 v[72:75], a[44:47], v[92:95], v[72:75]
    ds_read_b128 v[116:119], v5 offset:21504
    v_mfma_f32_16x16x32_bf16 v[36:39], a[36:39], v[96:99], v[36:39]
    v_mfma_f32_16x16x32_bf16 v[56:59], v[96:99], a[40:43], v[56:59]
    buffer_load_dwordx4 a[160:163], v10, s[40:43], s57 offen offset:0
    ds_read_b128 v[120:123], v5 offset:39936
    v_mfma_f32_16x16x32_bf16 v[76:79], a[44:47], v[96:99], v[76:79]
    v_mfma_f32_16x16x32_bf16 v[16:19], a[32:35], v[96:99], v[16:19]
    ds_read_b128 v[124:127], v6 offset:12288
    v_mfma_f32_16x16x32_bf16 v[40:43], a[36:39], v[100:103], v[40:43]
    v_mfma_f32_16x16x32_bf16 v[60:63], v[100:103], a[40:43], v[60:63]
    buffer_load_dwordx4 a[164:167], v10, s[40:43], s57 offen offset:1024
    ds_read_b128 v[128:131], v6 offset:30720
    v_mfma_f32_16x16x32_bf16 v[80:83], a[44:47], v[100:103], v[80:83]
    v_mfma_f32_16x16x32_bf16 v[20:23], a[32:35], v[100:103], v[20:23]
    v_mfma_f32_16x16x32_bf16 v[44:47], a[36:39], v[104:107], v[44:47]
    buffer_load_dwordx4 a[168:171], v10, s[40:43], s57 offen offset:2048
    v_mfma_f32_16x16x32_bf16 v[64:67], v[104:107], a[40:43], v[64:67]
    v_mfma_f32_16x16x32_bf16 v[84:87], a[44:47], v[104:107], v[84:87]
    v_mfma_f32_16x16x32_bf16 v[24:27], a[32:35], v[104:107], v[24:27]
    v_mfma_f32_16x16x32_bf16 v[48:51], a[36:39], v[108:111], v[48:51]
    buffer_load_dwordx4 a[172:175], v12, s[40:43], s57 offen offset:512
    v_mfma_f32_16x16x32_bf16 v[68:71], v[108:111], a[40:43], v[68:71]
    v_mfma_f32_16x16x32_bf16 v[88:91], a[44:47], v[108:111], v[88:91]
    v_mfma_f32_16x16x32_bf16 v[28:31], a[32:35], v[108:111], v[28:31]
    s_waitcnt lgkmcnt(0)
    v_mfma_f32_16x16x32_bf16 v[32:35], a[52:55], v[112:115], v[32:35]
    ds_read_b128 v[92:95], v5 offset:4096
    v_mfma_f32_16x16x32_bf16 v[52:55], v[112:115], a[56:59], v[52:55]
    s_add_u32 m0, s10, 12288
    s_nop 0
    buffer_load_dwordx4 v7, s[40:43], s52 offen offset:0 sc1 lds
    v_mfma_f32_16x16x32_bf16 v[72:75], a[60:63], v[112:115], v[72:75]
    ds_read_b128 v[96:99], v5 offset:22528
    v_mfma_f32_16x16x32_bf16 v[36:39], a[52:55], v[116:119], v[36:39]
    v_mfma_f32_16x16x32_bf16 v[56:59], v[116:119], a[56:59], v[56:59]
    s_add_u32 m0, s11, 12288
    s_nop 0
    buffer_load_dwordx4 v8, s[40:43], s52 offen sc1 lds
    ds_read_b128 v[100:103], v5 offset:40960
    v_mfma_f32_16x16x32_bf16 v[76:79], a[60:63], v[116:119], v[76:79]
    v_mfma_f32_16x16x32_bf16 v[16:19], a[48:51], v[116:119], v[16:19]
    ds_read_b128 v[104:107], v6 offset:13312
    v_mfma_f32_16x16x32_bf16 v[40:43], a[52:55], v[120:123], v[40:43]
    buffer_load_dwordx4 a[176:179], v11, s[40:43], s57 offen offset:0
    v_mfma_f32_16x16x32_bf16 v[60:63], v[120:123], a[56:59], v[60:63]
    ds_read_b128 v[108:111], v6 offset:31744
    v_mfma_f32_16x16x32_bf16 v[80:83], a[60:63], v[120:123], v[80:83]
    v_mfma_f32_16x16x32_bf16 v[20:23], a[48:51], v[120:123], v[20:23]
    buffer_load_dwordx4 a[180:183], v11, s[40:43], s57 offen offset:1024
    v_mfma_f32_16x16x32_bf16 v[44:47], a[52:55], v[124:127], v[44:47]
    v_mfma_f32_16x16x32_bf16 v[64:67], v[124:127], a[56:59], v[64:67]
    v_mfma_f32_16x16x32_bf16 v[84:87], a[60:63], v[124:127], v[84:87]
    buffer_load_dwordx4 a[184:187], v11, s[40:43], s57 offen offset:2048
    v_mfma_f32_16x16x32_bf16 v[24:27], a[48:51], v[124:127], v[24:27]
    v_mfma_f32_16x16x32_bf16 v[48:51], a[52:55], v[128:131], v[48:51]
    v_mfma_f32_16x16x32_bf16 v[68:71], v[128:131], a[56:59], v[68:71]
    buffer_load_dwordx4 a[188:191], v12, s[40:43], s57 offen offset:1024
    v_mfma_f32_16x16x32_bf16 v[88:91], a[60:63], v[128:131], v[88:91]
    v_mfma_f32_16x16x32_bf16 v[28:31], a[48:51], v[128:131], v[28:31]
    s_waitcnt lgkmcnt(0)
    v_mfma_f32_16x16x32_bf16 v[32:35], a[68:71], v[92:95], v[32:35]
    ds_read_b128 v[112:115], v5 offset:5120
    v_mfma_f32_16x16x32_bf16 v[52:55], v[92:95], a[72:75], v[52:55]
    s_add_u32 m0, s10, 12288
    s_nop 0
    buffer_load_dwordx4 v7, s[40:43], s52 offen offset:1024 sc1 lds
    v_mfma_f32_16x16x32_bf16 v[72:75], a[76:79], v[92:95], v[72:75]
    ds_read_b128 v[116:119], v5 offset:23552
    v_mfma_f32_16x16x32_bf16 v[36:39], a[68:71], v[96:99], v[36:39]
    v_mfma_f32_16x16x32_bf16 v[56:59], v[96:99], a[72:75], v[56:59]
    buffer_load_dwordx4 a[192:195], v9, s[40:43], s58 offen offset:0
    ds_read_b128 v[120:123], v5 offset:41984
    v_mfma_f32_16x16x32_bf16 v[76:79], a[76:79], v[96:99], v[76:79]
    v_mfma_f32_16x16x32_bf16 v[16:19], a[64:67], v[96:99], v[16:19]
    ds_read_b128 v[124:127], v6 offset:14336
    v_mfma_f32_16x16x32_bf16 v[40:43], a[68:71], v[100:103], v[40:43]
    v_mfma_f32_16x16x32_bf16 v[60:63], v[100:103], a[72:75], v[60:63]
    buffer_load_dwordx4 a[196:199], v9, s[40:43], s58 offen offset:1024
    ds_read_b128 v[128:131], v6 offset:32768
    v_mfma_f32_16x16x32_bf16 v[80:83], a[76:79], v[100:103], v[80:83]
    v_mfma_f32_16x16x32_bf16 v[20:23], a[64:67], v[100:103], v[20:23]
    v_mfma_f32_16x16x32_bf16 v[44:47], a[68:71], v[104:107], v[44:47]
    buffer_load_dwordx4 a[200:203], v9, s[40:43], s58 offen offset:2048
    v_mfma_f32_16x16x32_bf16 v[64:67], v[104:107], a[72:75], v[64:67]
    v_mfma_f32_16x16x32_bf16 v[84:87], a[76:79], v[104:107], v[84:87]
    v_mfma_f32_16x16x32_bf16 v[24:27], a[64:67], v[104:107], v[24:27]
    v_mfma_f32_16x16x32_bf16 v[48:51], a[68:71], v[108:111], v[48:51]
    buffer_load_dwordx4 a[204:207], v12, s[40:43], s58 offen offset:0
    v_mfma_f32_16x16x32_bf16 v[68:71], v[108:111], a[72:75], v[68:71]
    v_mfma_f32_16x16x32_bf16 v[88:91], a[76:79], v[108:111], v[88:91]
    v_mfma_f32_16x16x32_bf16 v[28:31], a[64:67], v[108:111], v[28:31]
    s_waitcnt vmcnt(23)
    s_barrier
    s_waitcnt lgkmcnt(0)
    v_mfma_f32_16x16x32_bf16 v[32:35], a[84:87], v[112:115], v[32:35]
    ds_read_b128 v[92:95], v5 offset:6144
    v_mfma_f32_16x16x32_bf16 v[52:55], v[112:115], a[88:91], v[52:55]
    s_add_u32 m0, s10, 12288
    s_nop 0
    buffer_load_dwordx4 v7, s[40:43], s52 offen offset:2048 sc1 lds
    v_mfma_f32_16x16x32_bf16 v[72:75], a[92:95], v[112:115], v[72:75]
    ds_read_b128 v[96:99], v5 offset:24576
    v_mfma_f32_16x16x32_bf16 v[36:39], a[84:87], v[116:119], v[36:39]
    v_mfma_f32_16x16x32_bf16 v[56:59], v[116:119], a[88:91], v[56:59]
    buffer_load_dwordx4 a[208:211], v10, s[40:43], s58 offen offset:0
    ds_read_b128 v[100:103], v5 offset:43008
    v_mfma_f32_16x16x32_bf16 v[76:79], a[92:95], v[116:119], v[76:79]
    v_mfma_f32_16x16x32_bf16 v[16:19], a[80:83], v[116:119], v[16:19]
    ds_read_b128 v[104:107], v6 offset:15360
    v_mfma_f32_16x16x32_bf16 v[40:43], a[84:87], v[120:123], v[40:43]
    v_mfma_f32_16x16x32_bf16 v[60:63], v[120:123], a[88:91], v[60:63]
    buffer_load_dwordx4 a[212:215], v10, s[40:43], s58 offen offset:1024
    ds_read_b128 v[108:111], v6 offset:33792
    v_mfma_f32_16x16x32_bf16 v[80:83], a[92:95], v[120:123], v[80:83]
    v_mfma_f32_16x16x32_bf16 v[20:23], a[80:83], v[120:123], v[20:23]
    v_mfma_f32_16x16x32_bf16 v[44:47], a[84:87], v[124:127], v[44:47]
    buffer_load_dwordx4 a[216:219], v10, s[40:43], s58 offen offset:2048
    v_mfma_f32_16x16x32_bf16 v[64:67], v[124:127], a[88:91], v[64:67]
    v_mfma_f32_16x16x32_bf16 v[84:87], a[92:95], v[124:127], v[84:87]
    v_mfma_f32_16x16x32_bf16 v[24:27], a[80:83], v[124:127], v[24:27]
    v_mfma_f32_16x16x32_bf16 v[48:51], a[84:87], v[128:131], v[48:51]
    buffer_load_dwordx4 a[220:223], v12, s[40:43], s58 offen offset:512
    v_mfma_f32_16x16x32_bf16 v[68:71], v[128:131], a[88:91], v[68:71]
    v_mfma_f32_16x16x32_bf16 v[88:91], a[92:95], v[128:131], v[88:91]
    v_mfma_f32_16x16x32_bf16 v[28:31], a[80:83], v[128:131], v[28:31]
    s_waitcnt lgkmcnt(0)
    v_mfma_f32_16x16x32_bf16 v[32:35], a[100:103], v[92:95], v[32:35]
    ds_read_b128 v[112:115], v5 offset:7168
    v_mfma_f32_16x16x32_bf16 v[52:55], v[92:95], a[104:107], v[52:55]
    s_add_u32 m0, s10, 15360
    s_nop 0
    buffer_load_dwordx4 v7, s[40:43], s53 offen offset:0 sc1 lds
    v_mfma_f32_16x16x32_bf16 v[72:75], a[108:111], v[92:95], v[72:75]
    ds_read_b128 v[116:119], v5 offset:25600
    v_mfma_f32_16x16x32_bf16 v[36:39], a[100:103], v[96:99], v[36:39]
    v_mfma_f32_16x16x32_bf16 v[56:59], v[96:99], a[104:107], v[56:59]
    s_add_u32 m0, s11, 15360
    s_nop 0
    buffer_load_dwordx4 v8, s[40:43], s53 offen sc1 lds
    ds_read_b128 v[120:123], v5 offset:44032
    v_mfma_f32_16x16x32_bf16 v[76:79], a[108:111], v[96:99], v[76:79]
    v_mfma_f32_16x16x32_bf16 v[16:19], a[96:99], v[96:99], v[16:19]
    ds_read_b128 v[124:127], v6 offset:16384
    v_mfma_f32_16x16x32_bf16 v[40:43], a[100:103], v[100:103], v[40:43]
    buffer_load_dwordx4 a[224:227], v11, s[40:43], s58 offen offset:0
    v_mfma_f32_16x16x32_bf16 v[60:63], v[100:103], a[104:107], v[60:63]
    ds_read_b128 v[128:131], v6 offset:34816
    v_mfma_f32_16x16x32_bf16 v[80:83], a[108:111], v[100:103], v[80:83]
    v_mfma_f32_16x16x32_bf16 v[20:23], a[96:99], v[100:103], v[20:23]
    buffer_load_dwordx4 a[228:231], v11, s[40:43], s58 offen offset:1024
    v_mfma_f32_16x16x32_bf16 v[44:47], a[100:103], v[104:107], v[44:47]
    v_mfma_f32_16x16x32_bf16 v[64:67], v[104:107], a[104:107], v[64:67]
    v_mfma_f32_16x16x32_bf16 v[84:87], a[108:111], v[104:107], v[84:87]
    buffer_load_dwordx4 a[232:235], v11, s[40:43], s58 offen offset:2048
    v_mfma_f32_16x16x32_bf16 v[24:27], a[96:99], v[104:107], v[24:27]
    v_mfma_f32_16x16x32_bf16 v[48:51], a[100:103], v[108:111], v[48:51]
    v_mfma_f32_16x16x32_bf16 v[68:71], v[108:111], a[104:107], v[68:71]
    buffer_load_dwordx4 a[236:239], v12, s[40:43], s58 offen offset:1024
    v_mfma_f32_16x16x32_bf16 v[88:91], a[108:111], v[108:111], v[88:91]
    v_mfma_f32_16x16x32_bf16 v[28:31], a[96:99], v[108:111], v[28:31]
    s_waitcnt lgkmcnt(0)
    v_mfma_f32_16x16x32_bf16 v[32:35], a[116:119], v[112:115], v[32:35]
    ds_read_b128 v[92:95], v5 offset:8192
    v_mfma_f32_16x16x32_bf16 v[52:55], v[112:115], a[120:123], v[52:55]
    s_add_u32 m0, s10, 15360
    s_nop 0
    buffer_load_dwordx4 v7, s[40:43], s53 offen offset:1024 sc1 lds
    v_mfma_f32_16x16x32_bf16 v[72:75], a[124:127], v[112:115], v[72:75]
    ds_read_b128 v[96:99], v5 offset:26624
    v_mfma_f32_16x16x32_bf16 v[36:39], a[116:119], v[116:119], v[36:39]
    v_mfma_f32_16x16x32_bf16 v[56:59], v[116:119], a[120:123], v[56:59]
    buffer_load_dwordx4 a[240:243], v9, s[40:43], s59 offen offset:0
    ds_read_b128 v[100:103], v5 offset:45056
    v_mfma_f32_16x16x32_bf16 v[76:79], a[124:127], v[116:119], v[76:79]
    v_mfma_f32_16x16x32_bf16 v[16:19], a[112:115], v[116:119], v[16:19]
    ds_read_b128 v[104:107], v6 offset:17408
    v_mfma_f32_16x16x32_bf16 v[40:43], a[116:119], v[120:123], v[40:43]
    v_mfma_f32_16x16x32_bf16 v[60:63], v[120:123], a[120:123], v[60:63]
    buffer_load_dwordx4 a[244:247], v9, s[40:43], s59 offen offset:1024
    ds_read_b128 v[108:111], v6 offset:35840
    v_mfma_f32_16x16x32_bf16 v[80:83], a[124:127], v[120:123], v[80:83]
    v_mfma_f32_16x16x32_bf16 v[20:23], a[112:115], v[120:123], v[20:23]
    v_mfma_f32_16x16x32_bf16 v[44:47], a[116:119], v[124:127], v[44:47]
    buffer_load_dwordx4 a[248:251], v9, s[40:43], s59 offen offset:2048
    v_mfma_f32_16x16x32_bf16 v[64:67], v[124:127], a[120:123], v[64:67]
    v_mfma_f32_16x16x32_bf16 v[84:87], a[124:127], v[124:127], v[84:87]
    v_mfma_f32_16x16x32_bf16 v[24:27], a[112:115], v[124:127], v[24:27]
    v_mfma_f32_16x16x32_bf16 v[48:51], a[116:119], v[128:131], v[48:51]
    buffer_load_dwordx4 a[252:255], v12, s[40:43], s59 offen offset:0
    v_mfma_f32_16x16x32_bf16 v[68:71], v[128:131], a[120:123], v[68:71]
    v_mfma_f32_16x16x32_bf16 v[88:91], a[124:127], v[128:131], v[88:91]
    v_mfma_f32_16x16x32_bf16 v[28:31], a[112:115], v[128:131], v[28:31]
    s_waitcnt vmcnt(31)
    s_barrier
    s_waitcnt lgkmcnt(0)
    v_mfma_f32_16x16x32_bf16 v[32:35], a[132:135], v[92:95], v[32:35]
    ds_read_b128 v[112:115], v5 offset:9216
    v_mfma_f32_16x16x32_bf16 v[52:55], v[92:95], a[136:139], v[52:55]
    s_add_u32 m0, s10, 15360
    s_nop 0
    buffer_load_dwordx4 v7, s[40:43], s53 offen offset:2048 sc1 lds
    v_mfma_f32_16x16x32_bf16 v[72:75], a[140:143], v[92:95], v[72:75]
    ds_read_b128 v[116:119], v5 offset:27648
    v_mfma_f32_16x16x32_bf16 v[36:39], a[132:135], v[96:99], v[36:39]
    v_mfma_f32_16x16x32_bf16 v[56:59], v[96:99], a[136:139], v[56:59]
    buffer_load_dwordx4 a[0:3], v10, s[40:43], s59 offen offset:0
    ds_read_b128 v[120:123], v6 offset:0
    v_mfma_f32_16x16x32_bf16 v[76:79], a[140:143], v[96:99], v[76:79]
    v_mfma_f32_16x16x32_bf16 v[16:19], a[128:131], v[96:99], v[16:19]
    ds_read_b128 v[124:127], v6 offset:18432
    v_mfma_f32_16x16x32_bf16 v[40:43], a[132:135], v[100:103], v[40:43]
    v_mfma_f32_16x16x32_bf16 v[60:63], v[100:103], a[136:139], v[60:63]
    buffer_load_dwordx4 a[4:7], v10, s[40:43], s59 offen offset:1024
    ds_read_b128 v[128:131], v6 offset:36864
    v_mfma_f32_16x16x32_bf16 v[80:83], a[140:143], v[100:103], v[80:83]
    v_mfma_f32_16x16x32_bf16 v[20:23], a[128:131], v[100:103], v[20:23]
    v_mfma_f32_16x16x32_bf16 v[44:47], a[132:135], v[104:107], v[44:47]
    buffer_load_dwordx4 a[8:11], v10, s[40:43], s59 offen offset:2048
    v_mfma_f32_16x16x32_bf16 v[64:67], v[104:107], a[136:139], v[64:67]
    v_mfma_f32_16x16x32_bf16 v[84:87], a[140:143], v[104:107], v[84:87]
    v_mfma_f32_16x16x32_bf16 v[24:27], a[128:131], v[104:107], v[24:27]
    v_mfma_f32_16x16x32_bf16 v[48:51], a[132:135], v[108:111], v[48:51]
    buffer_load_dwordx4 a[12:15], v12, s[40:43], s59 offen offset:512
    v_mfma_f32_16x16x32_bf16 v[68:71], v[108:111], a[136:139], v[68:71]
    v_mfma_f32_16x16x32_bf16 v[88:91], a[140:143], v[108:111], v[88:91]
    v_mfma_f32_16x16x32_bf16 v[28:31], a[128:131], v[108:111], v[28:31]
    s_waitcnt lgkmcnt(0)
    v_mfma_f32_16x16x32_bf16 v[32:35], a[148:151], v[112:115], v[32:35]
    ds_read_b128 v[92:95], v5 offset:10240
    v_mfma_f32_16x16x32_bf16 v[52:55], v[112:115], a[152:155], v[52:55]
    buffer_load_dwordx4 a[16:19], v11, s[40:43], s59 offen offset:0
    v_mfma_f32_16x16x32_bf16 v[72:75], a[156:159], v[112:115], v[72:75]
    ds_read_b128 v[96:99], v5 offset:28672
    v_mfma_f32_16x16x32_bf16 v[36:39], a[148:151], v[116:119], v[36:39]
    v_mfma_f32_16x16x32_bf16 v[56:59], v[116:119], a[152:155], v[56:59]
    ds_read_b128 v[100:103], v6 offset:1024
    v_mfma_f32_16x16x32_bf16 v[76:79], a[156:159], v[116:119], v[76:79]
    buffer_load_dwordx4 a[20:23], v11, s[40:43], s59 offen offset:1024
    v_mfma_f32_16x16x32_bf16 v[16:19], a[144:147], v[116:119], v[16:19]
    ds_read_b128 v[104:107], v6 offset:19456
    v_mfma_f32_16x16x32_bf16 v[40:43], a[148:151], v[120:123], v[40:43]
    v_mfma_f32_16x16x32_bf16 v[60:63], v[120:123], a[152:155], v[60:63]
    ds_read_b128 v[108:111], v6 offset:37888
    v_mfma_f32_16x16x32_bf16 v[80:83], a[156:159], v[120:123], v[80:83]
    v_mfma_f32_16x16x32_bf16 v[20:23], a[144:147], v[120:123], v[20:23]
    buffer_load_dwordx4 a[24:27], v11, s[40:43], s59 offen offset:2048
    v_mfma_f32_16x16x32_bf16 v[44:47], a[148:151], v[124:127], v[44:47]
    v_mfma_f32_16x16x32_bf16 v[64:67], v[124:127], a[152:155], v[64:67]
    v_mfma_f32_16x16x32_bf16 v[84:87], a[156:159], v[124:127], v[84:87]
    v_mfma_f32_16x16x32_bf16 v[24:27], a[144:147], v[124:127], v[24:27]
    buffer_load_dwordx4 a[28:31], v12, s[40:43], s59 offen offset:1024
    v_mfma_f32_16x16x32_bf16 v[48:51], a[148:151], v[128:131], v[48:51]
    v_mfma_f32_16x16x32_bf16 v[68:71], v[128:131], a[152:155], v[68:71]
    v_mfma_f32_16x16x32_bf16 v[88:91], a[156:159], v[128:131], v[88:91]
    v_mfma_f32_16x16x32_bf16 v[28:31], a[144:147], v[128:131], v[28:31]
    s_waitcnt lgkmcnt(0)
    s_waitcnt vmcnt(36)
    v_mfma_f32_16x16x32_bf16 v[32:35], a[164:167], v[92:95], v[32:35]
    ds_read_b128 v[112:115], v5 offset:11264
    v_mfma_f32_16x16x32_bf16 v[52:55], v[92:95], a[168:171], v[52:55]
    v_mfma_f32_16x16x32_bf16 v[72:75], a[172:175], v[92:95], v[72:75]
    ds_read_b128 v[116:119], v5 offset:29696
    v_mfma_f32_16x16x32_bf16 v[36:39], a[164:167], v[96:99], v[36:39]
    v_mfma_f32_16x16x32_bf16 v[56:59], v[96:99], a[168:171], v[56:59]
    ds_read_b128 v[120:123], v6 offset:2048
    v_mfma_f32_16x16x32_bf16 v[76:79], a[172:175], v[96:99], v[76:79]
    v_mfma_f32_16x16x32_bf16 v[16:19], a[160:163], v[96:99], v[16:19]
    ds_read_b128 v[124:127], v6 offset:20480
    v_mfma_f32_16x16x32_bf16 v[40:43], a[164:167], v[100:103], v[40:43]
    v_mfma_f32_16x16x32_bf16 v[60:63], v[100:103], a[168:171], v[60:63]
    ds_read_b128 v[128:131], v6 offset:38912
    v_mfma_f32_16x16x32_bf16 v[80:83], a[172:175], v[100:103], v[80:83]
    v_mfma_f32_16x16x32_bf16 v[20:23], a[160:163], v[100:103], v[20:23]
    v_mfma_f32_16x16x32_bf16 v[44:47], a[164:167], v[104:107], v[44:47]
    v_mfma_f32_16x16x32_bf16 v[64:67], v[104:107], a[168:171], v[64:67]
    v_mfma_f32_16x16x32_bf16 v[84:87], a[172:175], v[104:107], v[84:87]
    v_mfma_f32_16x16x32_bf16 v[24:27], a[160:163], v[104:107], v[24:27]
    v_mfma_f32_16x16x32_bf16 v[48:51], a[164:167], v[108:111], v[48:51]
    v_mfma_f32_16x16x32_bf16 v[68:71], v[108:111], a[168:171], v[68:71]
    v_mfma_f32_16x16x32_bf16 v[88:91], a[172:175], v[108:111], v[88:91]
    v_mfma_f32_16x16x32_bf16 v[28:31], a[160:163], v[108:111], v[28:31]
    s_waitcnt vmcnt(24)
    s_barrier
    s_waitcnt lgkmcnt(0)
    v_mfma_f32_16x16x32_bf16 v[32:35], a[180:183], v[112:115], v[32:35]
    ds_read_b128 v[92:95], v5 offset:12288
    v_mfma_f32_16x16x32_bf16 v[52:55], v[112:115], a[184:187], v[52:55]
    s_add_u32 m0, s14, 0
    s_add_u32 s15, s61, 0
    buffer_load_dwordx4 v2, s[40:43], s15 offen offset:0 lds
    v_mfma_f32_16x16x32_bf16 v[72:75], a[188:191], v[112:115], v[72:75]
    ds_read_b128 v[96:99], v5 offset:30720
    v_mfma_f32_16x16x32_bf16 v[36:39], a[180:183], v[116:119], v[36:39]
    v_mfma_f32_16x16x32_bf16 v[56:59], v[116:119], a[184:187], v[56:59]
    ds_read_b128 v[100:103], v6 offset:3072
    v_mfma_f32_16x16x32_bf16 v[76:79], a[188:191], v[116:119], v[76:79]
    v_mfma_f32_16x16x32_bf16 v[16:19], a[176:179], v[116:119], v[16:19]
    ds_read_b128 v[104:107], v6 offset:21504
    v_mfma_f32_16x16x32_bf16 v[40:43], a[180:183], v[120:123], v[40:43]
    v_mfma_f32_16x16x32_bf16 v[60:63], v[120:123], a[184:187], v[60:63]
    ds_read_b128 v[108:111], v6 offset:39936
    v_mfma_f32_16x16x32_bf16 v[80:83], a[188:191], v[120:123], v[80:83]
    v_mfma_f32_16x16x32_bf16 v[20:23], a[176:179], v[120:123], v[20:23]
    s_add_u32 m0, s14, 0
    s_add_u32 s15, s61, 0
    buffer_load_dwordx4 v2, s[40:43], s15 offen offset:1024 lds
    v_mfma_f32_16x16x32_bf16 v[44:47], a[180:183], v[124:127], v[44:47]
    v_mfma_f32_16x16x32_bf16 v[64:67], v[124:127], a[184:187], v[64:67]
    v_mfma_f32_16x16x32_bf16 v[84:87], a[188:191], v[124:127], v[84:87]
    v_mfma_f32_16x16x32_bf16 v[24:27], a[176:179], v[124:127], v[24:27]
    v_mfma_f32_16x16x32_bf16 v[48:51], a[180:183], v[128:131], v[48:51]
    v_mfma_f32_16x16x32_bf16 v[68:71], v[128:131], a[184:187], v[68:71]
    v_mfma_f32_16x16x32_bf16 v[88:91], a[188:191], v[128:131], v[88:91]
    v_mfma_f32_16x16x32_bf16 v[28:31], a[176:179], v[128:131], v[28:31]
    s_waitcnt lgkmcnt(0)
    v_mfma_f32_16x16x32_bf16 v[32:35], a[196:199], v[92:95], v[32:35]
    ds_read_b128 v[112:115], v5 offset:13312
    v_mfma_f32_16x16x32_bf16 v[52:55], v[92:95], a[200:203], v[52:55]
    s_add_u32 m0, s14, 0
    s_add_u32 s15, s61, 0
    buffer_load_dwordx4 v2, s[40:43], s15 offen offset:2048 lds
    v_mfma_f32_16x16x32_bf16 v[72:75], a[204:207], v[92:95], v[72:75]
    ds_read_b128 v[116:119], v5 offset:31744
    v_mfma_f32_16x16x32_bf16 v[36:39], a[196:199], v[96:99], v[36:39]
    v_mfma_f32_16x16x32_bf16 v[56:59], v[96:99], a[200:203], v[56:59]
    ds_read_b128 v[120:123], v6 offset:4096
    v_mfma_f32_16x16x32_bf16 v[76:79], a[204:207], v[96:99], v[76:79]
    v_mfma_f32_16x16x32_bf16 v[16:19], a[192:195], v[96:99], v[16:19]
    ds_read_b128 v[124:127], v6 offset:22528
    v_mfma_f32_16x16x32_bf16 v[40:43], a[196:199], v[100:103], v[40:43]
    v_mfma_f32_16x16x32_bf16 v[60:63], v[100:103], a[200:203], v[60:63]
    ds_read_b128 v[128:131], v6 offset:40960
    v_mfma_f32_16x16x32_bf16 v[80:83], a[204:207], v[100:103], v[80:83]
    v_mfma_f32_16x16x32_bf16 v[20:23], a[192:195], v[100:103], v[20:23]
    s_add_u32 m0, s14, 0
    s_add_u32 s15, s61, 0
    buffer_load_dwordx4 v2, s[40:43], s15 offen offset:3072 lds
    v_mfma_f32_16x16x32_bf16 v[44:47], a[196:199], v[104:107], v[44:47]
    v_mfma_f32_16x16x32_bf16 v[64:67], v[104:107], a[200:203], v[64:67]
    v_mfma_f32_16x16x32_bf16 v[84:87], a[204:207], v[104:107], v[84:87]
    v_mfma_f32_16x16x32_bf16 v[24:27], a[192:195], v[104:107], v[24:27]
    v_mfma_f32_16x16x32_bf16 v[48:51], a[196:199], v[108:111], v[48:51]
    v_mfma_f32_16x16x32_bf16 v[68:71], v[108:111], a[200:203], v[68:71]
    v_mfma_f32_16x16x32_bf16 v[88:91], a[204:207], v[108:111], v[88:91]
    v_mfma_f32_16x16x32_bf16 v[28:31], a[192:195], v[108:111], v[28:31]
    s_waitcnt lgkmcnt(0)
    s_waitcnt vmcnt(24)
    v_mfma_f32_16x16x32_bf16 v[32:35], a[212:215], v[112:115], v[32:35]
    ds_read_b128 v[92:95], v5 offset:14336
    v_mfma_f32_16x16x32_bf16 v[52:55], v[112:115], a[216:219], v[52:55]
    s_add_u32 m0, s14, 4096
    s_add_u32 s15, s61, 4096
    buffer_load_dwordx4 v2, s[40:43], s15 offen offset:0 lds
    v_mfma_f32_16x16x32_bf16 v[72:75], a[220:223], v[112:115], v[72:75]
    ds_read_b128 v[96:99], v5 offset:32768
    v_mfma_f32_16x16x32_bf16 v[36:39], a[212:215], v[116:119], v[36:39]
    v_mfma_f32_16x16x32_bf16 v[56:59], v[116:119], a[216:219], v[56:59]
    ds_read_b128 v[100:103], v6 offset:5120
    v_mfma_f32_16x16x32_bf16 v[76:79], a[220:223], v[116:119], v[76:79]
    v_mfma_f32_16x16x32_bf16 v[16:19], a[208:211], v[116:119], v[16:19]
    ds_read_b128 v[104:107], v6 offset:23552
    v_mfma_f32_16x16x32_bf16 v[40:43], a[212:215], v[120:123], v[40:43]
    v_mfma_f32_16x16x32_bf16 v[60:63], v[120:123], a[216:219], v[60:63]
    ds_read_b128 v[108:111], v6 offset:41984
    v_mfma_f32_16x16x32_bf16 v[80:83], a[220:223], v[120:123], v[80:83]
    v_mfma_f32_16x16x32_bf16 v[20:23], a[208:211], v[120:123], v[20:23]
    v_mfma_f32_16x16x32_bf16 v[44:47], a[212:215], v[124:127], v[44:47]
    v_mfma_f32_16x16x32_bf16 v[64:67], v[124:127], a[216:219], v[64:67]
    v_mfma_f32_16x16x32_bf16 v[84:87], a[220:223], v[124:127], v[84:87]
    v_mfma_f32_16x16x32_bf16 v[24:27], a[208:211], v[124:127], v[24:27]
    v_mfma_f32_16x16x32_bf16 v[48:51], a[212:215], v[128:131], v[48:51]
    v_mfma_f32_16x16x32_bf16 v[68:71], v[128:131], a[216:219], v[68:71]
    v_mfma_f32_16x16x32_bf16 v[88:91], a[220:223], v[128:131], v[88:91]
    v_mfma_f32_16x16x32_bf16 v[28:31], a[208:211], v[128:131], v[28:31]
    s_waitcnt vmcnt(13)
    s_barrier
    s_waitcnt lgkmcnt(0)
    v_mfma_f32_16x16x32_bf16 v[32:35], a[228:231], v[92:95], v[32:35]
    ds_read_b128 v[112:115], v5 offset:15360
    v_mfma_f32_16x16x32_bf16 v[52:55], v[92:95], a[232:235], v[52:55]
    s_add_u32 m0, s14, 4096
    s_add_u32 s15, s61, 4096
    buffer_load_dwordx4 v2, s[40:43], s15 offen offset:1024 lds
    v_mfma_f32_16x16x32_bf16 v[72:75], a[236:239], v[92:95], v[72:75]
    ds_read_b128 v[116:119], v5 offset:33792
    v_mfma_f32_16x16x32_bf16 v[36:39], a[228:231], v[96:99], v[36:39]
    v_mfma_f32_16x16x32_bf16 v[56:59], v[96:99], a[232:235], v[56:59]
    ds_read_b128 v[120:123], v6 offset:6144
    v_mfma_f32_16x16x32_bf16 v[76:79], a[236:239], v[96:99], v[76:79]
    v_mfma_f32_16x16x32_bf16 v[16:19], a[224:227], v[96:99], v[16:19]
    ds_read_b128 v[124:127], v6 offset:24576
    v_mfma_f32_16x16x32_bf16 v[40:43], a[228:231], v[100:103], v[40:43]
    v_mfma_f32_16x16x32_bf16 v[60:63], v[100:103], a[232:235], v[60:63]
    ds_read_b128 v[128:131], v6 offset:43008
    v_mfma_f32_16x16x32_bf16 v[80:83], a[236:239], v[100:103], v[80:83]
    v_mfma_f32_16x16x32_bf16 v[20:23], a[224:227], v[100:103], v[20:23]
    v_mfma_f32_16x16x32_bf16 v[44:47], a[228:231], v[104:107], v[44:47]
    v_mfma_f32_16x16x32_bf16 v[64:67], v[104:107], a[232:235], v[64:67]
    v_mfma_f32_16x16x32_bf16 v[84:87], a[236:239], v[104:107], v[84:87]
    v_mfma_f32_16x16x32_bf16 v[24:27], a[224:227], v[104:107], v[24:27]
    v_mfma_f32_16x16x32_bf16 v[48:51], a[228:231], v[108:111], v[48:51]
    v_mfma_f32_16x16x32_bf16 v[68:71], v[108:111], a[232:235], v[68:71]
    v_mfma_f32_16x16x32_bf16 v[88:91], a[236:239], v[108:111], v[88:91]
    v_mfma_f32_16x16x32_bf16 v[28:31], a[224:227], v[108:111], v[28:31]
    s_waitcnt lgkmcnt(0)
    v_mfma_f32_16x16x32_bf16 v[32:35], a[244:247], v[112:115], v[32:35]
    ds_read_b128 v[92:95], v5 offset:16384
    v_mfma_f32_16x16x32_bf16 v[52:55], v[112:115], a[248:251], v[52:55]
    s_add_u32 m0, s14, 4096
    s_add_u32 s15, s61, 4096
    buffer_load_dwordx4 v2, s[40:43], s15 offen offset:2048 lds
    v_mfma_f32_16x16x32_bf16 v[72:75], a[252:255], v[112:115], v[72:75]
    ds_read_b128 v[96:99], v5 offset:34816
    v_mfma_f32_16x16x32_bf16 v[36:39], a[244:247], v[116:119], v[36:39]
    v_mfma_f32_16x16x32_bf16 v[56:59], v[116:119], a[248:251], v[56:59]
    ds_read_b128 v[100:103], v6 offset:7168
    v_mfma_f32_16x16x32_bf16 v[76:79], a[252:255], v[116:119], v[76:79]
    v_mfma_f32_16x16x32_bf16 v[16:19], a[240:243], v[116:119], v[16:19]
    ds_read_b128 v[104:107], v6 offset:25600
    v_mfma_f32_16x16x32_bf16 v[40:43], a[244:247], v[120:123], v[40:43]
    v_mfma_f32_16x16x32_bf16 v[60:63], v[120:123], a[248:251], v[60:63]
    ds_read_b128 v[108:111], v6 offset:44032
    v_mfma_f32_16x16x32_bf16 v[80:83], a[252:255], v[120:123], v[80:83]
    v_mfma_f32_16x16x32_bf16 v[20:23], a[240:243], v[120:123], v[20:23]
    v_mfma_f32_16x16x32_bf16 v[44:47], a[244:247], v[124:127], v[44:47]
    v_mfma_f32_16x16x32_bf16 v[64:67], v[124:127], a[248:251], v[64:67]
    v_mfma_f32_16x16x32_bf16 v[84:87], a[252:255], v[124:127], v[84:87]
    v_mfma_f32_16x16x32_bf16 v[24:27], a[240:243], v[124:127], v[24:27]
    v_mfma_f32_16x16x32_bf16 v[48:51], a[244:247], v[128:131], v[48:51]
    v_mfma_f32_16x16x32_bf16 v[68:71], v[128:131], a[248:251], v[68:71]
    v_mfma_f32_16x16x32_bf16 v[88:91], a[252:255], v[128:131], v[88:91]
    v_mfma_f32_16x16x32_bf16 v[28:31], a[240:243], v[128:131], v[28:31]
    s_waitcnt lgkmcnt(0)
    s_waitcnt vmcnt(11)
    v_mfma_f32_16x16x32_bf16 v[32:35], a[4:7], v[92:95], v[32:35]
    ds_read_b128 v[112:115], v5 offset:17408
    v_mfma_f32_16x16x32_bf16 v[52:55], v[92:95], a[8:11], v[52:55]
    s_add_u32 m0, s14, 4096
    s_add_u32 s15, s61, 4096
    buffer_load_dwordx4 v2, s[40:43], s15 offen offset:3072 lds
    v_mfma_f32_16x16x32_bf16 v[72:75], a[12:15], v[92:95], v[72:75]
    ds_read_b128 v[116:119], v5 offset:35840
    v_mfma_f32_16x16x32_bf16 v[36:39], a[4:7], v[96:99], v[36:39]
    v_mfma_f32_16x16x32_bf16 v[56:59], v[96:99], a[8:11], v[56:59]
    ds_read_b128 v[120:123], v6 offset:8192
    v_mfma_f32_16x16x32_bf16 v[76:79], a[12:15], v[96:99], v[76:79]
    v_mfma_f32_16x16x32_bf16 v[16:19], a[0:3], v[96:99], v[16:19]
    ds_read_b128 v[124:127], v6 offset:26624
    v_mfma_f32_16x16x32_bf16 v[40:43], a[4:7], v[100:103], v[40:43]
    v_mfma_f32_16x16x32_bf16 v[60:63], v[100:103], a[8:11], v[60:63]
    ds_read_b128 v[128:131], v6 offset:45056
    v_mfma_f32_16x16x32_bf16 v[80:83], a[12:15], v[100:103], v[80:83]
    v_mfma_f32_16x16x32_bf16 v[20:23], a[0:3], v[100:103], v[20:23]
    v_mfma_f32_16x16x32_bf16 v[44:47], a[4:7], v[104:107], v[44:47]
    v_mfma_f32_16x16x32_bf16 v[64:67], v[104:107], a[8:11], v[64:67]
    v_mfma_f32_16x16x32_bf16 v[84:87], a[12:15], v[104:107], v[84:87]
    v_mfma_f32_16x16x32_bf16 v[24:27], a[0:3], v[104:107], v[24:27]
    v_mfma_f32_16x16x32_bf16 v[48:51], a[4:7], v[108:111], v[48:51]
    v_mfma_f32_16x16x32_bf16 v[68:71], v[108:111], a[8:11], v[68:71]
    v_mfma_f32_16x16x32_bf16 v[88:91], a[12:15], v[108:111], v[88:91]
    v_mfma_f32_16x16x32_bf16 v[28:31], a[0:3], v[108:111], v[28:31]
    s_waitcnt lgkmcnt(0)
    s_waitcnt vmcnt(8)
    v_mfma_f32_16x16x32_bf16 v[32:35], a[20:23], v[112:115], v[32:35]
    v_mfma_f32_16x16x32_bf16 v[52:55], v[112:115], a[24:27], v[52:55]
    s_add_u32 m0, s14, 8192
    s_add_u32 s15, s61, 8192
    buffer_load_dwordx4 v2, s[40:43], s15 offen offset:0 lds
    v_mfma_f32_16x16x32_bf16 v[72:75], a[28:31], v[112:115], v[72:75]
    v_mfma_f32_16x16x32_bf16 v[36:39], a[20:23], v[116:119], v[36:39]
    v_mfma_f32_16x16x32_bf16 v[56:59], v[116:119], a[24:27], v[56:59]
    v_mfma_f32_16x16x32_bf16 v[76:79], a[28:31], v[116:119], v[76:79]
    v_mfma_f32_16x16x32_bf16 v[16:19], a[16:19], v[116:119], v[16:19]
    v_mfma_f32_16x16x32_bf16 v[40:43], a[20:23], v[120:123], v[40:43]
    v_mfma_f32_16x16x32_bf16 v[60:63], v[120:123], a[24:27], v[60:63]
    v_mfma_f32_16x16x32_bf16 v[80:83], a[28:31], v[120:123], v[80:83]
    v_mfma_f32_16x16x32_bf16 v[20:23], a[16:19], v[120:123], v[20:23]
    v_mfma_f32_16x16x32_bf16 v[44:47], a[20:23], v[124:127], v[44:47]
    v_mfma_f32_16x16x32_bf16 v[64:67], v[124:127], a[24:27], v[64:67]
    v_mfma_f32_16x16x32_bf16 v[84:87], a[28:31], v[124:127], v[84:87]
    v_mfma_f32_16x16x32_bf16 v[24:27], a[16:19], v[124:127], v[24:27]
    v_mfma_f32_16x16x32_bf16 v[48:51], a[20:23], v[128:131], v[48:51]
    v_mfma_f32_16x16x32_bf16 v[68:71], v[128:131], a[24:27], v[68:71]
    v_mfma_f32_16x16x32_bf16 v[88:91], a[28:31], v[128:131], v[88:91]
    v_mfma_f32_16x16x32_bf16 v[28:31], a[16:19], v[128:131], v[28:31]
K1_attn:
    v_cvt_pk_bf16_f32 v194, v72, v73
    ds_write_b16 v141, v194 offset:0
    ds_write_b16_d16_hi v141, v194 offset:160
    v_cvt_pk_bf16_f32 v150, v76, v77
    ds_write_b16 v141, v150 offset:32
    ds_write_b16_d16_hi v141, v150 offset:192
    v_cvt_pk_bf16_f32 v154, v80, v81
    ds_write_b16 v141, v154 offset:64
    ds_write_b16_d16_hi v141, v154 offset:224
    v_cvt_pk_bf16_f32 v158, v84, v85
    buffer_load_dwordx4 v[208:211], v206, s[32:35], s64 offen sc1
    ds_write_b16 v141, v158 offset:96
    ds_write_b16_d16_hi v141, v158 offset:256
    v_cvt_pk_bf16_f32 v162, v88, v89
    ds_write_b16 v141, v162 offset:128
    ds_write_b16_d16_hi v141, v162 offset:288
    v_cvt_pk_bf16_f32 v166, v74, v75
    v_cvt_pk_bf16_f32 v164, v32, v33
    v_cvt_pk_bf16_f32 v165, v34, v35
    buffer_load_dwordx4 v[212:215], v207, s[32:35], s64 offen sc1
    v_mov_b32 v167, 0
    v_cvt_pk_bf16_f32 v170, v78, v79
    v_cvt_pk_bf16_f32 v168, v36, v37
    v_cvt_pk_bf16_f32 v169, v38, v39
    buffer_load_dwordx4 v[216:219], v223, s[32:35], s64 offen sc1
    v_mov_b32 v171, 0
    v_cvt_pk_bf16_f32 v148, v16, v17
    v_cvt_pk_bf16_f32 v149, v18, v19
    v_mov_b32 v151, 0
    buffer_load_dwordx4 a[240:243], v236, s[36:39], s76 offen nt
    v_cvt_pk_bf16_f32 v174, v82, v83
    v_cvt_pk_bf16_f32 v172, v40, v41
    v_cvt_pk_bf16_f32 v173, v42, v43
    v_mov_b32 v175, 0
    v_cvt_pk_bf16_f32 v152, v20, v21
    v_cvt_pk_bf16_f32 v153, v22, v23
    v_mov_b32 v155, 0
    v_cvt_pk_bf16_f32 v178, v86, v87
    v_cvt_pk_bf16_f32 v176, v44, v45
    v_cvt_pk_bf16_f32 v177, v46, v47
    v_mov_b32 v179, 0
    v_cvt_pk_bf16_f32 v156, v24, v25
    buffer_load_dwordx4 a[244:247], v236, s[36:39], s77 offen nt
    v_cvt_pk_bf16_f32 v157, v26, v27
    v_mov_b32 v159, 0
    v_cvt_pk_bf16_f32 v182, v90, v91
    v_cvt_pk_bf16_f32 v180, v48, v49
    v_cvt_pk_bf16_f32 v181, v50, v51
    v_mov_b32 v183, 0
    v_cvt_pk_bf16_f32 v160, v28, v29
    v_cvt_pk_bf16_f32 v161, v30, v31
    v_mov_b32 v163, 0
    ds_read_b64 v[196:197], v142 offset:0
    ds_read_b64 v[198:199], v142 offset:32
    ds_read_b64 v[200:201], v142 offset:64
    ds_read_b64 v[202:203], v142 offset:96
    ds_read_b64 v[204:205], v142 offset:128
    v_mfma_f32_16x16x32_bf16 v[92:95], v[164:167], v[148:151], v[136:139]
    v_mfma_f32_16x16x32_bf16 v[96:99], v[168:171], v[148:151], 0
    v_mfma_f32_16x16x32_bf16 v[100:103], v[168:171], v[152:155], 0
    v_mfma_f32_16x16x32_bf16 v[104:107], v[172:175], v[152:155], 0
    v_mfma_f32_16x16x32_bf16 v[108:111], v[172:175], v[156:159], 0
    v_mfma_f32_16x16x32_bf16 v[112:115], v[176:179], v[156:159], 0
    v_mfma_f32_16x16x32_bf16 v[116:119], v[176:179], v[160:163], 0
    v_mfma_f32_16x16x32_bf16 v[120:123], v[180:183], v[160:163], 0
    v_cvt_pk_bf16_f32 v184, v52, v53
    v_cvt_pk_bf16_f32 v185, v54, v55
    v_cvt_pk_bf16_f32 v186, v56, v57
    buffer_load_dwordx4 a[248:251], v236, s[36:39], s78 offen nt
    v_cvt_pk_bf16_f32 v187, v58, v59
    v_cvt_pk_bf16_f32 v188, v60, v61
    v_cvt_pk_bf16_f32 v189, v62, v63
    v_cvt_pk_bf16_f32 v190, v64, v65
    v_cvt_pk_bf16_f32 v191, v66, v67
    v_cvt_pk_bf16_f32 v192, v68, v69
    v_cvt_pk_bf16_f32 v193, v70, v71
    s_mov_b32 s19, 0x3eae1a93
    v_cndmask_b32 v18, v96, v97, s[70:71]
    v_cndmask_b32 v19, v92, v93, s[70:71]
    v_cndmask_b32 v20, v98, v99, s[70:71]
    v_cndmask_b32 v21, v94, v95, s[70:71]
    v_cndmask_b32 v16, v19, v18, s[72:73]
    buffer_load_dwordx4 a[252:255], v236, s[36:39], s79 offen nt
    v_cndmask_b32 v17, v21, v20, s[74:75]
    v_max_f32 v18, v16, v17
    v_mov_b32 v19, v18
    v_cndmask_b32 v26, v104, v105, s[70:71]
    v_cndmask_b32 v27, v100, v101, s[70:71]
    v_cndmask_b32 v28, v106, v107, s[70:71]
    v_cndmask_b32 v29, v102, v103, s[70:71]
    v_cndmask_b32 v24, v27, v26, s[72:73]
    v_cndmask_b32 v25, v29, v28, s[74:75]
    v_max_f32 v26, v24, v25
    v_mov_b32 v27, v26
    v_cndmask_b32 v34, v112, v113, s[70:71]
    v_cndmask_b32 v35, v108, v109, s[70:71]
    v_cndmask_b32 v36, v114, v115, s[70:71]
    v_cndmask_b32 v37, v110, v111, s[70:71]
    v_cndmask_b32 v32, v35, v34, s[72:73]
    v_cndmask_b32 v33, v37, v36, s[74:75]
    v_max_f32 v34, v32, v33
    v_mov_b32 v35, v34
    v_cndmask_b32 v42, v120, v121, s[70:71]
    v_cndmask_b32 v43, v116, v117, s[70:71]
    v_cndmask_b32 v44, v122, v123, s[70:71]
    v_cndmask_b32 v45, v118, v119, s[70:71]
    v_cndmask_b32 v40, v43, v42, s[72:73]
    v_cndmask_b32 v41, v45, v44, s[74:75]
    v_max_f32 v42, v40, v41
    v_mov_b32 v43, v42
    v_permlane16_swap_b32 v18, v19
    v_permlane16_swap_b32 v26, v27
    v_permlane16_swap_b32 v34, v35
    v_permlane16_swap_b32 v42, v43
    v_max_f32 v18, v18, v19
    v_mov_b32 v19, v18
    v_max_f32 v26, v26, v27
    v_mov_b32 v27, v26
    v_max_f32 v34, v34, v35
    v_mov_b32 v35, v34
    v_max_f32 v42, v42, v43
    v_mov_b32 v43, v42
    v_permlane32_swap_b32 v18, v19
    v_permlane32_swap_b32 v26, v27
    v_permlane32_swap_b32 v34, v35
    v_permlane32_swap_b32 v42, v43
    v_max_f32 v18, v18, v19
    v_max_f32 v26, v26, v27
    v_max_f32 v34, v34, v35
    v_max_f32 v42, v42, v43
    v_sub_f32 v16, v16, v18
    v_sub_f32 v17, v17, v18
    v_mul_f32 v16, s19, v16
    v_mul_f32 v17, s19, v17
    v_sub_f32 v24, v24, v26
    v_sub_f32 v25, v25, v26
    v_mul_f32 v24, s19, v24
    v_mul_f32 v25, s19, v25
    v_sub_f32 v32, v32, v34
    v_sub_f32 v33, v33, v34
    v_mul_f32 v32, s19, v32
    v_mul_f32 v33, s19, v33
    v_sub_f32 v40, v40, v42
    v_sub_f32 v41, v41, v42
    v_mul_f32 v40, s19, v40
    v_mul_f32 v41, s19, v41
    v_exp_f32 v16, v16
    v_exp_f32 v17, v17
    v_exp_f32 v24, v24
    v_exp_f32 v25, v25
    v_exp_f32 v32, v32
    v_exp_f32 v33, v33
    v_exp_f32 v40, v40
    v_exp_f32 v41, v41
    v_add_f32 v18, v16, v17
    v_mov_b32 v19, v18
    v_add_f32 v26, v24, v25
    v_mov_b32 v27, v26
    v_add_f32 v34, v32, v33
    v_mov_b32 v35, v34
    v_add_f32 v42, v40, v41
    v_mov_b32 v43, v42
    v_permlane16_swap_b32 v18, v19
    v_permlane16_swap_b32 v26, v27
    v_permlane16_swap_b32 v34, v35
    v_permlane16_swap_b32 v42, v43
    v_add_f32 v18, v18, v19
    v_mov_b32 v19, v18
    v_add_f32 v26, v26, v27
    v_mov_b32 v27, v26
    v_add_f32 v34, v34, v35
    v_mov_b32 v35, v34
    v_add_f32 v42, v42, v43
    v_mov_b32 v43, v42
    v_permlane32_swap_b32 v18, v19
    v_permlane32_swap_b32 v26, v27
    v_permlane32_swap_b32 v34, v35
    v_permlane32_swap_b32 v42, v43
    v_add_f32 v18, v18, v19
    v_add_f32 v26, v26, v27
    v_add_f32 v34, v34, v35
    v_add_f32 v42, v42, v43
    v_rcp_f32 v18, v18
    v_rcp_f32 v26, v26
    v_rcp_f32 v34, v34
    v_rcp_f32 v42, v42
    v_mul_f32 v16, v16, v18
    v_mul_f32 v17, v17, v18
    v_cvt_pk_bf16_f32 v16, v16, v16
    v_cvt_pk_bf16_f32 v17, v17, v17
    v_and_b32 v20, v16, v132
    v_and_b32 v21, v17, v133
    v_and_b32 v22, v16, v134
    v_and_b32 v23, v17, v135
    v_mul_f32 v24, v24, v26
    v_mul_f32 v25, v25, v26
    v_cvt_pk_bf16_f32 v24, v24, v24
    v_cvt_pk_bf16_f32 v25, v25, v25
    v_and_b32 v28, v24, v132
    v_and_b32 v29, v25, v133
    v_and_b32 v30, v24, v134
    v_and_b32 v31, v25, v135
    v_mul_f32 v32, v32, v34
    v_mul_f32 v33, v33, v34
    v_cvt_pk_bf16_f32 v32, v32, v32
    v_cvt_pk_bf16_f32 v33, v33, v33
    v_and_b32 v36, v32, v132
    v_and_b32 v37, v33, v133
    v_and_b32 v38, v32, v134
    v_and_b32 v39, v33, v135
    v_mul_f32 v40, v40, v42
    v_mul_f32 v41, v41, v42
    v_cvt_pk_bf16_f32 v40, v40, v40
    v_cvt_pk_bf16_f32 v41, v41, v41
    v_and_b32 v44, v40, v132
    v_and_b32 v45, v41, v133
    v_and_b32 v46, v40, v134
    v_and_b32 v47, v41, v135
    s_waitcnt lgkmcnt(0)
    v_mfma_f32_16x16x32_bf16 v[92:95], v[184:187], v[20:23], 0
    v_mfma_f32_16x16x32_bf16 v[96:99], v[196:199], v[20:23], 0
    v_mfma_f32_16x16x32_bf16 v[100:103], v[186:189], v[28:31], 0
    v_mfma_f32_16x16x32_bf16 v[104:107], v[198:201], v[28:31], 0
    v_mfma_f32_16x16x32_bf16 v[108:111], v[188:191], v[36:39], 0
    v_mfma_f32_16x16x32_bf16 v[112:115], v[200:203], v[36:39], 0
    v_mfma_f32_16x16x32_bf16 v[116:119], v[190:193], v[44:47], 0
    v_mfma_f32_16x16x32_bf16 v[120:123], v[202:205], v[44:47], 0
    s_add_u32 s66, s62, 0x240000
    s_lshl_b32 s67, s4, 11
    s_add_u32 s67, s67, s66
    s_lshl_b32 s68, s4, 8
    s_add_u32 s68, s68, s66
    s_add_u32 s68, s68, 16384
    v_cvt_pk_bf16_f32 v48, v92, v93
    v_cvt_pk_bf16_f32 v49, v94, v95
    v_cvt_pk_bf16_f32 v50, v96, v97
    ds_write_b64 v143, v[48:49] offset:0
    ds_write_b32 v144, v50 offset:0
    v_cvt_pk_bf16_f32 v52, v100, v101
    v_cvt_pk_bf16_f32 v53, v102, v103
    v_cvt_pk_bf16_f32 v54, v104, v105
    ds_write_b64 v143, v[52:53] offset:3072
    ds_write_b32 v144, v54 offset:3072
    v_cvt_pk_bf16_f32 v56, v108, v109
    v_cvt_pk_bf16_f32 v57, v110, v111
    v_cvt_pk_bf16_f32 v58, v112, v113
    ds_write_b64 v143, v[56:57] offset:6144
    ds_write_b32 v144, v58 offset:6144
    v_cvt_pk_bf16_f32 v60, v116, v117
    v_cvt_pk_bf16_f32 v61, v118, v119
    v_cvt_pk_bf16_f32 v62, v120, v121
    ds_write_b64 v143, v[60:61] offset:9216
    ds_write_b32 v144, v62 offset:9216
    s_waitcnt lgkmcnt(0)
    s_waitcnt vmcnt(7)
    s_barrier
    ds_read_b128 v[224:227], v145 offset:0
    ds_read_b128 v[228:231], v145 offset:1024
    ds_read_b128 v[232:235], v145 offset:2048
    s_waitcnt lgkmcnt(2)
    buffer_store_dwordx4 v[224:227], v2, s[40:43], s67 offen offset:0 sc1
    s_waitcnt lgkmcnt(1)
    buffer_store_dwordx4 v[228:231], v2, s[40:43], s67 offen offset:1024 sc1
    s_waitcnt lgkmcnt(0)
    buffer_store_dwordx4 v[232:235], v221, s[40:43], s68 offen sc1
    s_mul_i32 s9, s4, 36
    s_add_u32 s9, s9, s3
    s_mul_i32 s11, s9, 18432
    s_add_u32 s11, s11, 0x2e8000
    v_add_u32 v7, s11, v2
    v_add_u32 v8, 4096, v7
    v_add_u32 v9, 8192, v7
    v_add_u32 v10, 12288, v7
    v_add_u32 v11, 16384, v7
    s_lshl_b32 s11, s9, 8
    s_add_u32 s11, s11, 0xd08000
    v_lshl_add_u32 v12, v4, 4, s11
    s_mov_b32 s48, 0
    s_mov_b32 s49, 73728
    s_mov_b32 s50, 147456
    s_mov_b32 s51, 221184
    s_mov_b32 s52, 294912
    s_mov_b32 s53, 368640
    s_mov_b32 s54, 442368
    s_mov_b32 s55, 516096
    s_mov_b32 s56, 589824
    buffer_load_dwordx4 v[16:19], v7, s[40:43], s48 offen offset:0
    buffer_load_dwordx4 v[20:23], v7, s[40:43], s48 offen offset:1024
    buffer_load_dwordx4 v[24:27], v7, s[40:43], s48 offen offset:2048
    buffer_load_dwordx4 v[28:31], v7, s[40:43], s48 offen offset:3072
    buffer_load_dwordx4 v[32:35], v8, s[40:43], s48 offen offset:0
    buffer_load_dwordx4 v[36:39], v8, s[40:43], s48 offen offset:1024
    buffer_load_dwordx4 v[40:43], v8, s[40:43], s48 offen offset:2048
    buffer_load_dwordx4 v[44:47], v8, s[40:43], s48 offen offset:3072
    s_waitcnt vmcnt(8)
    s_waitcnt lgkmcnt(0)
    s_mov_b32 s16, 1
    s_atomic_add s16, s[20:21], s22 glc
    v_add_u32 v13, 112640, v2
    v_add_u32 v14, 20480, v2
    v_and_b32 v15, 7, v4
    v_lshlrev_b32 v15, 4, v15
    v_lshl_add_u32 v15, v3, 7, v15
    v_add_u32 v6, 20480, v15
    v_add_u32 v15, 112640, v15
    ds_read_b128 a[0:3], v13 offset:0
    ds_read_b128 a[4:7], v13 offset:1024
    ds_read_b128 a[8:11], v13 offset:2048
    ds_read_b128 a[12:15], v13 offset:3072
    ds_read_b128 a[16:19], v15 offset:4096
    ds_read_b128 a[20:23], v13 offset:4608
    ds_read_b128 a[24:27], v13 offset:5632
    ds_read_b128 a[28:31], v13 offset:6656
    ds_read_b128 a[32:35], v13 offset:7680
    ds_read_b128 a[36:39], v15 offset:8704
    ds_read_b128 a[40:43], v13 offset:9216
    ds_read_b128 a[44:47], v13 offset:10240
    ds_read_b128 a[48:51], v13 offset:11264
    ds_read_b128 a[52:55], v13 offset:12288
    ds_read_b128 a[56:59], v15 offset:13312
    ds_read_b128 a[60:63], v13 offset:13824
    ds_read_b128 a[64:67], v13 offset:14848
    ds_read_b128 a[68:71], v13 offset:15872
    ds_read_b128 a[72:75], v13 offset:16896
    ds_read_b128 a[76:79], v15 offset:17920
    ds_read_b128 a[80:83], v13 offset:18432
    ds_read_b128 a[84:87], v13 offset:19456
    ds_read_b128 a[88:91], v13 offset:20480
    ds_read_b128 a[92:95], v13 offset:21504
    ds_read_b128 a[96:99], v15 offset:22528
    ds_read_b128 a[100:103], v13 offset:23040
    ds_read_b128 a[104:107], v13 offset:24064
    ds_read_b128 a[108:111], v13 offset:25088
    ds_read_b128 a[112:115], v13 offset:26112
    ds_read_b128 a[116:119], v15 offset:27136
    buffer_load_dwordx4 v[48:51], v9, s[40:43], s48 offen offset:0
    buffer_load_dwordx4 v[52:55], v9, s[40:43], s48 offen offset:1024
    buffer_load_dwordx4 v[56:59], v9, s[40:43], s48 offen offset:2048
    buffer_load_dwordx4 v[60:63], v9, s[40:43], s48 offen offset:3072
    buffer_load_dwordx4 v[64:67], v10, s[40:43], s48 offen offset:0
    s_mov_b32 s17, 0
    s_atomic_add s17, s[20:21], s22 glc
    buffer_load_dwordx4 v[68:71], v10, s[40:43], s48 offen offset:1024
    buffer_load_dwordx4 v[72:75], v10, s[40:43], s48 offen offset:2048
    buffer_load_dwordx4 v[76:79], v10, s[40:43], s48 offen offset:3072
    buffer_load_dwordx4 v[80:83], v11, s[40:43], s48 offen offset:0
    buffer_load_dwordx4 v[84:87], v11, s[40:43], s48 offen offset:1024
    v_lshlrev_b32 v224, 16, v208
    v_and_b32 v225, 0xffff0000, v208
    v_lshlrev_b32 v226, 16, v209
    v_and_b32 v227, 0xffff0000, v209
    v_lshlrev_b32 v228, 16, v210
    v_and_b32 v229, 0xffff0000, v210
    v_lshlrev_b32 v230, 16, v211
    v_and_b32 v231, 0xffff0000, v211
    v_lshlrev_b32 v232, 16, v212
    v_and_b32 v233, 0xffff0000, v212
    v_lshlrev_b32 v234, 16, v213
    v_and_b32 v235, 0xffff0000, v213
    v_lshlrev_b32 v236, 16, v214
    v_and_b32 v237, 0xffff0000, v214
    v_lshlrev_b32 v238, 16, v215
    v_and_b32 v239, 0xffff0000, v215
    v_lshlrev_b32 v240, 16, v216
    v_and_b32 v241, 0xffff0000, v216
    v_lshlrev_b32 v242, 16, v217
    v_and_b32 v243, 0xffff0000, v217
    v_lshlrev_b32 v244, 16, v218
    v_and_b32 v245, 0xffff0000, v218
    v_lshlrev_b32 v246, 16, v219
    v_and_b32 v247, 0xffff0000, v219
    v_mov_b32 v248, 0x3f803f80
    v_mov_b32 v249, 0x3f803f80
    v_mov_b32 v250, 0x3f803f80
    v_mov_b32 v251, 0x3f803f80
    v_and_b32 v252, 2, v4
    v_cmp_eq_u32 s[72:73], 2, v252
    v_lshrrev_b32 v252, 2, v4
    v_cmp_eq_u32 vcc, v252, v3
    v_lshlrev_b32 v252, 3, v4
    v_mov_b32 v253, 0x80000000
    v_cndmask_b32 v252, v253, v252, vcc
    s_mov_b32 s18, 262144
    s_waitcnt lgkmcnt(0)
    s_add_u32 s16, s16, 1
    s_max_u32 s16, s16, s17
H1_l:
    s_cmp_ge_u32 s16, s46
    s_cbranch_scc1 H1_b
    s_sub_u32 s18, s18, 1
    s_cbranch_scc1 H1_b
    s_mov_b32 s16, 0
    s_atomic_add s16, s[20:21], s22 glc
    s_waitcnt lgkmcnt(0)
    s_branch H1_l
H1_b:
    s_add_u32 s46, s46, 8
    v_add_u32 v5, 4096, v2
    s_add_u32 s14, s66, 8192
    s_add_u32 s15, s66, 16384
    buffer_load_dwordx4 v[88:91], v2, s[40:43], s66 offen offset:0 sc1
    ds_read_b128 a[120:123], v13 offset:27648
    ds_read_b128 a[124:127], v13 offset:28672
    ds_read_b128 a[128:131], v13 offset:29696
    buffer_load_dwordx4 v[92:95], v2, s[40:43], s66 offen offset:1024 sc1
    ds_read_b128 a[132:135], v13 offset:30720
    ds_read_b128 a[136:139], v15 offset:31744
    ds_read_b128 a[140:143], v13 offset:32256
    buffer_load_dwordx4 v[96:99], v2, s[40:43], s66 offen offset:2048 sc1
    ds_read_b128 a[144:147], v13 offset:33280
    ds_read_b128 a[148:151], v13 offset:34304
    ds_read_b128 a[152:155], v13 offset:35328
    buffer_load_dwordx4 v[100:103], v2, s[40:43], s66 offen offset:3072 sc1
    ds_read_b128 a[156:159], v15 offset:36352
    ds_read_b128 a[160:163], v13 offset:36864
    ds_read_b128 a[164:167], v13 offset:37888
    buffer_load_dwordx4 v[104:107], v5, s[40:43], s66 offen offset:0 sc1
    ds_read_b128 a[168:171], v13 offset:38912
    ds_read_b128 a[172:175], v13 offset:39936
    ds_read_b128 a[176:179], v15 offset:40960
    buffer_load_dwordx4 v[108:111], v5, s[40:43], s66 offen offset:1024 sc1
    ds_read_b128 a[180:183], v13 offset:41472
    ds_read_b128 a[184:187], v13 offset:42496
    ds_read_b128 a[188:191], v13 offset:43520
    buffer_load_dwordx4 v[112:115], v5, s[40:43], s66 offen offset:2048 sc1
    ds_read_b128 a[192:195], v13 offset:44544
    ds_read_b128 a[196:199], v15 offset:45568
    ds_read_b128 a[200:203], v14 offset:0
    buffer_load_dwordx4 v[116:119], v5, s[40:43], s66 offen offset:3072 sc1
    ds_read_b128 a[204:207], v14 offset:1024
    ds_read_b128 a[208:211], v14 offset:2048
    ds_read_b128 a[212:215], v14 offset:3072
    buffer_load_dwordx4 v[120:123], v2, s[40:43], s14 offen offset:0 sc1
    ds_read_b128 a[216:219], v6 offset:4096
    ds_read_b128 a[220:223], v14 offset:4608
    ds_read_b128 a[224:227], v14 offset:5632
    buffer_load_dwordx4 v[124:127], v2, s[40:43], s14 offen offset:1024 sc1
    ds_read_b128 a[228:231], v14 offset:6656
    ds_read_b128 a[232:235], v14 offset:7680
    ds_read_b128 a[236:239], v6 offset:8704
    s_waitcnt vmcnt(9)
    v_mfma_f32_16x16x32_bf16 v[160:163], a[0:3], v[88:91], 0
    ds_read_b128 a[0:3], v14 offset:18432
    buffer_load_dwordx4 v[128:131], v2, s[40:43], s14 offen offset:2048 sc1
    v_mfma_f32_16x16x32_bf16 v[164:167], a[4:7], v[88:91], 0
    ds_read_b128 a[4:7], v14 offset:19456
    v_mfma_f32_16x16x32_bf16 v[168:171], a[8:11], v[88:91], 0
    ds_read_b128 a[8:11], v14 offset:20480
    buffer_load_dwordx4 v[132:135], v2, s[40:43], s14 offen offset:3072 sc1
    v_mfma_f32_16x16x32_bf16 v[172:175], a[12:15], v[88:91], 0
    ds_read_b128 a[12:15], v14 offset:21504
    v_mfma_f32_16x16x32_bf16 v[176:179], a[16:19], v[88:91], 0
    ds_read_b128 a[16:19], v6 offset:22528
    s_waitcnt vmcnt(10)
    v_mfma_f32_16x16x32_bf16 v[160:163], a[20:23], v[92:95], v[160:163]
    ds_read_b128 a[20:23], v14 offset:23040
    buffer_load_dwordx4 v[136:139], v5, s[40:43], s14 offen offset:0 sc1
    v_mfma_f32_16x16x32_bf16 v[164:167], a[24:27], v[92:95], v[164:167]
    ds_read_b128 a[24:27], v14 offset:24064
    v_mfma_f32_16x16x32_bf16 v[168:171], a[28:31], v[92:95], v[168:171]
    ds_read_b128 a[28:31], v14 offset:25088
    buffer_load_dwordx4 v[140:143], v5, s[40:43], s14 offen offset:1024 sc1
    v_mfma_f32_16x16x32_bf16 v[172:175], a[32:35], v[92:95], v[172:175]
    ds_read_b128 a[32:35], v14 offset:26112
    v_mfma_f32_16x16x32_bf16 v[176:179], a[36:39], v[92:95], v[176:179]
    ds_read_b128 a[36:39], v6 offset:27136
    s_waitcnt vmcnt(11)
    v_mfma_f32_16x16x32_bf16 v[160:163], a[40:43], v[96:99], v[160:163]
    ds_read_b128 a[40:43], v14 offset:36864
    buffer_load_dwordx4 v[144:147], v5, s[40:43], s14 offen offset:2048 sc1
    v_mfma_f32_16x16x32_bf16 v[164:167], a[44:47], v[96:99], v[164:167]
    ds_read_b128 a[44:47], v14 offset:37888
    v_mfma_f32_16x16x32_bf16 v[168:171], a[48:51], v[96:99], v[168:171]
    ds_read_b128 a[48:51], v14 offset:38912
    buffer_load_dwordx4 v[148:151], v5, s[40:43], s14 offen offset:3072 sc1
    v_mfma_f32_16x16x32_bf16 v[172:175], a[52:55], v[96:99], v[172:175]
    ds_read_b128 a[52:55], v14 offset:39936
    v_mfma_f32_16x16x32_bf16 v[176:179], a[56:59], v[96:99], v[176:179]
    ds_read_b128 a[56:59], v6 offset:40960
    s_waitcnt vmcnt(12)
    v_mfma_f32_16x16x32_bf16 v[160:163], a[60:63], v[100:103], v[160:163]
    ds_read_b128 a[60:63], v14 offset:41472
    buffer_load_dwordx4 v[152:155], v2, s[40:43], s15 offen offset:0 sc1
    v_mfma_f32_16x16x32_bf16 v[164:167], a[64:67], v[100:103], v[164:167]
    ds_read_b128 a[64:67], v14 offset:42496
    v_mfma_f32_16x16x32_bf16 v[168:171], a[68:71], v[100:103], v[168:171]
    ds_read_b128 a[68:71], v14 offset:43520
    buffer_load_dwordx4 v[156:159], v2, s[40:43], s15 offen offset:1024 sc1
    v_mfma_f32_16x16x32_bf16 v[172:175], a[72:75], v[100:103], v[172:175]
    ds_read_b128 a[72:75], v14 offset:44544
    v_mfma_f32_16x16x32_bf16 v[176:179], a[76:79], v[100:103], v[176:179]
    ds_read_b128 a[76:79], v6 offset:45568
    s_waitcnt vmcnt(13)
    v_mfma_f32_16x16x32_bf16 v[160:163], a[80:83], v[104:107], v[160:163]
    ds_read_b128 a[80:83], v14 offset:55296
    v_mfma_f32_16x16x32_bf16 v[164:167], a[84:87], v[104:107], v[164:167]
    ds_read_b128 a[84:87], v14 offset:56320
    v_mfma_f32_16x16x32_bf16 v[168:171], a[88:91], v[104:107], v[168:171]
    ds_read_b128 a[88:91], v14 offset:57344
    v_mfma_f32_16x16x32_bf16 v[172:175], a[92:95], v[104:107], v[172:175]
    ds_read_b128 a[92:95], v14 offset:58368
    v_mfma_f32_16x16x32_bf16 v[176:179], a[96:99], v[104:107], v[176:179]
    ds_read_b128 a[96:99], v6 offset:59392
    s_waitcnt vmcnt(12)
    v_mfma_f32_16x16x32_bf16 v[160:163], a[100:103], v[108:111], v[160:163]
    ds_read_b128 a[100:103], v14 offset:59904
    v_mfma_f32_16x16x32_bf16 v[164:167], a[104:107], v[108:111], v[164:167]
    ds_read_b128 a[104:107], v14 offset:60928
    v_mfma_f32_16x16x32_bf16 v[168:171], a[108:111], v[108:111], v[168:171]
    ds_read_b128 a[108:111], v14 offset:61952
    v_mfma_f32_16x16x32_bf16 v[172:175], a[112:115], v[108:111], v[172:175]
    ds_read_b128 a[112:115], v14 offset:62976
    v_mfma_f32_16x16x32_bf16 v[176:179], a[116:119], v[108:111], v[176:179]
    ds_read_b128 a[116:119], v6 offset:64000
    s_waitcnt vmcnt(11)
    s_waitcnt lgkmcnt(15)
    v_mfma_f32_16x16x32_bf16 v[160:163], a[120:123], v[112:115], v[160:163]
    v_mfma_f32_16x16x32_bf16 v[164:167], a[124:127], v[112:115], v[164:167]
    v_mfma_f32_16x16x32_bf16 v[168:171], a[128:131], v[112:115], v[168:171]
    v_mfma_f32_16x16x32_bf16 v[172:175], a[132:135], v[112:115], v[172:175]
    v_mfma_f32_16x16x32_bf16 v[176:179], a[136:139], v[112:115], v[176:179]
    s_waitcnt vmcnt(10)
    v_mfma_f32_16x16x32_bf16 v[160:163], a[140:143], v[116:119], v[160:163]
    v_mfma_f32_16x16x32_bf16 v[164:167], a[144:147], v[116:119], v[164:167]
    v_mfma_f32_16x16x32_bf16 v[168:171], a[148:151], v[116:119], v[168:171]
    v_mfma_f32_16x16x32_bf16 v[172:175], a[152:155], v[116:119], v[172:175]
    v_mfma_f32_16x16x32_bf16 v[176:179], a[156:159], v[116:119], v[176:179]
    s_waitcnt vmcnt(9)
    v_mfma_f32_16x16x32_bf16 v[160:163], a[160:163], v[120:123], v[160:163]
    v_mfma_f32_16x16x32_bf16 v[164:167], a[164:167], v[120:123], v[164:167]
    v_mfma_f32_16x16x32_bf16 v[168:171], a[168:171], v[120:123], v[168:171]
    v_mfma_f32_16x16x32_bf16 v[172:175], a[172:175], v[120:123], v[172:175]
    v_mfma_f32_16x16x32_bf16 v[176:179], a[176:179], v[120:123], v[176:179]
    s_waitcnt vmcnt(8)
    v_mfma_f32_16x16x32_bf16 v[160:163], a[180:183], v[124:127], v[160:163]
    v_mfma_f32_16x16x32_bf16 v[164:167], a[184:187], v[124:127], v[164:167]
    v_mfma_f32_16x16x32_bf16 v[168:171], a[188:191], v[124:127], v[168:171]
    v_mfma_f32_16x16x32_bf16 v[172:175], a[192:195], v[124:127], v[172:175]
    v_mfma_f32_16x16x32_bf16 v[176:179], a[196:199], v[124:127], v[176:179]
    s_waitcnt vmcnt(7)
    v_mfma_f32_16x16x32_bf16 v[160:163], a[200:203], v[128:131], v[160:163]
    v_mfma_f32_16x16x32_bf16 v[164:167], a[204:207], v[128:131], v[164:167]
    v_mfma_f32_16x16x32_bf16 v[168:171], a[208:211], v[128:131], v[168:171]
    v_mfma_f32_16x16x32_bf16 v[172:175], a[212:215], v[128:131], v[172:175]
    v_mfma_f32_16x16x32_bf16 v[176:179], a[216:219], v[128:131], v[176:179]
    s_waitcnt vmcnt(6)
    v_mfma_f32_16x16x32_bf16 v[160:163], a[220:223], v[132:135], v[160:163]
    v_mfma_f32_16x16x32_bf16 v[164:167], a[224:227], v[132:135], v[164:167]
    v_mfma_f32_16x16x32_bf16 v[168:171], a[228:231], v[132:135], v[168:171]
    v_mfma_f32_16x16x32_bf16 v[172:175], a[232:235], v[132:135], v[172:175]
    v_mfma_f32_16x16x32_bf16 v[176:179], a[236:239], v[132:135], v[176:179]
    s_waitcnt vmcnt(5)
    v_mfma_f32_16x16x32_bf16 v[160:163], a[0:3], v[136:139], v[160:163]
    v_mfma_f32_16x16x32_bf16 v[164:167], a[4:7], v[136:139], v[164:167]
    v_mfma_f32_16x16x32_bf16 v[168:171], a[8:11], v[136:139], v[168:171]
    v_mfma_f32_16x16x32_bf16 v[172:175], a[12:15], v[136:139], v[172:175]
    v_mfma_f32_16x16x32_bf16 v[176:179], a[16:19], v[136:139], v[176:179]
    s_waitcnt vmcnt(4)
    v_mfma_f32_16x16x32_bf16 v[160:163], a[20:23], v[140:143], v[160:163]
    v_mfma_f32_16x16x32_bf16 v[164:167], a[24:27], v[140:143], v[164:167]
    v_mfma_f32_16x16x32_bf16 v[168:171], a[28:31], v[140:143], v[168:171]
    v_mfma_f32_16x16x32_bf16 v[172:175], a[32:35], v[140:143], v[172:175]
    v_mfma_f32_16x16x32_bf16 v[176:179], a[36:39], v[140:143], v[176:179]
    s_waitcnt vmcnt(3)
    v_mfma_f32_16x16x32_bf16 v[160:163], a[40:43], v[144:147], v[160:163]
    v_mfma_f32_16x16x32_bf16 v[164:167], a[44:47], v[144:147], v[164:167]
    v_mfma_f32_16x16x32_bf16 v[168:171], a[48:51], v[144:147], v[168:171]
    v_mfma_f32_16x16x32_bf16 v[172:175], a[52:55], v[144:147], v[172:175]
    v_mfma_f32_16x16x32_bf16 v[176:179], a[56:59], v[144:147], v[176:179]
    s_waitcnt vmcnt(2)
    s_waitcnt lgkmcnt(10)
    v_mfma_f32_16x16x32_bf16 v[160:163], a[60:63], v[148:151], v[160:163]
    v_mfma_f32_16x16x32_bf16 v[164:167], a[64:67], v[148:151], v[164:167]
    v_mfma_f32_16x16x32_bf16 v[168:171], a[68:71], v[148:151], v[168:171]
    v_mfma_f32_16x16x32_bf16 v[172:175], a[72:75], v[148:151], v[172:175]
    v_mfma_f32_16x16x32_bf16 v[176:179], a[76:79], v[148:151], v[176:179]
    s_waitcnt vmcnt(1)
    s_waitcnt lgkmcnt(5)
    v_mfma_f32_16x16x32_bf16 v[160:163], a[80:83], v[152:155], v[160:163]
    v_mfma_f32_16x16x32_bf16 v[164:167], a[84:87], v[152:155], v[164:167]
    v_mfma_f32_16x16x32_bf16 v[168:171], a[88:91], v[152:155], v[168:171]
    v_mfma_f32_16x16x32_bf16 v[172:175], a[92:95], v[152:155], v[172:175]
    v_mfma_f32_16x16x32_bf16 v[176:179], a[96:99], v[152:155], v[176:179]
    s_waitcnt vmcnt(0)
    s_waitcnt lgkmcnt(0)
    v_mfma_f32_16x16x32_bf16 v[160:163], a[100:103], v[156:159], v[160:163]
    v_mfma_f32_16x16x32_bf16 v[164:167], a[104:107], v[156:159], v[164:167]
    v_mfma_f32_16x16x32_bf16 v[168:171], a[108:111], v[156:159], v[168:171]
    v_mfma_f32_16x16x32_bf16 v[172:175], a[112:115], v[156:159], v[172:175]
    v_mfma_f32_16x16x32_bf16 v[176:179], a[116:119], v[156:159], v[176:179]
    s_nop 3
    v_cvt_pk_bf16_f32 v180, v160, v161
    v_cvt_pk_bf16_f32 v181, v162, v163
    v_cvt_pk_bf16_f32 v182, v164, v165
    v_cvt_pk_bf16_f32 v183, v166, v167
    v_cvt_pk_bf16_f32 v184, v168, v169
    v_cvt_pk_bf16_f32 v185, v170, v171
    v_cvt_pk_bf16_f32 v186, v172, v173
    v_cvt_pk_bf16_f32 v187, v174, v175
    v_cvt_pk_bf16_f32 v188, v176, v177
    v_cvt_pk_bf16_f32 v189, v178, v179
    v_permlane16_swap_b32 v180, v182
    v_permlane16_swap_b32 v181, v183
    v_permlane16_swap_b32 v184, v186
    v_permlane16_swap_b32 v185, v187
    v_permlane16_swap_b32 v188, v190
    v_permlane16_swap_b32 v189, v191
    v_and_b32 v188, v188, v222
    v_and_b32 v189, v189, v222
    v_and_b32 v190, v190, v222
    v_and_b32 v191, v191, v222
    v_lshlrev_b32 v88, 16, v180
    v_and_b32 v89, 0xffff0000, v180
    v_lshlrev_b32 v90, 16, v181
    v_and_b32 v91, 0xffff0000, v181
    v_lshlrev_b32 v92, 16, v182
    v_and_b32 v93, 0xffff0000, v182
    v_lshlrev_b32 v94, 16, v183
    v_and_b32 v95, 0xffff0000, v183
    v_pk_add_f32 v[88:89], v[88:89], v[224:225]
    v_pk_add_f32 v[90:91], v[90:91], v[226:227]
    v_pk_add_f32 v[92:93], v[92:93], v[228:229]
    v_pk_add_f32 v[94:95], v[94:95], v[230:231]
    v_cvt_pk_bf16_f32 v208, v88, v89
    v_cvt_pk_bf16_f32 v209, v90, v91
    v_cvt_pk_bf16_f32 v210, v92, v93
    v_cvt_pk_bf16_f32 v211, v94, v95
    buffer_store_dwordx4 v[208:211], v220, s[40:43], s65 offen offset:0 sc1
    v_lshlrev_b32 v96, 16, v184
    v_and_b32 v97, 0xffff0000, v184
    v_lshlrev_b32 v98, 16, v185
    v_and_b32 v99, 0xffff0000, v185
    v_lshlrev_b32 v100, 16, v186
    v_and_b32 v101, 0xffff0000, v186
    v_lshlrev_b32 v102, 16, v187
    v_and_b32 v103, 0xffff0000, v187
    v_pk_add_f32 v[96:97], v[96:97], v[232:233]
    v_pk_add_f32 v[98:99], v[98:99], v[234:235]
    v_pk_add_f32 v[100:101], v[100:101], v[236:237]
    v_pk_add_f32 v[102:103], v[102:103], v[238:239]
    v_cvt_pk_bf16_f32 v212, v96, v97
    v_cvt_pk_bf16_f32 v213, v98, v99
    v_cvt_pk_bf16_f32 v214, v100, v101
    v_cvt_pk_bf16_f32 v215, v102, v103
    buffer_store_dwordx4 v[212:215], v220, s[40:43], s65 offen offset:1024 sc1
    v_lshlrev_b32 v104, 16, v188
    v_and_b32 v105, 0xffff0000, v188
    v_lshlrev_b32 v106, 16, v189
    v_and_b32 v107, 0xffff0000, v189
    v_lshlrev_b32 v108, 16, v190
    v_and_b32 v109, 0xffff0000, v190
    v_lshlrev_b32 v110, 16, v191
    v_and_b32 v111, 0xffff0000, v191
    v_pk_add_f32 v[104:105], v[104:105], v[240:241]
    v_pk_add_f32 v[106:107], v[106:107], v[242:243]
    v_pk_add_f32 v[108:109], v[108:109], v[244:245]
    v_pk_add_f32 v[110:111], v[110:111], v[246:247]
    v_cvt_pk_bf16_f32 v216, v104, v105
    v_cvt_pk_bf16_f32 v217, v106, v107
    v_cvt_pk_bf16_f32 v218, v108, v109
    v_cvt_pk_bf16_f32 v219, v110, v111
    buffer_store_dwordx4 v[216:219], v221, s[40:43], s65 offen offset:2048 sc1
    v_mfma_f32_16x16x32_bf16 v[160:163], v[248:251], v[208:211], 0
    v_mfma_f32_16x16x32_bf16 v[164:167], v[208:211], v[208:211], 0
    v_mfma_f32_16x16x32_bf16 v[160:163], v[248:251], v[212:215], v[160:163]
    v_mfma_f32_16x16x32_bf16 v[164:167], v[212:215], v[212:215], v[164:167]
    v_mfma_f32_16x16x32_bf16 v[160:163], v[248:251], v[216:219], v[160:163]
    v_mfma_f32_16x16x32_bf16 v[164:167], v[216:219], v[216:219], v[164:167]
    s_lshl_b32 s15, s5, 12
    s_add_u32 s69, s15, s44
    s_add_u32 s69, s69, 0x900000
    s_lshl_b32 s15, s4, 9
    s_lshl_b32 s19, s3, 7
    s_add_u32 s15, s15, s19
    s_add_u32 s15, s15, s69
    s_nop 0
    v_cndmask_b32 v112, v164, v165, s[70:71]
    v_cndmask_b32 v113, v166, v167, s[70:71]
    v_mul_f32 v116, 0x3c638e39, v160
    v_cndmask_b32 v112, v112, v113, s[72:73]
    v_fma_f32 v117, -v116, v160, v112
    v_max_f32 v117, 0, v117
    buffer_store_dwordx2 v[116:117], v252, s[40:43], s15 offen sc1
    s_cmp_lg_u32 s45, 0
    s_cbranch_scc1 W2_a
    s_mul_i32 s6, s3, 18432
    s_add_u32 s6, s6, 29696
    v_add_u32 v236, s6, v2
    ds_write_b128 v236, a[240:243] offset:0
    ds_write_b128 v236, a[244:247] offset:1024
    ds_write_b128 v236, a[248:251] offset:2048
    ds_write_b128 v236, a[252:255] offset:3072
    v_bfe_u32 v237, v1, 2, 4
    v_lshlrev_b32 v237, 7, v237
    v_and_b32 v238, 3, v1
    v_lshl_add_u32 v237, v238, 3, v237
    v_add_u32 v237, s6, v237
    ds_read_b64_tr_b16 v[240:241], v237 offset:0
    ds_read_b64_tr_b16 v[242:243], v237 offset:2048
    ds_read_b64_tr_b16 v[244:245], v237 offset:32
    ds_read_b64_tr_b16 v[246:247], v237 offset:2080
    ds_read_b64_tr_b16 v[248:249], v237 offset:64
    ds_read_b64_tr_b16 v[250:251], v237 offset:2112
    ds_read_b64_tr_b16 v[252:253], v237 offset:96
    ds_read_b64_tr_b16 v[254:255], v237 offset:2144
W2_a:
    buffer_load_dwordx4 v[120:123], v9, s[40:43], s49 offen offset:0
    buffer_load_dwordx4 v[124:127], v9, s[40:43], s49 offen offset:1024
    buffer_load_dwordx4 v[128:131], v9, s[40:43], s49 offen offset:2048
    buffer_load_dwordx4 v[132:135], v9, s[40:43], s49 offen offset:3072
    buffer_load_dwordx4 v[136:139], v10, s[40:43], s49 offen offset:0
    buffer_load_dwordx4 v[140:143], v10, s[40:43], s49 offen offset:1024
    s_waitcnt vmcnt(6)
    s_waitcnt lgkmcnt(0)
    s_mov_b32 s16, 1
    s_atomic_add s16, s[20:21], s22 glc
    s_mul_i32 s6, s5, 1366
    s_lshr_b32 s6, s6, 12
    s_mul_i32 s6, s6, 3
    s_sub_u32 s6, s5, s6
    s_mul_i32 s6, s6, 2
    s_mul_i32 s10, s3, 147456
    s_add_u32 s10, s10, 0x510000
    s_lshl_b32 s11, s5, 3
    s_add_u32 s11, s11, s4
    s_mul_i32 s11, s11, 73728
    s_add_u32 s11, s11, s44
    s_add_u32 s11, s11, 0x920000
    s_mul_i32 s14, s3, 4608
    s_add_u32 s11, s11, s14
    s_mul_i32 s76, s6, 18432
    s_add_u32 s76, s76, s10
    s_lshl_b32 s57, s6, 9
    s_add_u32 s57, s57, s11
    s_add_u32 s6, s6, 1
    s_cmp_eq_u32 s6, 7
    s_cselect_b32 s6, 0, s6
    s_mul_i32 s77, s6, 18432
    s_add_u32 s77, s77, s10
    s_lshl_b32 s58, s6, 9
    s_add_u32 s58, s58, s11
    s_add_u32 s6, s6, 1
    s_cmp_eq_u32 s6, 7
    s_cselect_b32 s6, 0, s6
    s_mul_i32 s78, s6, 18432
    s_add_u32 s78, s78, s10
    s_lshl_b32 s59, s6, 9
    s_add_u32 s59, s59, s11
    s_add_u32 s6, s6, 1
    s_cmp_eq_u32 s6, 7
    s_cselect_b32 s6, 0, s6
    s_mul_i32 s79, s6, 18432
    s_add_u32 s79, s79, s10
    s_lshl_b32 s85, s6, 9
    s_add_u32 s85, s85, s11
    s_add_u32 s6, s6, 1
    s_cmp_eq_u32 s6, 7
    s_cselect_b32 s6, 0, s6
    s_mul_i32 s80, s6, 18432
    s_add_u32 s80, s80, s10
    s_lshl_b32 s86, s6, 9
    s_add_u32 s86, s86, s11
    s_add_u32 s6, s6, 1
    s_cmp_eq_u32 s6, 7
    s_cselect_b32 s6, 0, s6
    s_mul_i32 s81, s6, 18432
    s_add_u32 s81, s81, s10
    s_lshl_b32 s87, s6, 9
    s_add_u32 s87, s87, s11
    s_add_u32 s6, s6, 1
    s_cmp_eq_u32 s6, 7
    s_cselect_b32 s6, 0, s6
    s_mul_i32 s82, s6, 18432
    s_add_u32 s82, s82, s10
    s_lshl_b32 s88, s6, 9
    s_add_u32 s88, s88, s11
    s_mov_b32 s6, 7
    s_mul_i32 s83, s6, 18432
    s_add_u32 s83, s83, s10
    s_lshl_b32 s89, s6, 9
    s_add_u32 s89, s89, s11
    s_mov_b32 s6, 8
    s_mul_i32 s84, s6, 18432
    s_add_u32 s84, s84, s10
    s_lshl_b32 s90, s6, 9
    s_add_u32 s90, s90, s11
    s_mov_b32 s6, 9
    v_add_u32 v13, 36864, v2
    v_add_u32 v14, 73728, v2
    v_add_u32 v15, 110592, v2
    v_and_b32 v5, 1, v3
    v_mul_u32_u24 v5, 18432, v5
    v_lshl_add_u32 v5, v4, 4, v5
    v_lshrrev_b32 v6, 5, v1
    v_lshl_add_u32 v5, v6, 8, v5
    v_add_u32 v6, 36864, v5
    s_lshr_b32 s14, s3, 1
    s_lshl_b32 s14, s14, 10
    s_and_b32 s15, s3, 1
    s_lshl_b32 s15, s15, 3
    s_add_u32 s14, s14, s15
    v_add_u32 v222, s14, v14
    v_add_u32 v223, s14, v15
    v_lshlrev_b32 v220, 3, v1
    s_mul_i32 s8, s3, 18432
    s_add_u32 s14, s8, 4096
    v_add_u32 v221, s14, v2
    s_add_u32 s62, s62, 0x6c0000
    s_mov_b32 s91, 0
    buffer_load_dwordx4 v[176:179], v12, s[40:43], s91 offen
    buffer_load_dwordx4 v[88:91], v7, s[40:43], s49 offen offset:0
    buffer_load_dwordx4 v[92:95], v7, s[40:43], s49 offen offset:1024
    buffer_load_dwordx4 v[96:99], v7, s[40:43], s49 offen offset:2048
    s_mov_b32 s17, 0
    s_atomic_add s17, s[20:21], s22 glc
    buffer_load_dwordx4 v[100:103], v7, s[40:43], s49 offen offset:3072
    buffer_load_dwordx4 v[104:107], v8, s[40:43], s49 offen offset:0
    buffer_load_dwordx4 v[108:111], v8, s[40:43], s49 offen offset:1024
    buffer_load_dwordx4 v[112:115], v8, s[40:43], s49 offen offset:2048
    buffer_load_dwordx4 v[116:119], v8, s[40:43], s49 offen offset:3072
    s_mov_b32 s18, 262144
    s_waitcnt lgkmcnt(0)
    s_add_u32 s16, s16, 1
    s_max_u32 s16, s16, s17
H2_l:
    s_cmp_ge_u32 s16, s46
    s_cbranch_scc1 H2_b
    s_sub_u32 s18, s18, 1
    s_cbranch_scc1 H2_b
    s_mov_b32 s16, 0
    s_atomic_add s16, s[20:21], s22 glc
    s_waitcnt lgkmcnt(0)
    s_branch H2_l
H2_b:
    s_add_u32 s46, s46, 8
    s_barrier
    s_add_u32 m0, s8, 0
    s_add_u32 s11, s62, 0
    buffer_load_dwordx4 v2, s[40:43], s11 offen sc1 lds
    s_add_u32 m0, s8, 1024
    s_add_u32 s11, s62, 1024
    buffer_load_dwordx4 v2, s[40:43], s11 offen sc1 lds
    s_add_u32 m0, s8, 2048
    s_add_u32 s11, s62, 2048
    buffer_load_dwordx4 v2, s[40:43], s11 offen sc1 lds
    buffer_load_dwordx2 v[160:161], v220, s[40:43], s69 offen offset:0 sc1
    buffer_load_dwordx2 v[162:163], v220, s[40:43], s69 offen offset:512 sc1
    buffer_load_dwordx2 v[164:165], v220, s[40:43], s69 offen offset:1024 sc1
    buffer_load_dwordx2 v[166:167], v220, s[40:43], s69 offen offset:1536 sc1
    buffer_load_dwordx2 v[168:169], v220, s[40:43], s69 offen offset:2048 sc1
    buffer_load_dwordx2 v[170:171], v220, s[40:43], s69 offen offset:2560 sc1
    buffer_load_dwordx2 v[172:173], v220, s[40:43], s69 offen offset:3072 sc1
    buffer_load_dwordx2 v[174:175], v220, s[40:43], s69 offen offset:3584 sc1
    s_add_u32 m0, s8, 3072
    s_add_u32 s11, s62, 3072
    buffer_load_dwordx4 v2, s[40:43], s11 offen sc1 lds
    s_add_u32 m0, s8, 4096
    s_add_u32 s11, s62, 4096
    buffer_load_dwordx4 v2, s[40:43], s11 offen sc1 lds
    s_add_u32 m0, s8, 5120
    s_add_u32 s11, s62, 5120
    buffer_load_dwordx4 v2, s[40:43], s11 offen sc1 lds
    s_add_u32 m0, s8, 6144
    s_add_u32 s11, s62, 6144
    buffer_load_dwordx4 v2, s[40:43], s11 offen sc1 lds
    s_add_u32 m0, s8, 7168
    s_add_u32 s11, s62, 7168
    buffer_load_dwordx4 v2, s[40:43], s11 offen sc1 lds
    s_add_u32 m0, s8, 8192
    s_add_u32 s11, s62, 8192
    buffer_load_dwordx4 v2, s[40:43], s11 offen sc1 lds
    s_add_u32 m0, s8, 9216
    s_add_u32 s11, s62, 9216
    buffer_load_dwordx4 v2, s[40:43], s11 offen sc1 lds
    s_add_u32 m0, s8, 10240
    s_add_u32 s11, s62, 10240
    buffer_load_dwordx4 v2, s[40:43], s11 offen sc1 lds
    s_add_u32 m0, s8, 11264
    s_add_u32 s11, s62, 11264
    buffer_load_dwordx4 v2, s[40:43], s11 offen sc1 lds
    s_add_u32 m0, s8, 12288
    s_add_u32 s11, s62, 12288
    buffer_load_dwordx4 v2, s[40:43], s11 offen sc1 lds
    s_add_u32 m0, s8, 13312
    s_add_u32 s11, s62, 13312
    buffer_load_dwordx4 v2, s[40:43], s11 offen sc1 lds
    s_waitcnt vmcnt(19)
    s_barrier
    ds_read_b128 a[0:3], v2 offset:0
    ds_read_b128 a[4:7], v2 offset:18432
    ds_read_b128 a[8:11], v13 offset:0
    ds_read_b128 a[12:15], v13 offset:18432
    ds_read_b128 a[16:19], v2 offset:1024
    ds_read_b128 a[20:23], v2 offset:19456
    ds_read_b128 a[24:27], v13 offset:1024
    ds_read_b128 a[28:31], v13 offset:19456
    ds_read_b128 a[32:35], v2 offset:2048
    ds_read_b128 a[36:39], v2 offset:20480
    ds_read_b128 a[40:43], v13 offset:2048
    ds_read_b128 a[44:47], v13 offset:20480
    s_waitcnt vmcnt(6)
    s_barrier
    s_waitcnt lgkmcnt(8)
    v_mfma_f32_16x16x32_bf16 v[144:147], v[16:19], a[0:3], 0
    ds_read_b128 a[48:51], v2 offset:3072
    s_add_u32 m0, s8, 14336
    s_add_u32 s11, s62, 14336
    buffer_load_dwordx4 v2, s[40:43], s11 offen sc1 lds
    v_mfma_f32_16x16x32_bf16 v[148:151], v[16:19], a[4:7], 0
    ds_read_b128 a[52:55], v2 offset:21504
    v_mfma_f32_16x16x32_bf16 v[152:155], v[16:19], a[8:11], 0
    ds_read_b128 a[56:59], v13 offset:3072
    s_add_u32 m0, s8, 15360
    s_add_u32 s11, s62, 15360
    buffer_load_dwordx4 v2, s[40:43], s11 offen sc1 lds
    v_mfma_f32_16x16x32_bf16 v[156:159], v[16:19], a[12:15], 0
    ds_read_b128 a[60:63], v13 offset:21504
    s_waitcnt lgkmcnt(8)
    v_mfma_f32_16x16x32_bf16 v[144:147], v[20:23], a[16:19], v[144:147]
    ds_read_b128 a[64:67], v2 offset:4096
    s_add_u32 m0, s8, 16384
    s_add_u32 s11, s62, 16384
    buffer_load_dwordx4 v2, s[40:43], s11 offen sc1 lds
    v_mfma_f32_16x16x32_bf16 v[148:151], v[20:23], a[20:23], v[148:151]
    ds_read_b128 a[68:71], v2 offset:22528
    v_mfma_f32_16x16x32_bf16 v[152:155], v[20:23], a[24:27], v[152:155]
    ds_read_b128 a[72:75], v13 offset:4096
    s_add_u32 m0, s8, 17408
    s_add_u32 s11, s62, 17408
    buffer_load_dwordx4 v2, s[40:43], s11 offen sc1 lds
    v_mfma_f32_16x16x32_bf16 v[156:159], v[20:23], a[28:31], v[156:159]
    ds_read_b128 a[76:79], v13 offset:22528
    s_waitcnt lgkmcnt(8)
    v_mfma_f32_16x16x32_bf16 v[144:147], v[24:27], a[32:35], v[144:147]
    ds_read_b128 a[80:83], v2 offset:5120
    v_mfma_f32_16x16x32_bf16 v[148:151], v[24:27], a[36:39], v[148:151]
    ds_read_b128 a[84:87], v2 offset:23552
    buffer_load_dwordx4 v[16:19], v10, s[40:43], s49 offen offset:2048
    v_mfma_f32_16x16x32_bf16 v[152:155], v[24:27], a[40:43], v[152:155]
    ds_read_b128 a[88:91], v13 offset:5120
    v_mfma_f32_16x16x32_bf16 v[156:159], v[24:27], a[44:47], v[156:159]
    ds_read_b128 a[92:95], v13 offset:23552
    buffer_load_dwordx4 v[20:23], v10, s[40:43], s49 offen offset:3072
    s_waitcnt lgkmcnt(8)
    v_mfma_f32_16x16x32_bf16 v[144:147], v[28:31], a[48:51], v[144:147]
    ds_read_b128 a[96:99], v2 offset:6144
    v_add_f32 v180, v160, v162
    v_add_f32 v181, v161, v163
    v_mfma_f32_16x16x32_bf16 v[148:151], v[28:31], a[52:55], v[148:151]
    ds_read_b128 a[100:103], v2 offset:24576
    buffer_load_dwordx4 v[24:27], v11, s[40:43], s49 offen offset:0
    v_add_f32 v180, v180, v164
    v_add_f32 v181, v181, v165
    v_mfma_f32_16x16x32_bf16 v[152:155], v[28:31], a[56:59], v[152:155]
    ds_read_b128 a[104:107], v13 offset:6144
    v_add_f32 v180, v180, v166
    v_add_f32 v181, v181, v167
    v_mfma_f32_16x16x32_bf16 v[156:159], v[28:31], a[60:63], v[156:159]
    ds_read_b128 a[108:111], v13 offset:24576
    buffer_load_dwordx4 v[28:31], v11, s[40:43], s49 offen offset:1024
    v_add_f32 v180, v180, v168
    v_add_f32 v181, v181, v169
    s_waitcnt lgkmcnt(8)
    v_mfma_f32_16x16x32_bf16 v[144:147], v[32:35], a[64:67], v[144:147]
    ds_read_b128 a[112:115], v2 offset:7168
    v_add_f32 v180, v180, v170
    v_add_f32 v181, v181, v171
    v_mfma_f32_16x16x32_bf16 v[148:151], v[32:35], a[68:71], v[148:151]
    ds_read_b128 a[116:119], v2 offset:25600
    v_add_f32 v180, v180, v172
    v_add_f32 v181, v181, v173
    v_mfma_f32_16x16x32_bf16 v[152:155], v[32:35], a[72:75], v[152:155]
    ds_read_b128 a[120:123], v13 offset:7168
    v_add_f32 v180, v180, v174
    v_add_f32 v181, v181, v175
    v_mfma_f32_16x16x32_bf16 v[156:159], v[32:35], a[76:79], v[156:159]
    ds_read_b128 a[124:127], v13 offset:25600
    buffer_load_dwordx4 v[32:35], v7, s[40:43], s50 offen offset:0
    v_mul_f32 v180, 0x3e000000, v180
    v_mul_f32 v181, 0x3c638e39, v181
    s_waitcnt vmcnt(10)
    s_barrier
    s_waitcnt lgkmcnt(8)
    s_cmp_lg_u32 s45, 0
    s_cbranch_scc1 W2_b
    buffer_store_dwordx4 v[240:243], v2, s[40:43], s26 offen sc1
    s_add_u32 s26, s26, 18432
    buffer_store_dwordx4 v[244:247], v2, s[40:43], s26 offen sc1
    s_add_u32 s26, s26, 18432
    buffer_store_dwordx4 v[248:251], v2, s[40:43], s26 offen sc1
    s_add_u32 s26, s26, 18432
    buffer_store_dwordx4 v[252:255], v2, s[40:43], s26 offen sc1
    s_add_u32 s26, s26, 18432
W2_b:
    v_mfma_f32_16x16x32_bf16 v[144:147], v[36:39], a[80:83], v[144:147]
    ds_read_b128 a[128:131], v2 offset:8192
    v_sub_f32 v160, v160, v180
    v_sub_f32 v162, v162, v180
    v_mfma_f32_16x16x32_bf16 v[148:151], v[36:39], a[84:87], v[148:151]
    ds_read_b128 a[132:135], v2 offset:26624
    v_sub_f32 v164, v164, v180
    v_sub_f32 v166, v166, v180
    v_mfma_f32_16x16x32_bf16 v[152:155], v[36:39], a[88:91], v[152:155]
    ds_read_b128 a[136:139], v13 offset:8192
    v_sub_f32 v168, v168, v180
    v_sub_f32 v170, v170, v180
    v_mfma_f32_16x16x32_bf16 v[156:159], v[36:39], a[92:95], v[156:159]
    ds_read_b128 a[140:143], v13 offset:26624
    buffer_load_dwordx4 v[36:39], v7, s[40:43], s50 offen offset:1024
    v_sub_f32 v172, v172, v180
    v_sub_f32 v174, v174, v180
    s_waitcnt lgkmcnt(8)
    v_mfma_f32_16x16x32_bf16 v[144:147], v[40:43], a[96:99], v[144:147]
    ds_read_b128 a[144:147], v2 offset:9216
    v_fmac_f32 v181, v160, v160
    v_fmac_f32 v181, v162, v162
    v_mfma_f32_16x16x32_bf16 v[148:151], v[40:43], a[100:103], v[148:151]
    ds_read_b128 a[148:151], v2 offset:27648
    v_fmac_f32 v181, v164, v164
    v_fmac_f32 v181, v166, v166
    v_mfma_f32_16x16x32_bf16 v[152:155], v[40:43], a[104:107], v[152:155]
    ds_read_b128 a[152:155], v13 offset:9216
    v_fmac_f32 v181, v168, v168
    v_fmac_f32 v181, v170, v170
    v_mfma_f32_16x16x32_bf16 v[156:159], v[40:43], a[108:111], v[156:159]
    ds_read_b128 a[156:159], v13 offset:27648
    buffer_load_dwordx4 v[40:43], v7, s[40:43], s50 offen offset:2048
    v_fmac_f32 v181, v172, v172
    v_fmac_f32 v181, v174, v174
    s_waitcnt lgkmcnt(8)
    v_mfma_f32_16x16x32_bf16 v[144:147], v[44:47], a[112:115], v[144:147]
    ds_read_b128 a[160:163], v2 offset:10240
    v_mul_f32 v181, 0x3e000000, v181
    v_cvt_pk_bf16_f32 v182, v181, v180
    v_mfma_f32_16x16x32_bf16 v[148:151], v[44:47], a[116:119], v[148:151]
    ds_read_b128 a[164:167], v2 offset:28672
    v_lshlrev_b32 v183, 16, v182
    v_and_b32 v182, 0xffff0000, v182
    v_mfma_f32_16x16x32_bf16 v[152:155], v[44:47], a[120:123], v[152:155]
    ds_read_b128 a[168:171], v13 offset:10240
    v_add_f32 v183, 0x3727c5ac, v183
    v_cvt_pk_bf16_f32 v183, v183, v183
    v_mfma_f32_16x16x32_bf16 v[156:159], v[44:47], a[124:127], v[156:159]
    ds_read_b128 a[172:175], v13 offset:28672
    buffer_load_dwordx4 v[44:47], v7, s[40:43], s50 offen offset:3072
    v_and_b32 v183, 0xffff0000, v183
    v_sqrt_f32 v183, v183
    s_waitcnt lgkmcnt(8)
    v_mfma_f32_16x16x32_bf16 v[144:147], v[48:51], a[128:131], v[144:147]
    ds_read_b128 a[176:179], v2 offset:11264
    v_cvt_pk_bf16_f32 v183, v183, v183
    v_and_b32 v183, 0xffff0000, v183
    v_mfma_f32_16x16x32_bf16 v[148:151], v[48:51], a[132:135], v[148:151]
    ds_read_b128 a[180:183], v2 offset:29696
    v_rcp_f32 v186, v183
    v_mfma_f32_16x16x32_bf16 v[152:155], v[48:51], a[136:139], v[152:155]
    ds_read_b128 a[184:187], v13 offset:11264
    v_sub_f32 v180, v180, v182
    v_mul_f32 v180, v180, v186
    v_mfma_f32_16x16x32_bf16 v[156:159], v[48:51], a[140:143], v[156:159]
    ds_read_b128 a[188:191], v13 offset:29696
    buffer_load_dwordx4 v[48:51], v8, s[40:43], s50 offen offset:0
    v_mul_f32 v181, v181, v186
    v_mul_f32 v181, v181, v186
    s_waitcnt lgkmcnt(8)
    v_mfma_f32_16x16x32_bf16 v[144:147], v[52:55], a[144:147], v[144:147]
    ds_read_b128 a[192:195], v2 offset:12288
    v_cvt_pk_bf16_f32 v184, v181, v180
    v_lshlrev_b32 v185, 16, v184
    v_mfma_f32_16x16x32_bf16 v[148:151], v[52:55], a[148:151], v[148:151]
    ds_read_b128 a[196:199], v2 offset:30720
    v_and_b32 v184, 0xffff0000, v184
    v_add_f32 v185, 0x3727c5ac, v185
    v_mfma_f32_16x16x32_bf16 v[152:155], v[52:55], a[152:155], v[152:155]
    ds_read_b128 a[200:203], v13 offset:12288
    v_cvt_pk_bf16_f32 v185, v185, v185
    v_and_b32 v185, 0xffff0000, v185
    v_mfma_f32_16x16x32_bf16 v[156:159], v[52:55], a[156:159], v[156:159]
    ds_read_b128 a[204:207], v13 offset:30720
    buffer_load_dwordx4 v[52:55], v8, s[40:43], s50 offen offset:1024
    v_sqrt_f32 v185, v185
    s_nop 0
    v_cvt_pk_bf16_f32 v185, v185, v185
    s_waitcnt vmcnt(10)
    s_barrier
    s_waitcnt lgkmcnt(8)
    v_mfma_f32_16x16x32_bf16 v[144:147], v[56:59], a[160:163], v[144:147]
    ds_read_b128 a[208:211], v2 offset:13312
    v_and_b32 v185, 0xffff0000, v185
    v_fmac_f32 v182, v184, v183
    v_mfma_f32_16x16x32_bf16 v[148:151], v[56:59], a[164:167], v[148:151]
    ds_read_b128 a[212:215], v2 offset:31744
    v_mul_f32 v183, v183, v185
    v_mfma_f32_16x16x32_bf16 v[152:155], v[56:59], a[168:171], v[152:155]
    ds_read_b128 a[216:219], v13 offset:13312
    v_cvt_pk_bf16_f32 v188, v182, v183
    v_lshlrev_b32 v190, 16, v188
    v_mfma_f32_16x16x32_bf16 v[156:159], v[56:59], a[172:175], v[156:159]
    ds_read_b128 a[220:223], v13 offset:31744
    buffer_load_dwordx4 v[56:59], v8, s[40:43], s50 offen offset:2048
    v_sub_f32 v190, v182, v190
    v_cvt_pk_bf16_f32 v187, v182, v190
    s_waitcnt lgkmcnt(8)
    v_mfma_f32_16x16x32_bf16 v[144:147], v[60:63], a[176:179], v[144:147]
    ds_read_b128 a[224:227], v2 offset:14336
    v_and_b32 v190, 0xffff0000, v188
    v_sub_f32 v190, v183, v190
    v_mfma_f32_16x16x32_bf16 v[148:151], v[60:63], a[180:183], v[148:151]
    ds_read_b128 a[228:231], v2 offset:32768
    v_cvt_pk_bf16_f32 v189, v182, v190
    v_cmp_eq_u32 vcc, 0, v3
    v_mfma_f32_16x16x32_bf16 v[152:155], v[60:63], a[184:187], v[152:155]
    ds_read_b128 a[232:235], v13 offset:14336
    v_cndmask_b32 v204, 0, v187, vcc
    v_cndmask_b32 v205, 0, v188, vcc
    v_mfma_f32_16x16x32_bf16 v[156:159], v[60:63], a[188:191], v[156:159]
    ds_read_b128 a[236:239], v13 offset:32768
    buffer_load_dwordx4 v[60:63], v8, s[40:43], s50 offen offset:3072
    v_cndmask_b32 v206, 0, v187, vcc
    v_cndmask_b32 v207, 0, v189, vcc
    s_waitcnt lgkmcnt(8)
    v_mfma_f32_16x16x32_bf16 v[144:147], v[64:67], a[192:195], v[144:147]
    ds_read_b128 a[240:243], v2 offset:15360
    v_cmp_eq_u32 vcc, 1, v3
    s_nop 1
    v_cndmask_b32 v208, 0, v187, vcc
    v_mfma_f32_16x16x32_bf16 v[148:151], v[64:67], a[196:199], v[148:151]
    ds_read_b128 a[244:247], v2 offset:33792
    v_cndmask_b32 v209, 0, v188, vcc
    v_cndmask_b32 v210, 0, v187, vcc
    v_mfma_f32_16x16x32_bf16 v[152:155], v[64:67], a[200:203], v[152:155]
    ds_read_b128 a[248:251], v13 offset:15360
    v_cndmask_b32 v211, 0, v189, vcc
    v_cmp_eq_u32 vcc, 2, v3
    v_mfma_f32_16x16x32_bf16 v[156:159], v[64:67], a[204:207], v[156:159]
    ds_read_b128 a[252:255], v13 offset:33792
    buffer_load_dwordx4 v[64:67], v9, s[40:43], s50 offen offset:0
    v_cndmask_b32 v212, 0, v187, vcc
    v_cndmask_b32 v213, 0, v188, vcc
    s_waitcnt lgkmcnt(8)
    v_mfma_f32_16x16x32_bf16 v[144:147], v[68:71], a[208:211], v[144:147]
    ds_read_b128 v[224:227], v2 offset:16384
    v_cndmask_b32 v214, 0, v187, vcc
    v_cndmask_b32 v215, 0, v189, vcc
    v_mfma_f32_16x16x32_bf16 v[148:151], v[68:71], a[212:215], v[148:151]
    ds_read_b128 v[228:231], v2 offset:34816
    v_cmp_eq_u32 vcc, 3, v3
    s_nop 1
    v_cndmask_b32 v216, 0, v187, vcc
    v_mfma_f32_16x16x32_bf16 v[152:155], v[68:71], a[216:219], v[152:155]
    ds_read_b128 v[232:235], v13 offset:16384
    v_cndmask_b32 v217, 0, v188, vcc
    v_cndmask_b32 v218, 0, v187, vcc
    v_mfma_f32_16x16x32_bf16 v[156:159], v[68:71], a[220:223], v[156:159]
    ds_read_b128 v[236:239], v13 offset:34816
    buffer_load_dwordx4 v[68:71], v9, s[40:43], s50 offen offset:1024
    v_cndmask_b32 v219, 0, v189, vcc
    v_mov_b32 v200, v183
    s_waitcnt lgkmcnt(8)
    v_mfma_f32_16x16x32_bf16 v[144:147], v[72:75], a[224:227], v[144:147]
    ds_read_b128 v[240:243], v2 offset:17408
    v_mov_b32 v202, v183
    s_nop 1
    v_permlane32_swap_b32 v200, v202
    v_mfma_f32_16x16x32_bf16 v[148:151], v[72:75], a[228:231], v[148:151]
    ds_read_b128 v[244:247], v2 offset:35840
    v_mov_b32 v201, v200
    v_mov_b32 v203, v202
    v_mfma_f32_16x16x32_bf16 v[152:155], v[72:75], a[232:235], v[152:155]
    ds_read_b128 v[248:251], v13 offset:17408
    v_permlane16_swap_b32 v200, v201
    v_permlane16_swap_b32 v202, v203
    v_mfma_f32_16x16x32_bf16 v[156:159], v[72:75], a[236:239], v[156:159]
    ds_read_b128 v[252:255], v13 offset:35840
    buffer_load_dwordx4 v[72:75], v9, s[40:43], s50 offen offset:2048
    v_rcp_f32 v192, v200
    s_waitcnt lgkmcnt(8)
    v_mfma_f32_16x16x32_bf16 v[144:147], v[76:79], a[240:243], v[144:147]
    v_rcp_f32 v193, v201
    v_mfma_f32_16x16x32_bf16 v[148:151], v[76:79], a[244:247], v[148:151]
    v_rcp_f32 v194, v202
    v_mfma_f32_16x16x32_bf16 v[152:155], v[76:79], a[248:251], v[152:155]
    v_rcp_f32 v195, v203
    v_mfma_f32_16x16x32_bf16 v[156:159], v[76:79], a[252:255], v[156:159]
    buffer_load_dwordx4 v[76:79], v9, s[40:43], s50 offen offset:3072
    v_mul_f32 v196, v192, v192
    v_mul_f32 v192, 0xc0135761, v192
    s_waitcnt lgkmcnt(4)
    v_mfma_f32_16x16x32_bf16 v[144:147], v[80:83], v[224:227], v[144:147]
    v_mul_f32 v196, v196, v192
    v_mul_f32 v196, 0x3d372713, v196
    v_mfma_f32_16x16x32_bf16 v[148:151], v[80:83], v[228:231], v[148:151]
    v_mul_f32 v197, v193, v193
    v_mul_f32 v193, 0xc0135761, v193
    v_mfma_f32_16x16x32_bf16 v[152:155], v[80:83], v[232:235], v[152:155]
    v_mul_f32 v197, v197, v193
    v_mul_f32 v197, 0x3d372713, v197
    v_mfma_f32_16x16x32_bf16 v[156:159], v[80:83], v[236:239], v[156:159]
    buffer_load_dwordx4 v[80:83], v10, s[40:43], s50 offen offset:0
    v_mul_f32 v198, v194, v194
    v_mul_f32 v194, 0xc0135761, v194
    s_waitcnt lgkmcnt(0)
    v_mfma_f32_16x16x32_bf16 v[144:147], v[84:87], v[240:243], v[144:147]
    v_mul_f32 v198, v198, v194
    v_mul_f32 v198, 0x3d372713, v198
    v_mfma_f32_16x16x32_bf16 v[148:151], v[84:87], v[244:247], v[148:151]
    v_mul_f32 v199, v195, v195
    v_mul_f32 v195, 0xc0135761, v195
    v_mfma_f32_16x16x32_bf16 v[152:155], v[84:87], v[248:251], v[152:155]
    v_mul_f32 v199, v199, v195
    v_mul_f32 v199, 0x3d372713, v199
    v_mfma_f32_16x16x32_bf16 v[156:159], v[84:87], v[252:255], v[156:159]
    buffer_load_dwordx4 v[84:87], v10, s[40:43], s50 offen offset:1024
    v_mfma_f32_16x16x32_bf16 v[160:163], v[176:179], v[204:207], v[144:147]
    v_mfma_f32_16x16x32_bf16 v[164:167], v[176:179], v[208:211], v[148:151]
    v_mfma_f32_16x16x32_bf16 v[168:171], v[176:179], v[212:215], v[152:155]
    v_mfma_f32_16x16x32_bf16 v[172:175], v[176:179], v[216:219], v[156:159]
    s_add_u32 s91, s91, 1024
    buffer_load_dwordx4 v[176:179], v12, s[40:43], s91 offen
    s_waitcnt vmcnt(13)
    s_waitcnt lgkmcnt(0)
    s_add_u32 s23, s4, 256
    s_mul_i32 s23, s23, 128
    s_cmp_lg_u32 s45, 0
    s_cbranch_scc1 W2_c
    s_atomic_add s27, s[20:21], s23
W2_c:
    v_mfma_f32_16x16x32_bf16 v[144:147], v[88:91], a[0:3], 0
    v_mul_f32 v180, v160, v160
    v_mul_f32 v181, v161, v161
    v_mfma_f32_16x16x32_bf16 v[148:151], v[88:91], a[4:7], 0
    v_mul_f32 v182, v162, v162
    v_mul_f32 v183, v163, v163
    v_mfma_f32_16x16x32_bf16 v[152:155], v[88:91], a[8:11], 0
    v_fma_f32 v180, v180, v196, v192
    v_fma_f32 v181, v181, v196, v192
    v_mfma_f32_16x16x32_bf16 v[156:159], v[88:91], a[12:15], 0
    buffer_load_dwordx4 v[88:91], v10, s[40:43], s50 offen offset:2048
    v_fma_f32 v182, v182, v196, v192
    v_fma_f32 v183, v183, v196, v192
    v_mfma_f32_16x16x32_bf16 v[144:147], v[92:95], a[16:19], v[144:147]
    v_mul_f32 v180, v180, v160
    v_mul_f32 v181, v181, v161
    v_mfma_f32_16x16x32_bf16 v[148:151], v[92:95], a[20:23], v[148:151]
    v_mul_f32 v182, v182, v162
    v_mul_f32 v183, v183, v163
    v_mfma_f32_16x16x32_bf16 v[152:155], v[92:95], a[24:27], v[152:155]
    v_exp_f32 v180, v180
    v_mfma_f32_16x16x32_bf16 v[156:159], v[92:95], a[28:31], v[156:159]
    buffer_load_dwordx4 v[92:95], v10, s[40:43], s50 offen offset:3072
    v_exp_f32 v181, v181
    v_mfma_f32_16x16x32_bf16 v[144:147], v[96:99], a[32:35], v[144:147]
    v_exp_f32 v182, v182
    v_mfma_f32_16x16x32_bf16 v[148:151], v[96:99], a[36:39], v[148:151]
    v_exp_f32 v183, v183
    v_fma_f32 v180, v180, v200, v200
    v_mfma_f32_16x16x32_bf16 v[152:155], v[96:99], a[40:43], v[152:155]
    v_fma_f32 v181, v181, v200, v200
    v_fma_f32 v182, v182, v200, v200
    v_mfma_f32_16x16x32_bf16 v[156:159], v[96:99], a[44:47], v[156:159]
    buffer_load_dwordx4 v[96:99], v11, s[40:43], s50 offen offset:0
    v_fma_f32 v183, v183, v200, v200
    v_mfma_f32_16x16x32_bf16 v[144:147], v[100:103], a[48:51], v[144:147]
    v_rcp_f32 v180, v180
    v_rcp_f32 v181, v181
    v_mfma_f32_16x16x32_bf16 v[148:151], v[100:103], a[52:55], v[148:151]
    v_rcp_f32 v182, v182
    v_mfma_f32_16x16x32_bf16 v[152:155], v[100:103], a[56:59], v[152:155]
    v_rcp_f32 v183, v183
    v_mfma_f32_16x16x32_bf16 v[156:159], v[100:103], a[60:63], v[156:159]
    buffer_load_dwordx4 v[100:103], v11, s[40:43], s50 offen offset:1024
    v_mul_f32 v180, v180, v160
    v_mfma_f32_16x16x32_bf16 v[144:147], v[104:107], a[64:67], v[144:147]
    v_mul_f32 v181, v181, v161
    v_mul_f32 v182, v182, v162
    v_mfma_f32_16x16x32_bf16 v[148:151], v[104:107], a[68:71], v[148:151]
    v_mul_f32 v183, v183, v163
    v_cvt_pk_bf16_f32 v184, v180, v181
    v_mfma_f32_16x16x32_bf16 v[152:155], v[104:107], a[72:75], v[152:155]
    v_cvt_pk_bf16_f32 v185, v182, v183
    ds_write_b64 v222, v[184:185] offset:0
    v_mul_f32 v186, v164, v164
    v_mfma_f32_16x16x32_bf16 v[156:159], v[104:107], a[76:79], v[156:159]
    buffer_load_dwordx4 v[104:107], v7, s[40:43], s51 offen offset:0
    v_mul_f32 v187, v165, v165
    v_mul_f32 v188, v166, v166
    v_mfma_f32_16x16x32_bf16 v[144:147], v[108:111], a[80:83], v[144:147]
    v_mul_f32 v189, v167, v167
    v_fma_f32 v186, v186, v197, v193
    v_mfma_f32_16x16x32_bf16 v[148:151], v[108:111], a[84:87], v[148:151]
    v_fma_f32 v187, v187, v197, v193
    v_fma_f32 v188, v188, v197, v193
    v_mfma_f32_16x16x32_bf16 v[152:155], v[108:111], a[88:91], v[152:155]
    v_fma_f32 v189, v189, v197, v193
    v_mul_f32 v186, v186, v164
    v_mfma_f32_16x16x32_bf16 v[156:159], v[108:111], a[92:95], v[156:159]
    buffer_load_dwordx4 v[108:111], v7, s[40:43], s51 offen offset:1024
    v_mul_f32 v187, v187, v165
    v_mul_f32 v188, v188, v166
    v_mfma_f32_16x16x32_bf16 v[144:147], v[112:115], a[96:99], v[144:147]
    v_mul_f32 v189, v189, v167
    v_exp_f32 v186, v186
    v_mfma_f32_16x16x32_bf16 v[148:151], v[112:115], a[100:103], v[148:151]
    v_exp_f32 v187, v187
    v_mfma_f32_16x16x32_bf16 v[152:155], v[112:115], a[104:107], v[152:155]
    v_exp_f32 v188, v188
    v_mfma_f32_16x16x32_bf16 v[156:159], v[112:115], a[108:111], v[156:159]
    buffer_load_dwordx4 v[112:115], v7, s[40:43], s51 offen offset:2048
    v_exp_f32 v189, v189
    v_mfma_f32_16x16x32_bf16 v[144:147], v[116:119], a[112:115], v[144:147]
    v_fma_f32 v186, v186, v201, v201
    v_mfma_f32_16x16x32_bf16 v[148:151], v[116:119], a[116:119], v[148:151]
    v_fma_f32 v187, v187, v201, v201
    v_fma_f32 v188, v188, v201, v201
    v_mfma_f32_16x16x32_bf16 v[152:155], v[116:119], a[120:123], v[152:155]
    v_fma_f32 v189, v189, v201, v201
    v_rcp_f32 v186, v186
    v_mfma_f32_16x16x32_bf16 v[156:159], v[116:119], a[124:127], v[156:159]
    buffer_load_dwordx4 v[116:119], v7, s[40:43], s51 offen offset:3072
    v_rcp_f32 v187, v187
    v_mfma_f32_16x16x32_bf16 v[144:147], v[120:123], a[128:131], v[144:147]
    v_rcp_f32 v188, v188
    v_mfma_f32_16x16x32_bf16 v[148:151], v[120:123], a[132:135], v[148:151]
    v_rcp_f32 v189, v189
    v_mfma_f32_16x16x32_bf16 v[152:155], v[120:123], a[136:139], v[152:155]
    v_mul_f32 v186, v186, v164
    v_mul_f32 v187, v187, v165
    v_mfma_f32_16x16x32_bf16 v[156:159], v[120:123], a[140:143], v[156:159]
    buffer_load_dwordx4 v[120:123], v8, s[40:43], s51 offen offset:0
    v_mul_f32 v188, v188, v166
    v_mul_f32 v189, v189, v167
    v_mfma_f32_16x16x32_bf16 v[144:147], v[124:127], a[144:147], v[144:147]
    v_cvt_pk_bf16_f32 v190, v186, v187
    v_cvt_pk_bf16_f32 v191, v188, v189
    v_mfma_f32_16x16x32_bf16 v[148:151], v[124:127], a[148:151], v[148:151]
    ds_write_b64 v222, v[190:191] offset:18432
    v_mul_f32 v180, v168, v168
    v_mfma_f32_16x16x32_bf16 v[152:155], v[124:127], a[152:155], v[152:155]
    v_mul_f32 v181, v169, v169
    v_mul_f32 v182, v170, v170
    v_mfma_f32_16x16x32_bf16 v[156:159], v[124:127], a[156:159], v[156:159]
    buffer_load_dwordx4 v[124:127], v8, s[40:43], s51 offen offset:1024
    v_mul_f32 v183, v171, v171
    v_fma_f32 v180, v180, v198, v194
    v_mfma_f32_16x16x32_bf16 v[144:147], v[128:131], a[160:163], v[144:147]
    v_fma_f32 v181, v181, v198, v194
    v_fma_f32 v182, v182, v198, v194
    v_mfma_f32_16x16x32_bf16 v[148:151], v[128:131], a[164:167], v[148:151]
    v_fma_f32 v183, v183, v198, v194
    v_mul_f32 v180, v180, v168
    v_mfma_f32_16x16x32_bf16 v[152:155], v[128:131], a[168:171], v[152:155]
    v_mul_f32 v181, v181, v169
    v_mul_f32 v182, v182, v170
    v_mfma_f32_16x16x32_bf16 v[156:159], v[128:131], a[172:175], v[156:159]
    buffer_load_dwordx4 v[128:131], v8, s[40:43], s51 offen offset:2048
    v_mul_f32 v183, v183, v171
    v_exp_f32 v180, v180
    v_mfma_f32_16x16x32_bf16 v[144:147], v[132:135], a[176:179], v[144:147]
    v_exp_f32 v181, v181
    v_mfma_f32_16x16x32_bf16 v[148:151], v[132:135], a[180:183], v[148:151]
    v_exp_f32 v182, v182
    v_mfma_f32_16x16x32_bf16 v[152:155], v[132:135], a[184:187], v[152:155]
    v_exp_f32 v183, v183
    v_mfma_f32_16x16x32_bf16 v[156:159], v[132:135], a[188:191], v[156:159]
    buffer_load_dwordx4 v[132:135], v8, s[40:43], s51 offen offset:3072
    v_fma_f32 v180, v180, v202, v202
    v_fma_f32 v181, v181, v202, v202
    v_mfma_f32_16x16x32_bf16 v[144:147], v[136:139], a[192:195], v[144:147]
    v_fma_f32 v182, v182, v202, v202
    v_fma_f32 v183, v183, v202, v202
    v_mfma_f32_16x16x32_bf16 v[148:151], v[136:139], a[196:199], v[148:151]
    v_rcp_f32 v180, v180
    v_mfma_f32_16x16x32_bf16 v[152:155], v[136:139], a[200:203], v[152:155]
    v_rcp_f32 v181, v181
    v_mfma_f32_16x16x32_bf16 v[156:159], v[136:139], a[204:207], v[156:159]
    buffer_load_dwordx4 v[136:139], v9, s[40:43], s51 offen offset:0
    v_rcp_f32 v182, v182
    v_mfma_f32_16x16x32_bf16 v[144:147], v[140:143], a[208:211], v[144:147]
    v_rcp_f32 v183, v183
    v_mfma_f32_16x16x32_bf16 v[148:151], v[140:143], a[212:215], v[148:151]
    v_mul_f32 v180, v180, v168
    v_mul_f32 v181, v181, v169
    v_mfma_f32_16x16x32_bf16 v[152:155], v[140:143], a[216:219], v[152:155]
    v_mul_f32 v182, v182, v170
    v_mul_f32 v183, v183, v171
    v_mfma_f32_16x16x32_bf16 v[156:159], v[140:143], a[220:223], v[156:159]
    buffer_load_dwordx4 v[140:143], v9, s[40:43], s51 offen offset:1024
    v_cvt_pk_bf16_f32 v184, v180, v181
    v_cvt_pk_bf16_f32 v185, v182, v183
    v_mfma_f32_16x16x32_bf16 v[144:147], v[16:19], a[224:227], v[144:147]
    ds_write_b64 v223, v[184:185] offset:0
    v_mul_f32 v186, v172, v172
    v_mul_f32 v187, v173, v173
    v_mfma_f32_16x16x32_bf16 v[148:151], v[16:19], a[228:231], v[148:151]
    v_mul_f32 v188, v174, v174
    v_mul_f32 v189, v175, v175
    v_mfma_f32_16x16x32_bf16 v[152:155], v[16:19], a[232:235], v[152:155]
    v_fma_f32 v186, v186, v199, v195
    v_fma_f32 v187, v187, v199, v195
    v_mfma_f32_16x16x32_bf16 v[156:159], v[16:19], a[236:239], v[156:159]
    buffer_load_dwordx4 v[16:19], v9, s[40:43], s51 offen offset:2048
    v_fma_f32 v188, v188, v199, v195
    v_fma_f32 v189, v189, v199, v195
    v_mfma_f32_16x16x32_bf16 v[144:147], v[20:23], a[240:243], v[144:147]
    v_mul_f32 v186, v186, v172
    v_mul_f32 v187, v187, v173
    v_mfma_f32_16x16x32_bf16 v[148:151], v[20:23], a[244:247], v[148:151]
    v_mul_f32 v188, v188, v174
    v_mul_f32 v189, v189, v175
    v_mfma_f32_16x16x32_bf16 v[152:155], v[20:23], a[248:251], v[152:155]
    v_exp_f32 v186, v186
    v_mfma_f32_16x16x32_bf16 v[156:159], v[20:23], a[252:255], v[156:159]
    buffer_load_dwordx4 v[20:23], v9, s[40:43], s51 offen offset:3072
    v_exp_f32 v187, v187
    v_mfma_f32_16x16x32_bf16 v[144:147], v[24:27], v[224:227], v[144:147]
    v_exp_f32 v188, v188
    v_mfma_f32_16x16x32_bf16 v[148:151], v[24:27], v[228:231], v[148:151]
    v_exp_f32 v189, v189
    v_mfma_f32_16x16x32_bf16 v[152:155], v[24:27], v[232:235], v[152:155]
    v_fma_f32 v186, v186, v203, v203
    v_fma_f32 v187, v187, v203, v203
    v_mfma_f32_16x16x32_bf16 v[156:159], v[24:27], v[236:239], v[156:159]
    buffer_load_dwordx4 v[24:27], v10, s[40:43], s51 offen offset:0
    v_fma_f32 v188, v188, v203, v203
    v_fma_f32 v189, v189, v203, v203
    v_mfma_f32_16x16x32_bf16 v[144:147], v[28:31], v[240:243], v[144:147]
    v_rcp_f32 v186, v186
    v_mfma_f32_16x16x32_bf16 v[148:151], v[28:31], v[244:247], v[148:151]
    v_rcp_f32 v187, v187
    v_mfma_f32_16x16x32_bf16 v[152:155], v[28:31], v[248:251], v[152:155]
    v_rcp_f32 v188, v188
    v_mfma_f32_16x16x32_bf16 v[156:159], v[28:31], v[252:255], v[156:159]
    buffer_load_dwordx4 v[28:31], v10, s[40:43], s51 offen offset:1024
    v_rcp_f32 v189, v189
    v_mul_f32 v186, v186, v172
    s_waitcnt vmcnt(18)
    v_mfma_f32_16x16x32_bf16 v[160:163], v[176:179], v[204:207], v[144:147]
    v_mul_f32 v187, v187, v173
    v_mul_f32 v188, v188, v174
    v_mfma_f32_16x16x32_bf16 v[164:167], v[176:179], v[208:211], v[148:151]
    v_mul_f32 v189, v189, v175
    v_cvt_pk_bf16_f32 v190, v186, v187
    v_mfma_f32_16x16x32_bf16 v[168:171], v[176:179], v[212:215], v[152:155]
    v_cvt_pk_bf16_f32 v191, v188, v189
    ds_write_b64 v223, v[190:191] offset:18432
    v_mfma_f32_16x16x32_bf16 v[172:175], v[176:179], v[216:219], v[156:159]
    s_add_u32 s91, s91, 1024
    buffer_load_dwordx4 v[176:179], v12, s[40:43], s91 offen
    v_mfma_f32_16x16x32_bf16 v[144:147], v[32:35], a[0:3], 0
    v_mul_f32 v180, v160, v160
    v_mul_f32 v181, v161, v161
    v_mfma_f32_16x16x32_bf16 v[148:151], v[32:35], a[4:7], 0
    v_mul_f32 v182, v162, v162
    v_mul_f32 v183, v163, v163
    v_mfma_f32_16x16x32_bf16 v[152:155], v[32:35], a[8:11], 0
    v_fma_f32 v180, v180, v196, v192
    v_fma_f32 v181, v181, v196, v192
    v_mfma_f32_16x16x32_bf16 v[156:159], v[32:35], a[12:15], 0
    buffer_load_dwordx4 v[32:35], v10, s[40:43], s51 offen offset:2048
    v_fma_f32 v182, v182, v196, v192
    v_fma_f32 v183, v183, v196, v192
    v_mfma_f32_16x16x32_bf16 v[144:147], v[36:39], a[16:19], v[144:147]
    v_mul_f32 v180, v180, v160
    v_mul_f32 v181, v181, v161
    v_mfma_f32_16x16x32_bf16 v[148:151], v[36:39], a[20:23], v[148:151]
    v_mul_f32 v182, v182, v162
    v_mul_f32 v183, v183, v163
    v_mfma_f32_16x16x32_bf16 v[152:155], v[36:39], a[24:27], v[152:155]
    v_exp_f32 v180, v180
    v_mfma_f32_16x16x32_bf16 v[156:159], v[36:39], a[28:31], v[156:159]
    buffer_load_dwordx4 v[36:39], v10, s[40:43], s51 offen offset:3072
    v_exp_f32 v181, v181
    v_mfma_f32_16x16x32_bf16 v[144:147], v[40:43], a[32:35], v[144:147]
    v_exp_f32 v182, v182
    v_mfma_f32_16x16x32_bf16 v[148:151], v[40:43], a[36:39], v[148:151]
    v_exp_f32 v183, v183
    v_fma_f32 v180, v180, v200, v200
    v_mfma_f32_16x16x32_bf16 v[152:155], v[40:43], a[40:43], v[152:155]
    v_fma_f32 v181, v181, v200, v200
    v_fma_f32 v182, v182, v200, v200
    v_mfma_f32_16x16x32_bf16 v[156:159], v[40:43], a[44:47], v[156:159]
    buffer_load_dwordx4 v[40:43], v11, s[40:43], s51 offen offset:0
    v_fma_f32 v183, v183, v200, v200
    v_mfma_f32_16x16x32_bf16 v[144:147], v[44:47], a[48:51], v[144:147]
    v_rcp_f32 v180, v180
    v_rcp_f32 v181, v181
    v_mfma_f32_16x16x32_bf16 v[148:151], v[44:47], a[52:55], v[148:151]
    v_rcp_f32 v182, v182
    v_mfma_f32_16x16x32_bf16 v[152:155], v[44:47], a[56:59], v[152:155]
    v_rcp_f32 v183, v183
    v_mfma_f32_16x16x32_bf16 v[156:159], v[44:47], a[60:63], v[156:159]
    buffer_load_dwordx4 v[44:47], v11, s[40:43], s51 offen offset:1024
    v_mul_f32 v180, v180, v160
    v_mfma_f32_16x16x32_bf16 v[144:147], v[48:51], a[64:67], v[144:147]
    v_mul_f32 v181, v181, v161
    v_mul_f32 v182, v182, v162
    v_mfma_f32_16x16x32_bf16 v[148:151], v[48:51], a[68:71], v[148:151]
    v_mul_f32 v183, v183, v163
    v_cvt_pk_bf16_f32 v184, v180, v181
    v_mfma_f32_16x16x32_bf16 v[152:155], v[48:51], a[72:75], v[152:155]
    v_cvt_pk_bf16_f32 v185, v182, v183
    ds_write_b64 v222, v[184:185] offset:2048
    v_mul_f32 v186, v164, v164
    v_mfma_f32_16x16x32_bf16 v[156:159], v[48:51], a[76:79], v[156:159]
    buffer_load_dwordx4 v[48:51], v7, s[40:43], s52 offen offset:0
    v_mul_f32 v187, v165, v165
    v_mul_f32 v188, v166, v166
    v_mfma_f32_16x16x32_bf16 v[144:147], v[52:55], a[80:83], v[144:147]
    v_mul_f32 v189, v167, v167
    v_fma_f32 v186, v186, v197, v193
    v_mfma_f32_16x16x32_bf16 v[148:151], v[52:55], a[84:87], v[148:151]
    v_fma_f32 v187, v187, v197, v193
    v_fma_f32 v188, v188, v197, v193
    v_mfma_f32_16x16x32_bf16 v[152:155], v[52:55], a[88:91], v[152:155]
    v_fma_f32 v189, v189, v197, v193
    v_mul_f32 v186, v186, v164
    v_mfma_f32_16x16x32_bf16 v[156:159], v[52:55], a[92:95], v[156:159]
    buffer_load_dwordx4 v[52:55], v7, s[40:43], s52 offen offset:1024
    v_mul_f32 v187, v187, v165
    v_mul_f32 v188, v188, v166
    v_mfma_f32_16x16x32_bf16 v[144:147], v[56:59], a[96:99], v[144:147]
    v_mul_f32 v189, v189, v167
    v_exp_f32 v186, v186
    v_mfma_f32_16x16x32_bf16 v[148:151], v[56:59], a[100:103], v[148:151]
    v_exp_f32 v187, v187
    v_mfma_f32_16x16x32_bf16 v[152:155], v[56:59], a[104:107], v[152:155]
    v_exp_f32 v188, v188
    v_mfma_f32_16x16x32_bf16 v[156:159], v[56:59], a[108:111], v[156:159]
    buffer_load_dwordx4 v[56:59], v7, s[40:43], s52 offen offset:2048
    v_exp_f32 v189, v189
    v_mfma_f32_16x16x32_bf16 v[144:147], v[60:63], a[112:115], v[144:147]
    v_fma_f32 v186, v186, v201, v201
    v_mfma_f32_16x16x32_bf16 v[148:151], v[60:63], a[116:119], v[148:151]
    v_fma_f32 v187, v187, v201, v201
    v_fma_f32 v188, v188, v201, v201
    v_mfma_f32_16x16x32_bf16 v[152:155], v[60:63], a[120:123], v[152:155]
    v_fma_f32 v189, v189, v201, v201
    v_rcp_f32 v186, v186
    v_mfma_f32_16x16x32_bf16 v[156:159], v[60:63], a[124:127], v[156:159]
    buffer_load_dwordx4 v[60:63], v7, s[40:43], s52 offen offset:3072
    v_rcp_f32 v187, v187
    v_mfma_f32_16x16x32_bf16 v[144:147], v[64:67], a[128:131], v[144:147]
    v_rcp_f32 v188, v188
    v_mfma_f32_16x16x32_bf16 v[148:151], v[64:67], a[132:135], v[148:151]
    v_rcp_f32 v189, v189
    v_mfma_f32_16x16x32_bf16 v[152:155], v[64:67], a[136:139], v[152:155]
    v_mul_f32 v186, v186, v164
    v_mul_f32 v187, v187, v165
    v_mfma_f32_16x16x32_bf16 v[156:159], v[64:67], a[140:143], v[156:159]
    buffer_load_dwordx4 v[64:67], v8, s[40:43], s52 offen offset:0
    v_mul_f32 v188, v188, v166
    v_mul_f32 v189, v189, v167
    v_mfma_f32_16x16x32_bf16 v[144:147], v[68:71], a[144:147], v[144:147]
    v_cvt_pk_bf16_f32 v190, v186, v187
    v_cvt_pk_bf16_f32 v191, v188, v189
    v_mfma_f32_16x16x32_bf16 v[148:151], v[68:71], a[148:151], v[148:151]
    ds_write_b64 v222, v[190:191] offset:20480
    v_mul_f32 v180, v168, v168
    v_mfma_f32_16x16x32_bf16 v[152:155], v[68:71], a[152:155], v[152:155]
    v_mul_f32 v181, v169, v169
    v_mul_f32 v182, v170, v170
    v_mfma_f32_16x16x32_bf16 v[156:159], v[68:71], a[156:159], v[156:159]
    buffer_load_dwordx4 v[68:71], v8, s[40:43], s52 offen offset:1024
    v_mul_f32 v183, v171, v171
    v_fma_f32 v180, v180, v198, v194
    v_mfma_f32_16x16x32_bf16 v[144:147], v[72:75], a[160:163], v[144:147]
    v_fma_f32 v181, v181, v198, v194
    v_fma_f32 v182, v182, v198, v194
    v_mfma_f32_16x16x32_bf16 v[148:151], v[72:75], a[164:167], v[148:151]
    v_fma_f32 v183, v183, v198, v194
    v_mul_f32 v180, v180, v168
    v_mfma_f32_16x16x32_bf16 v[152:155], v[72:75], a[168:171], v[152:155]
    v_mul_f32 v181, v181, v169
    v_mul_f32 v182, v182, v170
    v_mfma_f32_16x16x32_bf16 v[156:159], v[72:75], a[172:175], v[156:159]
    buffer_load_dwordx4 v[72:75], v8, s[40:43], s52 offen offset:2048
    v_mul_f32 v183, v183, v171
    v_exp_f32 v180, v180
    v_mfma_f32_16x16x32_bf16 v[144:147], v[76:79], a[176:179], v[144:147]
    v_exp_f32 v181, v181
    v_mfma_f32_16x16x32_bf16 v[148:151], v[76:79], a[180:183], v[148:151]
    v_exp_f32 v182, v182
    v_mfma_f32_16x16x32_bf16 v[152:155], v[76:79], a[184:187], v[152:155]
    v_exp_f32 v183, v183
    v_mfma_f32_16x16x32_bf16 v[156:159], v[76:79], a[188:191], v[156:159]
    buffer_load_dwordx4 v[76:79], v8, s[40:43], s52 offen offset:3072
    v_fma_f32 v180, v180, v202, v202
    v_fma_f32 v181, v181, v202, v202
    v_mfma_f32_16x16x32_bf16 v[144:147], v[80:83], a[192:195], v[144:147]
    v_fma_f32 v182, v182, v202, v202
    v_fma_f32 v183, v183, v202, v202
    v_mfma_f32_16x16x32_bf16 v[148:151], v[80:83], a[196:199], v[148:151]
    v_rcp_f32 v180, v180
    v_mfma_f32_16x16x32_bf16 v[152:155], v[80:83], a[200:203], v[152:155]
    v_rcp_f32 v181, v181
    v_mfma_f32_16x16x32_bf16 v[156:159], v[80:83], a[204:207], v[156:159]
    buffer_load_dwordx4 v[80:83], v9, s[40:43], s52 offen offset:0
    v_rcp_f32 v182, v182
    v_mfma_f32_16x16x32_bf16 v[144:147], v[84:87], a[208:211], v[144:147]
    v_rcp_f32 v183, v183
    v_mfma_f32_16x16x32_bf16 v[148:151], v[84:87], a[212:215], v[148:151]
    v_mul_f32 v180, v180, v168
    v_mul_f32 v181, v181, v169
    v_mfma_f32_16x16x32_bf16 v[152:155], v[84:87], a[216:219], v[152:155]
    v_mul_f32 v182, v182, v170
    v_mul_f32 v183, v183, v171
    v_mfma_f32_16x16x32_bf16 v[156:159], v[84:87], a[220:223], v[156:159]
    buffer_load_dwordx4 v[84:87], v9, s[40:43], s52 offen offset:1024
    v_cvt_pk_bf16_f32 v184, v180, v181
    v_cvt_pk_bf16_f32 v185, v182, v183
    s_waitcnt vmcnt(31)
    v_mfma_f32_16x16x32_bf16 v[144:147], v[88:91], a[224:227], v[144:147]
    ds_write_b64 v223, v[184:185] offset:2048
    v_mul_f32 v186, v172, v172
    v_mul_f32 v187, v173, v173
    v_mfma_f32_16x16x32_bf16 v[148:151], v[88:91], a[228:231], v[148:151]
    v_mul_f32 v188, v174, v174
    v_mul_f32 v189, v175, v175
    v_mfma_f32_16x16x32_bf16 v[152:155], v[88:91], a[232:235], v[152:155]
    v_fma_f32 v186, v186, v199, v195
    v_fma_f32 v187, v187, v199, v195
    v_mfma_f32_16x16x32_bf16 v[156:159], v[88:91], a[236:239], v[156:159]
    buffer_load_dwordx4 v[88:91], v9, s[40:43], s52 offen offset:2048
    v_fma_f32 v188, v188, v199, v195
    v_fma_f32 v189, v189, v199, v195
    v_mfma_f32_16x16x32_bf16 v[144:147], v[92:95], a[240:243], v[144:147]
    v_mul_f32 v186, v186, v172
    v_mul_f32 v187, v187, v173
    v_mfma_f32_16x16x32_bf16 v[148:151], v[92:95], a[244:247], v[148:151]
    v_mul_f32 v188, v188, v174
    v_mul_f32 v189, v189, v175
    v_mfma_f32_16x16x32_bf16 v[152:155], v[92:95], a[248:251], v[152:155]
    v_exp_f32 v186, v186
    v_mfma_f32_16x16x32_bf16 v[156:159], v[92:95], a[252:255], v[156:159]
    buffer_load_dwordx4 v[92:95], v9, s[40:43], s52 offen offset:3072
    v_exp_f32 v187, v187
    s_waitcnt vmcnt(31)
    v_mfma_f32_16x16x32_bf16 v[144:147], v[96:99], v[224:227], v[144:147]
    v_exp_f32 v188, v188
    v_mfma_f32_16x16x32_bf16 v[148:151], v[96:99], v[228:231], v[148:151]
    v_exp_f32 v189, v189
    v_mfma_f32_16x16x32_bf16 v[152:155], v[96:99], v[232:235], v[152:155]
    v_fma_f32 v186, v186, v203, v203
    v_fma_f32 v187, v187, v203, v203
    v_mfma_f32_16x16x32_bf16 v[156:159], v[96:99], v[236:239], v[156:159]
    buffer_load_dwordx4 v[96:99], v10, s[40:43], s52 offen offset:0
    v_fma_f32 v188, v188, v203, v203
    v_fma_f32 v189, v189, v203, v203
    v_mfma_f32_16x16x32_bf16 v[144:147], v[100:103], v[240:243], v[144:147]
    v_rcp_f32 v186, v186
    v_mfma_f32_16x16x32_bf16 v[148:151], v[100:103], v[244:247], v[148:151]
    v_rcp_f32 v187, v187
    v_mfma_f32_16x16x32_bf16 v[152:155], v[100:103], v[248:251], v[152:155]
    v_rcp_f32 v188, v188
    v_mfma_f32_16x16x32_bf16 v[156:159], v[100:103], v[252:255], v[156:159]
    buffer_load_dwordx4 v[100:103], v10, s[40:43], s52 offen offset:1024
    v_rcp_f32 v189, v189
    v_mul_f32 v186, v186, v172
    s_waitcnt vmcnt(18)
    v_mfma_f32_16x16x32_bf16 v[160:163], v[176:179], v[204:207], v[144:147]
    v_mul_f32 v187, v187, v173
    v_mul_f32 v188, v188, v174
    v_mfma_f32_16x16x32_bf16 v[164:167], v[176:179], v[208:211], v[148:151]
    v_mul_f32 v189, v189, v175
    v_cvt_pk_bf16_f32 v190, v186, v187
    v_mfma_f32_16x16x32_bf16 v[168:171], v[176:179], v[212:215], v[152:155]
    v_cvt_pk_bf16_f32 v191, v188, v189
    ds_write_b64 v223, v[190:191] offset:20480
    v_mfma_f32_16x16x32_bf16 v[172:175], v[176:179], v[216:219], v[156:159]
    s_add_u32 s91, s91, 1024
    buffer_load_dwordx4 v[176:179], v12, s[40:43], s91 offen
    v_mfma_f32_16x16x32_bf16 v[144:147], v[104:107], a[0:3], 0
    v_mul_f32 v180, v160, v160
    v_mul_f32 v181, v161, v161
    v_mfma_f32_16x16x32_bf16 v[148:151], v[104:107], a[4:7], 0
    v_mul_f32 v182, v162, v162
    v_mul_f32 v183, v163, v163
    v_mfma_f32_16x16x32_bf16 v[152:155], v[104:107], a[8:11], 0
    v_fma_f32 v180, v180, v196, v192
    v_fma_f32 v181, v181, v196, v192
    v_mfma_f32_16x16x32_bf16 v[156:159], v[104:107], a[12:15], 0
    buffer_load_dwordx4 v[104:107], v10, s[40:43], s52 offen offset:2048
    v_fma_f32 v182, v182, v196, v192
    v_fma_f32 v183, v183, v196, v192
    v_mfma_f32_16x16x32_bf16 v[144:147], v[108:111], a[16:19], v[144:147]
    v_mul_f32 v180, v180, v160
    v_mul_f32 v181, v181, v161
    v_mfma_f32_16x16x32_bf16 v[148:151], v[108:111], a[20:23], v[148:151]
    v_mul_f32 v182, v182, v162
    v_mul_f32 v183, v183, v163
    v_mfma_f32_16x16x32_bf16 v[152:155], v[108:111], a[24:27], v[152:155]
    v_exp_f32 v180, v180
    v_mfma_f32_16x16x32_bf16 v[156:159], v[108:111], a[28:31], v[156:159]
    buffer_load_dwordx4 v[108:111], v10, s[40:43], s52 offen offset:3072
    v_exp_f32 v181, v181
    v_mfma_f32_16x16x32_bf16 v[144:147], v[112:115], a[32:35], v[144:147]
    v_exp_f32 v182, v182
    v_mfma_f32_16x16x32_bf16 v[148:151], v[112:115], a[36:39], v[148:151]
    v_exp_f32 v183, v183
    v_fma_f32 v180, v180, v200, v200
    v_mfma_f32_16x16x32_bf16 v[152:155], v[112:115], a[40:43], v[152:155]
    v_fma_f32 v181, v181, v200, v200
    v_fma_f32 v182, v182, v200, v200
    v_mfma_f32_16x16x32_bf16 v[156:159], v[112:115], a[44:47], v[156:159]
    buffer_load_dwordx4 v[112:115], v11, s[40:43], s52 offen offset:0
    v_fma_f32 v183, v183, v200, v200
    v_mfma_f32_16x16x32_bf16 v[144:147], v[116:119], a[48:51], v[144:147]
    v_rcp_f32 v180, v180
    v_rcp_f32 v181, v181
    v_mfma_f32_16x16x32_bf16 v[148:151], v[116:119], a[52:55], v[148:151]
    v_rcp_f32 v182, v182
    v_mfma_f32_16x16x32_bf16 v[152:155], v[116:119], a[56:59], v[152:155]
    v_rcp_f32 v183, v183
    v_mfma_f32_16x16x32_bf16 v[156:159], v[116:119], a[60:63], v[156:159]
    buffer_load_dwordx4 v[116:119], v11, s[40:43], s52 offen offset:1024
    v_mul_f32 v180, v180, v160
    v_mfma_f32_16x16x32_bf16 v[144:147], v[120:123], a[64:67], v[144:147]
    v_mul_f32 v181, v181, v161
    v_mul_f32 v182, v182, v162
    v_mfma_f32_16x16x32_bf16 v[148:151], v[120:123], a[68:71], v[148:151]
    v_mul_f32 v183, v183, v163
    v_cvt_pk_bf16_f32 v184, v180, v181
    v_mfma_f32_16x16x32_bf16 v[152:155], v[120:123], a[72:75], v[152:155]
    v_cvt_pk_bf16_f32 v185, v182, v183
    ds_write_b64 v222, v[184:185] offset:4096
    v_mul_f32 v186, v164, v164
    v_mfma_f32_16x16x32_bf16 v[156:159], v[120:123], a[76:79], v[156:159]
    buffer_load_dwordx4 v[120:123], v7, s[40:43], s53 offen offset:0
    v_mul_f32 v187, v165, v165
    v_mul_f32 v188, v166, v166
    v_mfma_f32_16x16x32_bf16 v[144:147], v[124:127], a[80:83], v[144:147]
    v_mul_f32 v189, v167, v167
    v_fma_f32 v186, v186, v197, v193
    v_mfma_f32_16x16x32_bf16 v[148:151], v[124:127], a[84:87], v[148:151]
    v_fma_f32 v187, v187, v197, v193
    v_fma_f32 v188, v188, v197, v193
    v_mfma_f32_16x16x32_bf16 v[152:155], v[124:127], a[88:91], v[152:155]
    v_fma_f32 v189, v189, v197, v193
    v_mul_f32 v186, v186, v164
    v_mfma_f32_16x16x32_bf16 v[156:159], v[124:127], a[92:95], v[156:159]
    buffer_load_dwordx4 v[124:127], v7, s[40:43], s53 offen offset:1024
    v_mul_f32 v187, v187, v165
    v_mul_f32 v188, v188, v166
    v_mfma_f32_16x16x32_bf16 v[144:147], v[128:131], a[96:99], v[144:147]
    v_mul_f32 v189, v189, v167
    v_exp_f32 v186, v186
    v_mfma_f32_16x16x32_bf16 v[148:151], v[128:131], a[100:103], v[148:151]
    v_exp_f32 v187, v187
    v_mfma_f32_16x16x32_bf16 v[152:155], v[128:131], a[104:107], v[152:155]
    v_exp_f32 v188, v188
    v_mfma_f32_16x16x32_bf16 v[156:159], v[128:131], a[108:111], v[156:159]
    buffer_load_dwordx4 v[128:131], v7, s[40:43], s53 offen offset:2048
    v_exp_f32 v189, v189
    v_mfma_f32_16x16x32_bf16 v[144:147], v[132:135], a[112:115], v[144:147]
    v_fma_f32 v186, v186, v201, v201
    v_mfma_f32_16x16x32_bf16 v[148:151], v[132:135], a[116:119], v[148:151]
    v_fma_f32 v187, v187, v201, v201
    v_fma_f32 v188, v188, v201, v201
    v_mfma_f32_16x16x32_bf16 v[152:155], v[132:135], a[120:123], v[152:155]
    v_fma_f32 v189, v189, v201, v201
    v_rcp_f32 v186, v186
    v_mfma_f32_16x16x32_bf16 v[156:159], v[132:135], a[124:127], v[156:159]
    buffer_load_dwordx4 v[132:135], v7, s[40:43], s53 offen offset:3072
    v_rcp_f32 v187, v187
    v_mfma_f32_16x16x32_bf16 v[144:147], v[136:139], a[128:131], v[144:147]
    v_rcp_f32 v188, v188
    v_mfma_f32_16x16x32_bf16 v[148:151], v[136:139], a[132:135], v[148:151]
    v_rcp_f32 v189, v189
    v_mfma_f32_16x16x32_bf16 v[152:155], v[136:139], a[136:139], v[152:155]
    v_mul_f32 v186, v186, v164
    v_mul_f32 v187, v187, v165
    v_mfma_f32_16x16x32_bf16 v[156:159], v[136:139], a[140:143], v[156:159]
    buffer_load_dwordx4 v[136:139], v8, s[40:43], s53 offen offset:0
    v_mul_f32 v188, v188, v166
    v_mul_f32 v189, v189, v167
    v_mfma_f32_16x16x32_bf16 v[144:147], v[140:143], a[144:147], v[144:147]
    v_cvt_pk_bf16_f32 v190, v186, v187
    v_cvt_pk_bf16_f32 v191, v188, v189
    v_mfma_f32_16x16x32_bf16 v[148:151], v[140:143], a[148:151], v[148:151]
    ds_write_b64 v222, v[190:191] offset:22528
    v_mul_f32 v180, v168, v168
    v_mfma_f32_16x16x32_bf16 v[152:155], v[140:143], a[152:155], v[152:155]
    v_mul_f32 v181, v169, v169
    v_mul_f32 v182, v170, v170
    v_mfma_f32_16x16x32_bf16 v[156:159], v[140:143], a[156:159], v[156:159]
    buffer_load_dwordx4 v[140:143], v8, s[40:43], s53 offen offset:1024
    v_mul_f32 v183, v171, v171
    v_fma_f32 v180, v180, v198, v194
    v_mfma_f32_16x16x32_bf16 v[144:147], v[16:19], a[160:163], v[144:147]
    v_fma_f32 v181, v181, v198, v194
    v_fma_f32 v182, v182, v198, v194
    v_mfma_f32_16x16x32_bf16 v[148:151], v[16:19], a[164:167], v[148:151]
    v_fma_f32 v183, v183, v198, v194
    v_mul_f32 v180, v180, v168
    v_mfma_f32_16x16x32_bf16 v[152:155], v[16:19], a[168:171], v[152:155]
    v_mul_f32 v181, v181, v169
    v_mul_f32 v182, v182, v170
    v_mfma_f32_16x16x32_bf16 v[156:159], v[16:19], a[172:175], v[156:159]
    buffer_load_dwordx4 v[16:19], v8, s[40:43], s53 offen offset:2048
    v_mul_f32 v183, v183, v171
    v_exp_f32 v180, v180
    v_mfma_f32_16x16x32_bf16 v[144:147], v[20:23], a[176:179], v[144:147]
    v_exp_f32 v181, v181
    v_mfma_f32_16x16x32_bf16 v[148:151], v[20:23], a[180:183], v[148:151]
    v_exp_f32 v182, v182
    v_mfma_f32_16x16x32_bf16 v[152:155], v[20:23], a[184:187], v[152:155]
    v_exp_f32 v183, v183
    v_mfma_f32_16x16x32_bf16 v[156:159], v[20:23], a[188:191], v[156:159]
    buffer_load_dwordx4 v[20:23], v8, s[40:43], s53 offen offset:3072
    v_fma_f32 v180, v180, v202, v202
    v_fma_f32 v181, v181, v202, v202
    v_mfma_f32_16x16x32_bf16 v[144:147], v[24:27], a[192:195], v[144:147]
    v_fma_f32 v182, v182, v202, v202
    v_fma_f32 v183, v183, v202, v202
    v_mfma_f32_16x16x32_bf16 v[148:151], v[24:27], a[196:199], v[148:151]
    v_rcp_f32 v180, v180
    v_mfma_f32_16x16x32_bf16 v[152:155], v[24:27], a[200:203], v[152:155]
    v_rcp_f32 v181, v181
    v_mfma_f32_16x16x32_bf16 v[156:159], v[24:27], a[204:207], v[156:159]
    buffer_load_dwordx4 v[24:27], v9, s[40:43], s53 offen offset:0
    v_rcp_f32 v182, v182
    v_mfma_f32_16x16x32_bf16 v[144:147], v[28:31], a[208:211], v[144:147]
    v_rcp_f32 v183, v183
    v_mfma_f32_16x16x32_bf16 v[148:151], v[28:31], a[212:215], v[148:151]
    v_mul_f32 v180, v180, v168
    v_mul_f32 v181, v181, v169
    v_mfma_f32_16x16x32_bf16 v[152:155], v[28:31], a[216:219], v[152:155]
    v_mul_f32 v182, v182, v170
    v_mul_f32 v183, v183, v171
    v_mfma_f32_16x16x32_bf16 v[156:159], v[28:31], a[220:223], v[156:159]
    buffer_load_dwordx4 v[28:31], v9, s[40:43], s53 offen offset:1024
    v_cvt_pk_bf16_f32 v184, v180, v181
    v_cvt_pk_bf16_f32 v185, v182, v183
    s_waitcnt vmcnt(31)
    v_mfma_f32_16x16x32_bf16 v[144:147], v[32:35], a[224:227], v[144:147]
    ds_write_b64 v223, v[184:185] offset:4096
    v_mul_f32 v186, v172, v172
    v_mul_f32 v187, v173, v173
    v_mfma_f32_16x16x32_bf16 v[148:151], v[32:35], a[228:231], v[148:151]
    v_mul_f32 v188, v174, v174
    v_mul_f32 v189, v175, v175
    v_mfma_f32_16x16x32_bf16 v[152:155], v[32:35], a[232:235], v[152:155]
    v_fma_f32 v186, v186, v199, v195
    v_fma_f32 v187, v187, v199, v195
    v_mfma_f32_16x16x32_bf16 v[156:159], v[32:35], a[236:239], v[156:159]
    buffer_load_dwordx4 v[32:35], v9, s[40:43], s53 offen offset:2048
    v_fma_f32 v188, v188, v199, v195
    v_fma_f32 v189, v189, v199, v195
    v_mfma_f32_16x16x32_bf16 v[144:147], v[36:39], a[240:243], v[144:147]
    v_mul_f32 v186, v186, v172
    v_mul_f32 v187, v187, v173
    v_mfma_f32_16x16x32_bf16 v[148:151], v[36:39], a[244:247], v[148:151]
    v_mul_f32 v188, v188, v174
    v_mul_f32 v189, v189, v175
    v_mfma_f32_16x16x32_bf16 v[152:155], v[36:39], a[248:251], v[152:155]
    v_exp_f32 v186, v186
    v_mfma_f32_16x16x32_bf16 v[156:159], v[36:39], a[252:255], v[156:159]
    buffer_load_dwordx4 v[36:39], v9, s[40:43], s53 offen offset:3072
    v_exp_f32 v187, v187
    s_waitcnt vmcnt(31)
    v_mfma_f32_16x16x32_bf16 v[144:147], v[40:43], v[224:227], v[144:147]
    v_exp_f32 v188, v188
    v_mfma_f32_16x16x32_bf16 v[148:151], v[40:43], v[228:231], v[148:151]
    v_exp_f32 v189, v189
    v_mfma_f32_16x16x32_bf16 v[152:155], v[40:43], v[232:235], v[152:155]
    v_fma_f32 v186, v186, v203, v203
    v_fma_f32 v187, v187, v203, v203
    v_mfma_f32_16x16x32_bf16 v[156:159], v[40:43], v[236:239], v[156:159]
    buffer_load_dwordx4 v[40:43], v10, s[40:43], s53 offen offset:0
    v_fma_f32 v188, v188, v203, v203
    v_fma_f32 v189, v189, v203, v203
    v_mfma_f32_16x16x32_bf16 v[144:147], v[44:47], v[240:243], v[144:147]
    v_rcp_f32 v186, v186
    v_mfma_f32_16x16x32_bf16 v[148:151], v[44:47], v[244:247], v[148:151]
    v_rcp_f32 v187, v187
    v_mfma_f32_16x16x32_bf16 v[152:155], v[44:47], v[248:251], v[152:155]
    v_rcp_f32 v188, v188
    v_mfma_f32_16x16x32_bf16 v[156:159], v[44:47], v[252:255], v[156:159]
    buffer_load_dwordx4 v[44:47], v10, s[40:43], s53 offen offset:1024
    v_rcp_f32 v189, v189
    v_mul_f32 v186, v186, v172
    s_waitcnt vmcnt(18)
    v_mfma_f32_16x16x32_bf16 v[160:163], v[176:179], v[204:207], v[144:147]
    v_mul_f32 v187, v187, v173
    v_mul_f32 v188, v188, v174
    v_mfma_f32_16x16x32_bf16 v[164:167], v[176:179], v[208:211], v[148:151]
    v_mul_f32 v189, v189, v175
    v_cvt_pk_bf16_f32 v190, v186, v187
    v_mfma_f32_16x16x32_bf16 v[168:171], v[176:179], v[212:215], v[152:155]
    v_cvt_pk_bf16_f32 v191, v188, v189
    ds_write_b64 v223, v[190:191] offset:22528
    v_mfma_f32_16x16x32_bf16 v[172:175], v[176:179], v[216:219], v[156:159]
    s_add_u32 s91, s91, 1024
    buffer_load_dwordx4 v[176:179], v12, s[40:43], s91 offen
    v_mfma_f32_16x16x32_bf16 v[144:147], v[48:51], a[0:3], 0
    v_mul_f32 v180, v160, v160
    v_mul_f32 v181, v161, v161
    v_mfma_f32_16x16x32_bf16 v[148:151], v[48:51], a[4:7], 0
    v_mul_f32 v182, v162, v162
    v_mul_f32 v183, v163, v163
    v_mfma_f32_16x16x32_bf16 v[152:155], v[48:51], a[8:11], 0
    v_fma_f32 v180, v180, v196, v192
    v_fma_f32 v181, v181, v196, v192
    v_mfma_f32_16x16x32_bf16 v[156:159], v[48:51], a[12:15], 0
    buffer_load_dwordx4 v[48:51], v10, s[40:43], s53 offen offset:2048
    v_fma_f32 v182, v182, v196, v192
    v_fma_f32 v183, v183, v196, v192
    v_mfma_f32_16x16x32_bf16 v[144:147], v[52:55], a[16:19], v[144:147]
    v_mul_f32 v180, v180, v160
    v_mul_f32 v181, v181, v161
    v_mfma_f32_16x16x32_bf16 v[148:151], v[52:55], a[20:23], v[148:151]
    v_mul_f32 v182, v182, v162
    v_mul_f32 v183, v183, v163
    v_mfma_f32_16x16x32_bf16 v[152:155], v[52:55], a[24:27], v[152:155]
    v_exp_f32 v180, v180
    v_mfma_f32_16x16x32_bf16 v[156:159], v[52:55], a[28:31], v[156:159]
    buffer_load_dwordx4 v[52:55], v10, s[40:43], s53 offen offset:3072
    v_exp_f32 v181, v181
    v_mfma_f32_16x16x32_bf16 v[144:147], v[56:59], a[32:35], v[144:147]
    v_exp_f32 v182, v182
    v_mfma_f32_16x16x32_bf16 v[148:151], v[56:59], a[36:39], v[148:151]
    v_exp_f32 v183, v183
    v_fma_f32 v180, v180, v200, v200
    v_mfma_f32_16x16x32_bf16 v[152:155], v[56:59], a[40:43], v[152:155]
    v_fma_f32 v181, v181, v200, v200
    v_fma_f32 v182, v182, v200, v200
    v_mfma_f32_16x16x32_bf16 v[156:159], v[56:59], a[44:47], v[156:159]
    buffer_load_dwordx4 v[56:59], v11, s[40:43], s53 offen offset:0
    v_fma_f32 v183, v183, v200, v200
    v_mfma_f32_16x16x32_bf16 v[144:147], v[60:63], a[48:51], v[144:147]
    v_rcp_f32 v180, v180
    v_rcp_f32 v181, v181
    v_mfma_f32_16x16x32_bf16 v[148:151], v[60:63], a[52:55], v[148:151]
    v_rcp_f32 v182, v182
    v_mfma_f32_16x16x32_bf16 v[152:155], v[60:63], a[56:59], v[152:155]
    v_rcp_f32 v183, v183
    v_mfma_f32_16x16x32_bf16 v[156:159], v[60:63], a[60:63], v[156:159]
    buffer_load_dwordx4 v[60:63], v11, s[40:43], s53 offen offset:1024
    v_mul_f32 v180, v180, v160
    v_mfma_f32_16x16x32_bf16 v[144:147], v[64:67], a[64:67], v[144:147]
    v_mul_f32 v181, v181, v161
    v_mul_f32 v182, v182, v162
    v_mfma_f32_16x16x32_bf16 v[148:151], v[64:67], a[68:71], v[148:151]
    v_mul_f32 v183, v183, v163
    v_cvt_pk_bf16_f32 v184, v180, v181
    v_mfma_f32_16x16x32_bf16 v[152:155], v[64:67], a[72:75], v[152:155]
    v_cvt_pk_bf16_f32 v185, v182, v183
    ds_write_b64 v222, v[184:185] offset:6144
    v_mul_f32 v186, v164, v164
    v_mfma_f32_16x16x32_bf16 v[156:159], v[64:67], a[76:79], v[156:159]
    buffer_load_dwordx4 v[64:67], v7, s[40:43], s54 offen offset:0
    v_mul_f32 v187, v165, v165
    v_mul_f32 v188, v166, v166
    v_mfma_f32_16x16x32_bf16 v[144:147], v[68:71], a[80:83], v[144:147]
    v_mul_f32 v189, v167, v167
    v_fma_f32 v186, v186, v197, v193
    v_mfma_f32_16x16x32_bf16 v[148:151], v[68:71], a[84:87], v[148:151]
    v_fma_f32 v187, v187, v197, v193
    v_fma_f32 v188, v188, v197, v193
    v_mfma_f32_16x16x32_bf16 v[152:155], v[68:71], a[88:91], v[152:155]
    v_fma_f32 v189, v189, v197, v193
    v_mul_f32 v186, v186, v164
    v_mfma_f32_16x16x32_bf16 v[156:159], v[68:71], a[92:95], v[156:159]
    buffer_load_dwordx4 v[68:71], v7, s[40:43], s54 offen offset:1024
    v_mul_f32 v187, v187, v165
    v_mul_f32 v188, v188, v166
    v_mfma_f32_16x16x32_bf16 v[144:147], v[72:75], a[96:99], v[144:147]
    v_mul_f32 v189, v189, v167
    v_exp_f32 v186, v186
    v_mfma_f32_16x16x32_bf16 v[148:151], v[72:75], a[100:103], v[148:151]
    v_exp_f32 v187, v187
    v_mfma_f32_16x16x32_bf16 v[152:155], v[72:75], a[104:107], v[152:155]
    v_exp_f32 v188, v188
    v_mfma_f32_16x16x32_bf16 v[156:159], v[72:75], a[108:111], v[156:159]
    buffer_load_dwordx4 v[72:75], v7, s[40:43], s54 offen offset:2048
    v_exp_f32 v189, v189
    v_mfma_f32_16x16x32_bf16 v[144:147], v[76:79], a[112:115], v[144:147]
    v_fma_f32 v186, v186, v201, v201
    v_mfma_f32_16x16x32_bf16 v[148:151], v[76:79], a[116:119], v[148:151]
    v_fma_f32 v187, v187, v201, v201
    v_fma_f32 v188, v188, v201, v201
    v_mfma_f32_16x16x32_bf16 v[152:155], v[76:79], a[120:123], v[152:155]
    v_fma_f32 v189, v189, v201, v201
    v_rcp_f32 v186, v186
    v_mfma_f32_16x16x32_bf16 v[156:159], v[76:79], a[124:127], v[156:159]
    buffer_load_dwordx4 v[76:79], v7, s[40:43], s54 offen offset:3072
    v_rcp_f32 v187, v187
    v_mfma_f32_16x16x32_bf16 v[144:147], v[80:83], a[128:131], v[144:147]
    v_rcp_f32 v188, v188
    v_mfma_f32_16x16x32_bf16 v[148:151], v[80:83], a[132:135], v[148:151]
    v_rcp_f32 v189, v189
    v_mfma_f32_16x16x32_bf16 v[152:155], v[80:83], a[136:139], v[152:155]
    v_mul_f32 v186, v186, v164
    v_mul_f32 v187, v187, v165
    v_mfma_f32_16x16x32_bf16 v[156:159], v[80:83], a[140:143], v[156:159]
    buffer_load_dwordx4 v[80:83], v8, s[40:43], s54 offen offset:0
    v_mul_f32 v188, v188, v166
    v_mul_f32 v189, v189, v167
    v_mfma_f32_16x16x32_bf16 v[144:147], v[84:87], a[144:147], v[144:147]
    v_cvt_pk_bf16_f32 v190, v186, v187
    v_cvt_pk_bf16_f32 v191, v188, v189
    v_mfma_f32_16x16x32_bf16 v[148:151], v[84:87], a[148:151], v[148:151]
    ds_write_b64 v222, v[190:191] offset:24576
    v_mul_f32 v180, v168, v168
    v_mfma_f32_16x16x32_bf16 v[152:155], v[84:87], a[152:155], v[152:155]
    v_mul_f32 v181, v169, v169
    v_mul_f32 v182, v170, v170
    v_mfma_f32_16x16x32_bf16 v[156:159], v[84:87], a[156:159], v[156:159]
    buffer_load_dwordx4 v[84:87], v8, s[40:43], s54 offen offset:1024
    v_mul_f32 v183, v171, v171
    v_fma_f32 v180, v180, v198, v194
    v_mfma_f32_16x16x32_bf16 v[144:147], v[88:91], a[160:163], v[144:147]
    v_fma_f32 v181, v181, v198, v194
    v_fma_f32 v182, v182, v198, v194
    v_mfma_f32_16x16x32_bf16 v[148:151], v[88:91], a[164:167], v[148:151]
    v_fma_f32 v183, v183, v198, v194
    v_mul_f32 v180, v180, v168
    v_mfma_f32_16x16x32_bf16 v[152:155], v[88:91], a[168:171], v[152:155]
    v_mul_f32 v181, v181, v169
    v_mul_f32 v182, v182, v170
    v_mfma_f32_16x16x32_bf16 v[156:159], v[88:91], a[172:175], v[156:159]
    buffer_load_dwordx4 v[88:91], v8, s[40:43], s54 offen offset:2048
    v_mul_f32 v183, v183, v171
    v_exp_f32 v180, v180
    v_mfma_f32_16x16x32_bf16 v[144:147], v[92:95], a[176:179], v[144:147]
    v_exp_f32 v181, v181
    v_mfma_f32_16x16x32_bf16 v[148:151], v[92:95], a[180:183], v[148:151]
    v_exp_f32 v182, v182
    v_mfma_f32_16x16x32_bf16 v[152:155], v[92:95], a[184:187], v[152:155]
    v_exp_f32 v183, v183
    v_mfma_f32_16x16x32_bf16 v[156:159], v[92:95], a[188:191], v[156:159]
    buffer_load_dwordx4 v[92:95], v8, s[40:43], s54 offen offset:3072
    v_fma_f32 v180, v180, v202, v202
    v_fma_f32 v181, v181, v202, v202
    v_mfma_f32_16x16x32_bf16 v[144:147], v[96:99], a[192:195], v[144:147]
    v_fma_f32 v182, v182, v202, v202
    v_fma_f32 v183, v183, v202, v202
    v_mfma_f32_16x16x32_bf16 v[148:151], v[96:99], a[196:199], v[148:151]
    v_rcp_f32 v180, v180
    v_mfma_f32_16x16x32_bf16 v[152:155], v[96:99], a[200:203], v[152:155]
    v_rcp_f32 v181, v181
    v_mfma_f32_16x16x32_bf16 v[156:159], v[96:99], a[204:207], v[156:159]
    buffer_load_dwordx4 v[96:99], v9, s[40:43], s54 offen offset:0
    v_rcp_f32 v182, v182
    v_mfma_f32_16x16x32_bf16 v[144:147], v[100:103], a[208:211], v[144:147]
    v_rcp_f32 v183, v183
    v_mfma_f32_16x16x32_bf16 v[148:151], v[100:103], a[212:215], v[148:151]
    v_mul_f32 v180, v180, v168
    v_mul_f32 v181, v181, v169
    v_mfma_f32_16x16x32_bf16 v[152:155], v[100:103], a[216:219], v[152:155]
    v_mul_f32 v182, v182, v170
    v_mul_f32 v183, v183, v171
    v_mfma_f32_16x16x32_bf16 v[156:159], v[100:103], a[220:223], v[156:159]
    buffer_load_dwordx4 v[100:103], v9, s[40:43], s54 offen offset:1024
    v_cvt_pk_bf16_f32 v184, v180, v181
    v_cvt_pk_bf16_f32 v185, v182, v183
    s_waitcnt vmcnt(31)
    v_mfma_f32_16x16x32_bf16 v[144:147], v[104:107], a[224:227], v[144:147]
    ds_write_b64 v223, v[184:185] offset:6144
    v_mul_f32 v186, v172, v172
    v_mul_f32 v187, v173, v173
    v_mfma_f32_16x16x32_bf16 v[148:151], v[104:107], a[228:231], v[148:151]
    v_mul_f32 v188, v174, v174
    v_mul_f32 v189, v175, v175
    v_mfma_f32_16x16x32_bf16 v[152:155], v[104:107], a[232:235], v[152:155]
    v_fma_f32 v186, v186, v199, v195
    v_fma_f32 v187, v187, v199, v195
    v_mfma_f32_16x16x32_bf16 v[156:159], v[104:107], a[236:239], v[156:159]
    buffer_load_dwordx4 v[104:107], v9, s[40:43], s54 offen offset:2048
    v_fma_f32 v188, v188, v199, v195
    v_fma_f32 v189, v189, v199, v195
    v_mfma_f32_16x16x32_bf16 v[144:147], v[108:111], a[240:243], v[144:147]
    v_mul_f32 v186, v186, v172
    v_mul_f32 v187, v187, v173
    v_mfma_f32_16x16x32_bf16 v[148:151], v[108:111], a[244:247], v[148:151]
    v_mul_f32 v188, v188, v174
    v_mul_f32 v189, v189, v175
    v_mfma_f32_16x16x32_bf16 v[152:155], v[108:111], a[248:251], v[152:155]
    v_exp_f32 v186, v186
    v_mfma_f32_16x16x32_bf16 v[156:159], v[108:111], a[252:255], v[156:159]
    buffer_load_dwordx4 v[108:111], v9, s[40:43], s54 offen offset:3072
    v_exp_f32 v187, v187
    s_waitcnt vmcnt(31)
    v_mfma_f32_16x16x32_bf16 v[144:147], v[112:115], v[224:227], v[144:147]
    v_exp_f32 v188, v188
    v_mfma_f32_16x16x32_bf16 v[148:151], v[112:115], v[228:231], v[148:151]
    v_exp_f32 v189, v189
    v_mfma_f32_16x16x32_bf16 v[152:155], v[112:115], v[232:235], v[152:155]
    v_fma_f32 v186, v186, v203, v203
    v_fma_f32 v187, v187, v203, v203
    v_mfma_f32_16x16x32_bf16 v[156:159], v[112:115], v[236:239], v[156:159]
    buffer_load_dwordx4 v[112:115], v10, s[40:43], s54 offen offset:0
    v_fma_f32 v188, v188, v203, v203
    v_fma_f32 v189, v189, v203, v203
    v_mfma_f32_16x16x32_bf16 v[144:147], v[116:119], v[240:243], v[144:147]
    v_rcp_f32 v186, v186
    v_mfma_f32_16x16x32_bf16 v[148:151], v[116:119], v[244:247], v[148:151]
    v_rcp_f32 v187, v187
    v_mfma_f32_16x16x32_bf16 v[152:155], v[116:119], v[248:251], v[152:155]
    v_rcp_f32 v188, v188
    v_mfma_f32_16x16x32_bf16 v[156:159], v[116:119], v[252:255], v[156:159]
    buffer_load_dwordx4 v[116:119], v10, s[40:43], s54 offen offset:1024
    v_rcp_f32 v189, v189
    v_mul_f32 v186, v186, v172
    s_waitcnt vmcnt(18)
    v_mfma_f32_16x16x32_bf16 v[160:163], v[176:179], v[204:207], v[144:147]
    v_mul_f32 v187, v187, v173
    v_mul_f32 v188, v188, v174
    v_mfma_f32_16x16x32_bf16 v[164:167], v[176:179], v[208:211], v[148:151]
    v_mul_f32 v189, v189, v175
    v_cvt_pk_bf16_f32 v190, v186, v187
    v_mfma_f32_16x16x32_bf16 v[168:171], v[176:179], v[212:215], v[152:155]
    v_cvt_pk_bf16_f32 v191, v188, v189
    ds_write_b64 v223, v[190:191] offset:24576
    v_mfma_f32_16x16x32_bf16 v[172:175], v[176:179], v[216:219], v[156:159]
    s_add_u32 s91, s91, 1024
    buffer_load_dwordx4 v[176:179], v12, s[40:43], s91 offen
    s_mov_b32 s16, 128
    s_cmp_lg_u32 s45, 0
    s_cbranch_scc1 W2_d
    s_mov_b32 s16, 0
    s_atomic_add s16, s[20:21], s23 glc
W2_d:
    v_mfma_f32_16x16x32_bf16 v[144:147], v[120:123], a[0:3], 0
    v_mul_f32 v180, v160, v160
    v_mul_f32 v181, v161, v161
    v_mfma_f32_16x16x32_bf16 v[148:151], v[120:123], a[4:7], 0
    v_mul_f32 v182, v162, v162
    v_mul_f32 v183, v163, v163
    v_mfma_f32_16x16x32_bf16 v[152:155], v[120:123], a[8:11], 0
    v_fma_f32 v180, v180, v196, v192
    v_fma_f32 v181, v181, v196, v192
    v_mfma_f32_16x16x32_bf16 v[156:159], v[120:123], a[12:15], 0
    buffer_load_dwordx4 v[120:123], v10, s[40:43], s54 offen offset:2048
    v_fma_f32 v182, v182, v196, v192
    v_fma_f32 v183, v183, v196, v192
    v_mfma_f32_16x16x32_bf16 v[144:147], v[124:127], a[16:19], v[144:147]
    v_mul_f32 v180, v180, v160
    v_mul_f32 v181, v181, v161
    v_mfma_f32_16x16x32_bf16 v[148:151], v[124:127], a[20:23], v[148:151]
    v_mul_f32 v182, v182, v162
    v_mul_f32 v183, v183, v163
    v_mfma_f32_16x16x32_bf16 v[152:155], v[124:127], a[24:27], v[152:155]
    v_exp_f32 v180, v180
    v_mfma_f32_16x16x32_bf16 v[156:159], v[124:127], a[28:31], v[156:159]
    buffer_load_dwordx4 v[124:127], v10, s[40:43], s54 offen offset:3072
    v_exp_f32 v181, v181
    v_mfma_f32_16x16x32_bf16 v[144:147], v[128:131], a[32:35], v[144:147]
    v_exp_f32 v182, v182
    v_mfma_f32_16x16x32_bf16 v[148:151], v[128:131], a[36:39], v[148:151]
    v_exp_f32 v183, v183
    v_fma_f32 v180, v180, v200, v200
    v_mfma_f32_16x16x32_bf16 v[152:155], v[128:131], a[40:43], v[152:155]
    v_fma_f32 v181, v181, v200, v200
    v_fma_f32 v182, v182, v200, v200
    v_mfma_f32_16x16x32_bf16 v[156:159], v[128:131], a[44:47], v[156:159]
    buffer_load_dwordx4 v[128:131], v11, s[40:43], s54 offen offset:0
    v_fma_f32 v183, v183, v200, v200
    v_mfma_f32_16x16x32_bf16 v[144:147], v[132:135], a[48:51], v[144:147]
    v_rcp_f32 v180, v180
    v_rcp_f32 v181, v181
    v_mfma_f32_16x16x32_bf16 v[148:151], v[132:135], a[52:55], v[148:151]
    v_rcp_f32 v182, v182
    v_mfma_f32_16x16x32_bf16 v[152:155], v[132:135], a[56:59], v[152:155]
    v_rcp_f32 v183, v183
    v_mfma_f32_16x16x32_bf16 v[156:159], v[132:135], a[60:63], v[156:159]
    buffer_load_dwordx4 v[132:135], v11, s[40:43], s54 offen offset:1024
    v_mul_f32 v180, v180, v160
    v_mfma_f32_16x16x32_bf16 v[144:147], v[136:139], a[64:67], v[144:147]
    v_mul_f32 v181, v181, v161
    v_mul_f32 v182, v182, v162
    v_mfma_f32_16x16x32_bf16 v[148:151], v[136:139], a[68:71], v[148:151]
    v_mul_f32 v183, v183, v163
    v_cvt_pk_bf16_f32 v184, v180, v181
    v_mfma_f32_16x16x32_bf16 v[152:155], v[136:139], a[72:75], v[152:155]
    v_cvt_pk_bf16_f32 v185, v182, v183
    ds_write_b64 v222, v[184:185] offset:8192
    v_mul_f32 v186, v164, v164
    v_mfma_f32_16x16x32_bf16 v[156:159], v[136:139], a[76:79], v[156:159]
    buffer_load_dwordx4 v[136:139], v7, s[40:43], s55 offen offset:0
    v_mul_f32 v187, v165, v165
    v_mul_f32 v188, v166, v166
    v_mfma_f32_16x16x32_bf16 v[144:147], v[140:143], a[80:83], v[144:147]
    v_mul_f32 v189, v167, v167
    v_fma_f32 v186, v186, v197, v193
    v_mfma_f32_16x16x32_bf16 v[148:151], v[140:143], a[84:87], v[148:151]
    v_fma_f32 v187, v187, v197, v193
    v_fma_f32 v188, v188, v197, v193
    v_mfma_f32_16x16x32_bf16 v[152:155], v[140:143], a[88:91], v[152:155]
    v_fma_f32 v189, v189, v197, v193
    v_mul_f32 v186, v186, v164
    v_mfma_f32_16x16x32_bf16 v[156:159], v[140:143], a[92:95], v[156:159]
    buffer_load_dwordx4 v[140:143], v7, s[40:43], s55 offen offset:1024
    v_mul_f32 v187, v187, v165
    v_mul_f32 v188, v188, v166
    v_mfma_f32_16x16x32_bf16 v[144:147], v[16:19], a[96:99], v[144:147]
    v_mul_f32 v189, v189, v167
    v_exp_f32 v186, v186
    v_mfma_f32_16x16x32_bf16 v[148:151], v[16:19], a[100:103], v[148:151]
    v_exp_f32 v187, v187
    v_mfma_f32_16x16x32_bf16 v[152:155], v[16:19], a[104:107], v[152:155]
    v_exp_f32 v188, v188
    v_mfma_f32_16x16x32_bf16 v[156:159], v[16:19], a[108:111], v[156:159]
    buffer_load_dwordx4 v[16:19], v7, s[40:43], s55 offen offset:2048
    v_exp_f32 v189, v189
    v_mfma_f32_16x16x32_bf16 v[144:147], v[20:23], a[112:115], v[144:147]
    v_fma_f32 v186, v186, v201, v201
    v_mfma_f32_16x16x32_bf16 v[148:151], v[20:23], a[116:119], v[148:151]
    v_fma_f32 v187, v187, v201, v201
    v_fma_f32 v188, v188, v201, v201
    v_mfma_f32_16x16x32_bf16 v[152:155], v[20:23], a[120:123], v[152:155]
    v_fma_f32 v189, v189, v201, v201
    v_rcp_f32 v186, v186
    v_mfma_f32_16x16x32_bf16 v[156:159], v[20:23], a[124:127], v[156:159]
    buffer_load_dwordx4 v[20:23], v7, s[40:43], s55 offen offset:3072
    v_rcp_f32 v187, v187
    v_mfma_f32_16x16x32_bf16 v[144:147], v[24:27], a[128:131], v[144:147]
    v_rcp_f32 v188, v188
    v_mfma_f32_16x16x32_bf16 v[148:151], v[24:27], a[132:135], v[148:151]
    v_rcp_f32 v189, v189
    v_mfma_f32_16x16x32_bf16 v[152:155], v[24:27], a[136:139], v[152:155]
    v_mul_f32 v186, v186, v164
    v_mul_f32 v187, v187, v165
    v_mfma_f32_16x16x32_bf16 v[156:159], v[24:27], a[140:143], v[156:159]
    buffer_load_dwordx4 v[24:27], v8, s[40:43], s55 offen offset:0
    v_mul_f32 v188, v188, v166
    v_mul_f32 v189, v189, v167
    v_mfma_f32_16x16x32_bf16 v[144:147], v[28:31], a[144:147], v[144:147]
    v_cvt_pk_bf16_f32 v190, v186, v187
    v_cvt_pk_bf16_f32 v191, v188, v189
    v_mfma_f32_16x16x32_bf16 v[148:151], v[28:31], a[148:151], v[148:151]
    ds_write_b64 v222, v[190:191] offset:26624
    v_mul_f32 v180, v168, v168
    v_mfma_f32_16x16x32_bf16 v[152:155], v[28:31], a[152:155], v[152:155]
    v_mul_f32 v181, v169, v169
    v_mul_f32 v182, v170, v170
    v_mfma_f32_16x16x32_bf16 v[156:159], v[28:31], a[156:159], v[156:159]
    buffer_load_dwordx4 v[28:31], v8, s[40:43], s55 offen offset:1024
    v_mul_f32 v183, v171, v171
    v_fma_f32 v180, v180, v198, v194
    v_mfma_f32_16x16x32_bf16 v[144:147], v[32:35], a[160:163], v[144:147]
    v_fma_f32 v181, v181, v198, v194
    v_fma_f32 v182, v182, v198, v194
    v_mfma_f32_16x16x32_bf16 v[148:151], v[32:35], a[164:167], v[148:151]
    v_fma_f32 v183, v183, v198, v194
    v_mul_f32 v180, v180, v168
    v_mfma_f32_16x16x32_bf16 v[152:155], v[32:35], a[168:171], v[152:155]
    v_mul_f32 v181, v181, v169
    v_mul_f32 v182, v182, v170
    v_mfma_f32_16x16x32_bf16 v[156:159], v[32:35], a[172:175], v[156:159]
    buffer_load_dwordx4 v[32:35], v8, s[40:43], s55 offen offset:2048
    v_mul_f32 v183, v183, v171
    v_exp_f32 v180, v180
    v_mfma_f32_16x16x32_bf16 v[144:147], v[36:39], a[176:179], v[144:147]
    v_exp_f32 v181, v181
    v_mfma_f32_16x16x32_bf16 v[148:151], v[36:39], a[180:183], v[148:151]
    v_exp_f32 v182, v182
    v_mfma_f32_16x16x32_bf16 v[152:155], v[36:39], a[184:187], v[152:155]
    v_exp_f32 v183, v183
    v_mfma_f32_16x16x32_bf16 v[156:159], v[36:39], a[188:191], v[156:159]
    buffer_load_dwordx4 v[36:39], v8, s[40:43], s55 offen offset:3072
    v_fma_f32 v180, v180, v202, v202
    v_fma_f32 v181, v181, v202, v202
    v_mfma_f32_16x16x32_bf16 v[144:147], v[40:43], a[192:195], v[144:147]
    v_fma_f32 v182, v182, v202, v202
    v_fma_f32 v183, v183, v202, v202
    v_mfma_f32_16x16x32_bf16 v[148:151], v[40:43], a[196:199], v[148:151]
    v_rcp_f32 v180, v180
    v_mfma_f32_16x16x32_bf16 v[152:155], v[40:43], a[200:203], v[152:155]
    v_rcp_f32 v181, v181
    v_mfma_f32_16x16x32_bf16 v[156:159], v[40:43], a[204:207], v[156:159]
    buffer_load_dwordx4 v[40:43], v9, s[40:43], s55 offen offset:0
    v_rcp_f32 v182, v182
    v_mfma_f32_16x16x32_bf16 v[144:147], v[44:47], a[208:211], v[144:147]
    v_rcp_f32 v183, v183
    v_mfma_f32_16x16x32_bf16 v[148:151], v[44:47], a[212:215], v[148:151]
    v_mul_f32 v180, v180, v168
    v_mul_f32 v181, v181, v169
    v_mfma_f32_16x16x32_bf16 v[152:155], v[44:47], a[216:219], v[152:155]
    v_mul_f32 v182, v182, v170
    v_mul_f32 v183, v183, v171
    v_mfma_f32_16x16x32_bf16 v[156:159], v[44:47], a[220:223], v[156:159]
    buffer_load_dwordx4 v[44:47], v9, s[40:43], s55 offen offset:1024
    v_cvt_pk_bf16_f32 v184, v180, v181
    v_cvt_pk_bf16_f32 v185, v182, v183
    s_waitcnt vmcnt(31)
    v_mfma_f32_16x16x32_bf16 v[144:147], v[48:51], a[224:227], v[144:147]
    ds_write_b64 v223, v[184:185] offset:8192
    v_mul_f32 v186, v172, v172
    v_mul_f32 v187, v173, v173
    v_mfma_f32_16x16x32_bf16 v[148:151], v[48:51], a[228:231], v[148:151]
    v_mul_f32 v188, v174, v174
    v_mul_f32 v189, v175, v175
    v_mfma_f32_16x16x32_bf16 v[152:155], v[48:51], a[232:235], v[152:155]
    v_fma_f32 v186, v186, v199, v195
    v_fma_f32 v187, v187, v199, v195
    v_mfma_f32_16x16x32_bf16 v[156:159], v[48:51], a[236:239], v[156:159]
    buffer_load_dwordx4 v[48:51], v9, s[40:43], s55 offen offset:2048
    v_fma_f32 v188, v188, v199, v195
    v_fma_f32 v189, v189, v199, v195
    v_mfma_f32_16x16x32_bf16 v[144:147], v[52:55], a[240:243], v[144:147]
    v_mul_f32 v186, v186, v172
    v_mul_f32 v187, v187, v173
    v_mfma_f32_16x16x32_bf16 v[148:151], v[52:55], a[244:247], v[148:151]
    v_mul_f32 v188, v188, v174
    v_mul_f32 v189, v189, v175
    v_mfma_f32_16x16x32_bf16 v[152:155], v[52:55], a[248:251], v[152:155]
    v_exp_f32 v186, v186
    v_mfma_f32_16x16x32_bf16 v[156:159], v[52:55], a[252:255], v[156:159]
    buffer_load_dwordx4 v[52:55], v9, s[40:43], s55 offen offset:3072
    v_exp_f32 v187, v187
    s_waitcnt vmcnt(31)
    v_mfma_f32_16x16x32_bf16 v[144:147], v[56:59], v[224:227], v[144:147]
    v_exp_f32 v188, v188
    v_mfma_f32_16x16x32_bf16 v[148:151], v[56:59], v[228:231], v[148:151]
    v_exp_f32 v189, v189
    v_mfma_f32_16x16x32_bf16 v[152:155], v[56:59], v[232:235], v[152:155]
    v_fma_f32 v186, v186, v203, v203
    v_fma_f32 v187, v187, v203, v203
    v_mfma_f32_16x16x32_bf16 v[156:159], v[56:59], v[236:239], v[156:159]
    buffer_load_dwordx4 v[56:59], v10, s[40:43], s55 offen offset:0
    v_fma_f32 v188, v188, v203, v203
    v_fma_f32 v189, v189, v203, v203
    v_mfma_f32_16x16x32_bf16 v[144:147], v[60:63], v[240:243], v[144:147]
    v_rcp_f32 v186, v186
    v_mfma_f32_16x16x32_bf16 v[148:151], v[60:63], v[244:247], v[148:151]
    v_rcp_f32 v187, v187
    v_mfma_f32_16x16x32_bf16 v[152:155], v[60:63], v[248:251], v[152:155]
    v_rcp_f32 v188, v188
    v_mfma_f32_16x16x32_bf16 v[156:159], v[60:63], v[252:255], v[156:159]
    buffer_load_dwordx4 v[60:63], v10, s[40:43], s55 offen offset:1024
    v_rcp_f32 v189, v189
    v_mul_f32 v186, v186, v172
    s_waitcnt vmcnt(18)
    v_mfma_f32_16x16x32_bf16 v[160:163], v[176:179], v[204:207], v[144:147]
    v_mul_f32 v187, v187, v173
    v_mul_f32 v188, v188, v174
    v_mfma_f32_16x16x32_bf16 v[164:167], v[176:179], v[208:211], v[148:151]
    v_mul_f32 v189, v189, v175
    v_cvt_pk_bf16_f32 v190, v186, v187
    v_mfma_f32_16x16x32_bf16 v[168:171], v[176:179], v[212:215], v[152:155]
    v_cvt_pk_bf16_f32 v191, v188, v189
    ds_write_b64 v223, v[190:191] offset:26624
    v_mfma_f32_16x16x32_bf16 v[172:175], v[176:179], v[216:219], v[156:159]
    s_add_u32 s91, s91, 1024
    buffer_load_dwordx4 v[176:179], v12, s[40:43], s91 offen
    v_mfma_f32_16x16x32_bf16 v[144:147], v[64:67], a[0:3], 0
    v_mul_f32 v180, v160, v160
    v_mul_f32 v181, v161, v161
    v_mfma_f32_16x16x32_bf16 v[148:151], v[64:67], a[4:7], 0
    v_mul_f32 v182, v162, v162
    v_mul_f32 v183, v163, v163
    v_mfma_f32_16x16x32_bf16 v[152:155], v[64:67], a[8:11], 0
    v_fma_f32 v180, v180, v196, v192
    v_fma_f32 v181, v181, v196, v192
    v_mfma_f32_16x16x32_bf16 v[156:159], v[64:67], a[12:15], 0
    buffer_load_dwordx4 v[64:67], v10, s[40:43], s55 offen offset:2048
    v_fma_f32 v182, v182, v196, v192
    v_fma_f32 v183, v183, v196, v192
    v_mfma_f32_16x16x32_bf16 v[144:147], v[68:71], a[16:19], v[144:147]
    v_mul_f32 v180, v180, v160
    v_mul_f32 v181, v181, v161
    v_mfma_f32_16x16x32_bf16 v[148:151], v[68:71], a[20:23], v[148:151]
    v_mul_f32 v182, v182, v162
    v_mul_f32 v183, v183, v163
    v_mfma_f32_16x16x32_bf16 v[152:155], v[68:71], a[24:27], v[152:155]
    v_exp_f32 v180, v180
    v_mfma_f32_16x16x32_bf16 v[156:159], v[68:71], a[28:31], v[156:159]
    buffer_load_dwordx4 v[68:71], v10, s[40:43], s55 offen offset:3072
    v_exp_f32 v181, v181
    v_mfma_f32_16x16x32_bf16 v[144:147], v[72:75], a[32:35], v[144:147]
    v_exp_f32 v182, v182
    v_mfma_f32_16x16x32_bf16 v[148:151], v[72:75], a[36:39], v[148:151]
    v_exp_f32 v183, v183
    v_fma_f32 v180, v180, v200, v200
    v_mfma_f32_16x16x32_bf16 v[152:155], v[72:75], a[40:43], v[152:155]
    v_fma_f32 v181, v181, v200, v200
    v_fma_f32 v182, v182, v200, v200
    v_mfma_f32_16x16x32_bf16 v[156:159], v[72:75], a[44:47], v[156:159]
    buffer_load_dwordx4 v[72:75], v11, s[40:43], s55 offen offset:0
    v_fma_f32 v183, v183, v200, v200
    v_mfma_f32_16x16x32_bf16 v[144:147], v[76:79], a[48:51], v[144:147]
    v_rcp_f32 v180, v180
    v_rcp_f32 v181, v181
    v_mfma_f32_16x16x32_bf16 v[148:151], v[76:79], a[52:55], v[148:151]
    v_rcp_f32 v182, v182
    v_mfma_f32_16x16x32_bf16 v[152:155], v[76:79], a[56:59], v[152:155]
    v_rcp_f32 v183, v183
    v_mfma_f32_16x16x32_bf16 v[156:159], v[76:79], a[60:63], v[156:159]
    buffer_load_dwordx4 v[76:79], v11, s[40:43], s55 offen offset:1024
    v_mul_f32 v180, v180, v160
    v_mfma_f32_16x16x32_bf16 v[144:147], v[80:83], a[64:67], v[144:147]
    v_mul_f32 v181, v181, v161
    v_mul_f32 v182, v182, v162
    v_mfma_f32_16x16x32_bf16 v[148:151], v[80:83], a[68:71], v[148:151]
    v_mul_f32 v183, v183, v163
    v_cvt_pk_bf16_f32 v184, v180, v181
    v_mfma_f32_16x16x32_bf16 v[152:155], v[80:83], a[72:75], v[152:155]
    v_cvt_pk_bf16_f32 v185, v182, v183
    ds_write_b64 v222, v[184:185] offset:10240
    v_mul_f32 v186, v164, v164
    v_mfma_f32_16x16x32_bf16 v[156:159], v[80:83], a[76:79], v[156:159]
    buffer_load_dwordx4 v[80:83], v7, s[40:43], s56 offen offset:0
    v_mul_f32 v187, v165, v165
    v_mul_f32 v188, v166, v166
    v_mfma_f32_16x16x32_bf16 v[144:147], v[84:87], a[80:83], v[144:147]
    v_mul_f32 v189, v167, v167
    v_fma_f32 v186, v186, v197, v193
    v_mfma_f32_16x16x32_bf16 v[148:151], v[84:87], a[84:87], v[148:151]
    v_fma_f32 v187, v187, v197, v193
    v_fma_f32 v188, v188, v197, v193
    v_mfma_f32_16x16x32_bf16 v[152:155], v[84:87], a[88:91], v[152:155]
    v_fma_f32 v189, v189, v197, v193
    v_mul_f32 v186, v186, v164
    v_mfma_f32_16x16x32_bf16 v[156:159], v[84:87], a[92:95], v[156:159]
    buffer_load_dwordx4 v[84:87], v7, s[40:43], s56 offen offset:1024
    v_mul_f32 v187, v187, v165
    v_mul_f32 v188, v188, v166
    v_mfma_f32_16x16x32_bf16 v[144:147], v[88:91], a[96:99], v[144:147]
    v_mul_f32 v189, v189, v167
    v_exp_f32 v186, v186
    v_mfma_f32_16x16x32_bf16 v[148:151], v[88:91], a[100:103], v[148:151]
    v_exp_f32 v187, v187
    v_mfma_f32_16x16x32_bf16 v[152:155], v[88:91], a[104:107], v[152:155]
    v_exp_f32 v188, v188
    v_mfma_f32_16x16x32_bf16 v[156:159], v[88:91], a[108:111], v[156:159]
    buffer_load_dwordx4 v[88:91], v7, s[40:43], s56 offen offset:2048
    v_exp_f32 v189, v189
    v_mfma_f32_16x16x32_bf16 v[144:147], v[92:95], a[112:115], v[144:147]
    v_fma_f32 v186, v186, v201, v201
    v_mfma_f32_16x16x32_bf16 v[148:151], v[92:95], a[116:119], v[148:151]
    v_fma_f32 v187, v187, v201, v201
    v_fma_f32 v188, v188, v201, v201
    v_mfma_f32_16x16x32_bf16 v[152:155], v[92:95], a[120:123], v[152:155]
    v_fma_f32 v189, v189, v201, v201
    v_rcp_f32 v186, v186
    v_mfma_f32_16x16x32_bf16 v[156:159], v[92:95], a[124:127], v[156:159]
    buffer_load_dwordx4 v[92:95], v7, s[40:43], s56 offen offset:3072
    v_rcp_f32 v187, v187
    v_mfma_f32_16x16x32_bf16 v[144:147], v[96:99], a[128:131], v[144:147]
    v_rcp_f32 v188, v188
    v_mfma_f32_16x16x32_bf16 v[148:151], v[96:99], a[132:135], v[148:151]
    v_rcp_f32 v189, v189
    v_mfma_f32_16x16x32_bf16 v[152:155], v[96:99], a[136:139], v[152:155]
    v_mul_f32 v186, v186, v164
    v_mul_f32 v187, v187, v165
    v_mfma_f32_16x16x32_bf16 v[156:159], v[96:99], a[140:143], v[156:159]
    buffer_load_dwordx4 v[96:99], v8, s[40:43], s56 offen offset:0
    v_mul_f32 v188, v188, v166
    v_mul_f32 v189, v189, v167
    v_mfma_f32_16x16x32_bf16 v[144:147], v[100:103], a[144:147], v[144:147]
    v_cvt_pk_bf16_f32 v190, v186, v187
    v_cvt_pk_bf16_f32 v191, v188, v189
    v_mfma_f32_16x16x32_bf16 v[148:151], v[100:103], a[148:151], v[148:151]
    ds_write_b64 v222, v[190:191] offset:28672
    v_mul_f32 v180, v168, v168
    v_mfma_f32_16x16x32_bf16 v[152:155], v[100:103], a[152:155], v[152:155]
    v_mul_f32 v181, v169, v169
    v_mul_f32 v182, v170, v170
    v_mfma_f32_16x16x32_bf16 v[156:159], v[100:103], a[156:159], v[156:159]
    buffer_load_dwordx4 v[100:103], v8, s[40:43], s56 offen offset:1024
    v_mul_f32 v183, v171, v171
    v_fma_f32 v180, v180, v198, v194
    v_mfma_f32_16x16x32_bf16 v[144:147], v[104:107], a[160:163], v[144:147]
    v_fma_f32 v181, v181, v198, v194
    v_fma_f32 v182, v182, v198, v194
    v_mfma_f32_16x16x32_bf16 v[148:151], v[104:107], a[164:167], v[148:151]
    v_fma_f32 v183, v183, v198, v194
    v_mul_f32 v180, v180, v168
    v_mfma_f32_16x16x32_bf16 v[152:155], v[104:107], a[168:171], v[152:155]
    v_mul_f32 v181, v181, v169
    v_mul_f32 v182, v182, v170
    v_mfma_f32_16x16x32_bf16 v[156:159], v[104:107], a[172:175], v[156:159]
    buffer_load_dwordx4 v[104:107], v8, s[40:43], s56 offen offset:2048
    v_mul_f32 v183, v183, v171
    v_exp_f32 v180, v180
    v_mfma_f32_16x16x32_bf16 v[144:147], v[108:111], a[176:179], v[144:147]
    v_exp_f32 v181, v181
    v_mfma_f32_16x16x32_bf16 v[148:151], v[108:111], a[180:183], v[148:151]
    v_exp_f32 v182, v182
    v_mfma_f32_16x16x32_bf16 v[152:155], v[108:111], a[184:187], v[152:155]
    v_exp_f32 v183, v183
    v_mfma_f32_16x16x32_bf16 v[156:159], v[108:111], a[188:191], v[156:159]
    buffer_load_dwordx4 v[108:111], v8, s[40:43], s56 offen offset:3072
    v_fma_f32 v180, v180, v202, v202
    v_fma_f32 v181, v181, v202, v202
    v_mfma_f32_16x16x32_bf16 v[144:147], v[112:115], a[192:195], v[144:147]
    v_fma_f32 v182, v182, v202, v202
    v_fma_f32 v183, v183, v202, v202
    v_mfma_f32_16x16x32_bf16 v[148:151], v[112:115], a[196:199], v[148:151]
    v_rcp_f32 v180, v180
    v_mfma_f32_16x16x32_bf16 v[152:155], v[112:115], a[200:203], v[152:155]
    v_rcp_f32 v181, v181
    v_mfma_f32_16x16x32_bf16 v[156:159], v[112:115], a[204:207], v[156:159]
    buffer_load_dwordx4 v[112:115], v9, s[40:43], s56 offen offset:0
    v_rcp_f32 v182, v182
    v_mfma_f32_16x16x32_bf16 v[144:147], v[116:119], a[208:211], v[144:147]
    v_rcp_f32 v183, v183
    v_mfma_f32_16x16x32_bf16 v[148:151], v[116:119], a[212:215], v[148:151]
    v_mul_f32 v180, v180, v168
    v_mul_f32 v181, v181, v169
    v_mfma_f32_16x16x32_bf16 v[152:155], v[116:119], a[216:219], v[152:155]
    v_mul_f32 v182, v182, v170
    v_mul_f32 v183, v183, v171
    v_mfma_f32_16x16x32_bf16 v[156:159], v[116:119], a[220:223], v[156:159]
    buffer_load_dwordx4 v[116:119], v9, s[40:43], s56 offen offset:1024
    v_cvt_pk_bf16_f32 v184, v180, v181
    v_cvt_pk_bf16_f32 v185, v182, v183
    s_waitcnt vmcnt(31)
    v_mfma_f32_16x16x32_bf16 v[144:147], v[120:123], a[224:227], v[144:147]
    ds_write_b64 v223, v[184:185] offset:10240
    v_mul_f32 v186, v172, v172
    v_mul_f32 v187, v173, v173
    v_mfma_f32_16x16x32_bf16 v[148:151], v[120:123], a[228:231], v[148:151]
    v_mul_f32 v188, v174, v174
    v_mul_f32 v189, v175, v175
    v_mfma_f32_16x16x32_bf16 v[152:155], v[120:123], a[232:235], v[152:155]
    v_fma_f32 v186, v186, v199, v195
    v_fma_f32 v187, v187, v199, v195
    v_mfma_f32_16x16x32_bf16 v[156:159], v[120:123], a[236:239], v[156:159]
    buffer_load_dwordx4 v[120:123], v9, s[40:43], s56 offen offset:2048
    v_fma_f32 v188, v188, v199, v195
    v_fma_f32 v189, v189, v199, v195
    v_mfma_f32_16x16x32_bf16 v[144:147], v[124:127], a[240:243], v[144:147]
    v_mul_f32 v186, v186, v172
    v_mul_f32 v187, v187, v173
    v_mfma_f32_16x16x32_bf16 v[148:151], v[124:127], a[244:247], v[148:151]
    v_mul_f32 v188, v188, v174
    v_mul_f32 v189, v189, v175
    v_mfma_f32_16x16x32_bf16 v[152:155], v[124:127], a[248:251], v[152:155]
    v_exp_f32 v186, v186
    v_mfma_f32_16x16x32_bf16 v[156:159], v[124:127], a[252:255], v[156:159]
    buffer_load_dwordx4 v[124:127], v9, s[40:43], s56 offen offset:3072
    v_exp_f32 v187, v187
    s_waitcnt vmcnt(31)
    v_mfma_f32_16x16x32_bf16 v[144:147], v[128:131], v[224:227], v[144:147]
    v_exp_f32 v188, v188
    v_mfma_f32_16x16x32_bf16 v[148:151], v[128:131], v[228:231], v[148:151]
    v_exp_f32 v189, v189
    v_mfma_f32_16x16x32_bf16 v[152:155], v[128:131], v[232:235], v[152:155]
    v_fma_f32 v186, v186, v203, v203
    v_fma_f32 v187, v187, v203, v203
    v_mfma_f32_16x16x32_bf16 v[156:159], v[128:131], v[236:239], v[156:159]
    buffer_load_dwordx4 v[128:131], v10, s[40:43], s56 offen offset:0
    v_fma_f32 v188, v188, v203, v203
    v_fma_f32 v189, v189, v203, v203
    v_mfma_f32_16x16x32_bf16 v[144:147], v[132:135], v[240:243], v[144:147]
    v_rcp_f32 v186, v186
    v_mfma_f32_16x16x32_bf16 v[148:151], v[132:135], v[244:247], v[148:151]
    v_rcp_f32 v187, v187
    v_mfma_f32_16x16x32_bf16 v[152:155], v[132:135], v[248:251], v[152:155]
    v_rcp_f32 v188, v188
    v_mfma_f32_16x16x32_bf16 v[156:159], v[132:135], v[252:255], v[156:159]
    buffer_load_dwordx4 v[132:135], v10, s[40:43], s56 offen offset:1024
    v_rcp_f32 v189, v189
    v_mul_f32 v186, v186, v172
    s_waitcnt vmcnt(18)
    v_mfma_f32_16x16x32_bf16 v[160:163], v[176:179], v[204:207], v[144:147]
    v_mul_f32 v187, v187, v173
    v_mul_f32 v188, v188, v174
    v_mfma_f32_16x16x32_bf16 v[164:167], v[176:179], v[208:211], v[148:151]
    v_mul_f32 v189, v189, v175
    v_cvt_pk_bf16_f32 v190, v186, v187
    v_mfma_f32_16x16x32_bf16 v[168:171], v[176:179], v[212:215], v[152:155]
    v_cvt_pk_bf16_f32 v191, v188, v189
    ds_write_b64 v223, v[190:191] offset:28672
    v_mfma_f32_16x16x32_bf16 v[172:175], v[176:179], v[216:219], v[156:159]
    s_add_u32 s91, s91, 1024
    buffer_load_dwordx4 v[176:179], v12, s[40:43], s91 offen
    s_mov_b32 s18, 262144
    s_waitcnt lgkmcnt(0)
H3_l:
    s_cmp_ge_u32 s16, 128
    s_cbranch_scc1 H3_b
    s_sub_u32 s18, s18, 1
    s_cbranch_scc1 H3_b
    s_mov_b32 s16, 0
    s_atomic_add s16, s[20:21], s23 glc
    s_waitcnt lgkmcnt(0)
    s_branch H3_l
H3_b:
    v_mfma_f32_16x16x32_bf16 v[144:147], v[136:139], a[0:3], 0
    v_mul_f32 v180, v160, v160
    v_mul_f32 v181, v161, v161
    v_mfma_f32_16x16x32_bf16 v[148:151], v[136:139], a[4:7], 0
    v_mul_f32 v182, v162, v162
    v_mul_f32 v183, v163, v163
    v_mfma_f32_16x16x32_bf16 v[152:155], v[136:139], a[8:11], 0
    v_fma_f32 v180, v180, v196, v192
    v_fma_f32 v181, v181, v196, v192
    v_mfma_f32_16x16x32_bf16 v[156:159], v[136:139], a[12:15], 0
    buffer_load_dwordx4 v[136:139], v10, s[40:43], s56 offen offset:2048
    v_fma_f32 v182, v182, v196, v192
    v_fma_f32 v183, v183, v196, v192
    v_mfma_f32_16x16x32_bf16 v[144:147], v[140:143], a[16:19], v[144:147]
    v_mul_f32 v180, v180, v160
    v_mul_f32 v181, v181, v161
    v_mfma_f32_16x16x32_bf16 v[148:151], v[140:143], a[20:23], v[148:151]
    v_mul_f32 v182, v182, v162
    v_mul_f32 v183, v183, v163
    v_mfma_f32_16x16x32_bf16 v[152:155], v[140:143], a[24:27], v[152:155]
    v_exp_f32 v180, v180
    v_mfma_f32_16x16x32_bf16 v[156:159], v[140:143], a[28:31], v[156:159]
    buffer_load_dwordx4 v[140:143], v10, s[40:43], s56 offen offset:3072
    v_exp_f32 v181, v181
    v_mfma_f32_16x16x32_bf16 v[144:147], v[16:19], a[32:35], v[144:147]
    v_exp_f32 v182, v182
    v_mfma_f32_16x16x32_bf16 v[148:151], v[16:19], a[36:39], v[148:151]
    v_exp_f32 v183, v183
    v_fma_f32 v180, v180, v200, v200
    v_mfma_f32_16x16x32_bf16 v[152:155], v[16:19], a[40:43], v[152:155]
    v_fma_f32 v181, v181, v200, v200
    v_fma_f32 v182, v182, v200, v200
    v_mfma_f32_16x16x32_bf16 v[156:159], v[16:19], a[44:47], v[156:159]
    buffer_load_dwordx4 v[16:19], v11, s[40:43], s56 offen offset:0
    v_fma_f32 v183, v183, v200, v200
    v_mfma_f32_16x16x32_bf16 v[144:147], v[20:23], a[48:51], v[144:147]
    v_rcp_f32 v180, v180
    v_rcp_f32 v181, v181
    v_mfma_f32_16x16x32_bf16 v[148:151], v[20:23], a[52:55], v[148:151]
    v_rcp_f32 v182, v182
    v_mfma_f32_16x16x32_bf16 v[152:155], v[20:23], a[56:59], v[152:155]
    v_rcp_f32 v183, v183
    v_mfma_f32_16x16x32_bf16 v[156:159], v[20:23], a[60:63], v[156:159]
    buffer_load_dwordx4 v[20:23], v11, s[40:43], s56 offen offset:1024
    v_mul_f32 v180, v180, v160
    v_mfma_f32_16x16x32_bf16 v[144:147], v[24:27], a[64:67], v[144:147]
    v_mul_f32 v181, v181, v161
    v_mul_f32 v182, v182, v162
    v_mfma_f32_16x16x32_bf16 v[148:151], v[24:27], a[68:71], v[148:151]
    v_mul_f32 v183, v183, v163
    v_cvt_pk_bf16_f32 v184, v180, v181
    v_mfma_f32_16x16x32_bf16 v[152:155], v[24:27], a[72:75], v[152:155]
    v_cvt_pk_bf16_f32 v185, v182, v183
    ds_write_b64 v222, v[184:185] offset:12288
    v_mul_f32 v186, v164, v164
    v_mfma_f32_16x16x32_bf16 v[156:159], v[24:27], a[76:79], v[156:159]
    buffer_load_dwordx4 v[24:27], v7, s[40:43], s76 offen offset:0 sc1
    v_mul_f32 v187, v165, v165
    v_mul_f32 v188, v166, v166
    v_mfma_f32_16x16x32_bf16 v[144:147], v[28:31], a[80:83], v[144:147]
    v_mul_f32 v189, v167, v167
    v_fma_f32 v186, v186, v197, v193
    v_mfma_f32_16x16x32_bf16 v[148:151], v[28:31], a[84:87], v[148:151]
    v_fma_f32 v187, v187, v197, v193
    v_fma_f32 v188, v188, v197, v193
    v_mfma_f32_16x16x32_bf16 v[152:155], v[28:31], a[88:91], v[152:155]
    v_fma_f32 v189, v189, v197, v193
    v_mul_f32 v186, v186, v164
    v_mfma_f32_16x16x32_bf16 v[156:159], v[28:31], a[92:95], v[156:159]
    buffer_load_dwordx4 v[28:31], v7, s[40:43], s76 offen offset:1024 sc1
    v_mul_f32 v187, v187, v165
    v_mul_f32 v188, v188, v166
    v_mfma_f32_16x16x32_bf16 v[144:147], v[32:35], a[96:99], v[144:147]
    v_mul_f32 v189, v189, v167
    v_exp_f32 v186, v186
    v_mfma_f32_16x16x32_bf16 v[148:151], v[32:35], a[100:103], v[148:151]
    v_exp_f32 v187, v187
    v_mfma_f32_16x16x32_bf16 v[152:155], v[32:35], a[104:107], v[152:155]
    v_exp_f32 v188, v188
    v_mfma_f32_16x16x32_bf16 v[156:159], v[32:35], a[108:111], v[156:159]
    buffer_load_dwordx4 v[32:35], v7, s[40:43], s76 offen offset:2048 sc1
    v_exp_f32 v189, v189
    v_mfma_f32_16x16x32_bf16 v[144:147], v[36:39], a[112:115], v[144:147]
    v_fma_f32 v186, v186, v201, v201
    v_mfma_f32_16x16x32_bf16 v[148:151], v[36:39], a[116:119], v[148:151]
    v_fma_f32 v187, v187, v201, v201
    v_fma_f32 v188, v188, v201, v201
    v_mfma_f32_16x16x32_bf16 v[152:155], v[36:39], a[120:123], v[152:155]
    v_fma_f32 v189, v189, v201, v201
    v_rcp_f32 v186, v186
    v_mfma_f32_16x16x32_bf16 v[156:159], v[36:39], a[124:127], v[156:159]
    buffer_load_dwordx4 v[36:39], v7, s[40:43], s76 offen offset:3072 sc1
    v_rcp_f32 v187, v187
    v_mfma_f32_16x16x32_bf16 v[144:147], v[40:43], a[128:131], v[144:147]
    v_rcp_f32 v188, v188
    v_mfma_f32_16x16x32_bf16 v[148:151], v[40:43], a[132:135], v[148:151]
    v_rcp_f32 v189, v189
    v_mfma_f32_16x16x32_bf16 v[152:155], v[40:43], a[136:139], v[152:155]
    v_mul_f32 v186, v186, v164
    v_mul_f32 v187, v187, v165
    v_mfma_f32_16x16x32_bf16 v[156:159], v[40:43], a[140:143], v[156:159]
    buffer_load_dwordx4 v[40:43], v8, s[40:43], s76 offen offset:0 sc1
    v_mul_f32 v188, v188, v166
    v_mul_f32 v189, v189, v167
    v_mfma_f32_16x16x32_bf16 v[144:147], v[44:47], a[144:147], v[144:147]
    v_cvt_pk_bf16_f32 v190, v186, v187
    v_cvt_pk_bf16_f32 v191, v188, v189
    v_mfma_f32_16x16x32_bf16 v[148:151], v[44:47], a[148:151], v[148:151]
    ds_write_b64 v222, v[190:191] offset:30720
    v_mul_f32 v180, v168, v168
    v_mfma_f32_16x16x32_bf16 v[152:155], v[44:47], a[152:155], v[152:155]
    v_mul_f32 v181, v169, v169
    v_mul_f32 v182, v170, v170
    v_mfma_f32_16x16x32_bf16 v[156:159], v[44:47], a[156:159], v[156:159]
    buffer_load_dwordx4 v[44:47], v8, s[40:43], s76 offen offset:1024 sc1
    v_mul_f32 v183, v171, v171
    v_fma_f32 v180, v180, v198, v194
    v_mfma_f32_16x16x32_bf16 v[144:147], v[48:51], a[160:163], v[144:147]
    v_fma_f32 v181, v181, v198, v194
    v_fma_f32 v182, v182, v198, v194
    v_mfma_f32_16x16x32_bf16 v[148:151], v[48:51], a[164:167], v[148:151]
    v_fma_f32 v183, v183, v198, v194
    v_mul_f32 v180, v180, v168
    v_mfma_f32_16x16x32_bf16 v[152:155], v[48:51], a[168:171], v[152:155]
    v_mul_f32 v181, v181, v169
    v_mul_f32 v182, v182, v170
    v_mfma_f32_16x16x32_bf16 v[156:159], v[48:51], a[172:175], v[156:159]
    buffer_load_dwordx4 v[48:51], v8, s[40:43], s76 offen offset:2048 sc1
    v_mul_f32 v183, v183, v171
    v_exp_f32 v180, v180
    v_mfma_f32_16x16x32_bf16 v[144:147], v[52:55], a[176:179], v[144:147]
    v_exp_f32 v181, v181
    v_mfma_f32_16x16x32_bf16 v[148:151], v[52:55], a[180:183], v[148:151]
    v_exp_f32 v182, v182
    v_mfma_f32_16x16x32_bf16 v[152:155], v[52:55], a[184:187], v[152:155]
    v_exp_f32 v183, v183
    v_mfma_f32_16x16x32_bf16 v[156:159], v[52:55], a[188:191], v[156:159]
    buffer_load_dwordx4 v[52:55], v8, s[40:43], s76 offen offset:3072 sc1
    v_fma_f32 v180, v180, v202, v202
    v_fma_f32 v181, v181, v202, v202
    v_mfma_f32_16x16x32_bf16 v[144:147], v[56:59], a[192:195], v[144:147]
    v_fma_f32 v182, v182, v202, v202
    v_fma_f32 v183, v183, v202, v202
    v_mfma_f32_16x16x32_bf16 v[148:151], v[56:59], a[196:199], v[148:151]
    v_rcp_f32 v180, v180
    v_mfma_f32_16x16x32_bf16 v[152:155], v[56:59], a[200:203], v[152:155]
    v_rcp_f32 v181, v181
    v_mfma_f32_16x16x32_bf16 v[156:159], v[56:59], a[204:207], v[156:159]
    buffer_load_dwordx4 v[56:59], v9, s[40:43], s76 offen offset:0 sc1
    v_rcp_f32 v182, v182
    v_mfma_f32_16x16x32_bf16 v[144:147], v[60:63], a[208:211], v[144:147]
    v_rcp_f32 v183, v183
    v_mfma_f32_16x16x32_bf16 v[148:151], v[60:63], a[212:215], v[148:151]
    v_mul_f32 v180, v180, v168
    v_mul_f32 v181, v181, v169
    v_mfma_f32_16x16x32_bf16 v[152:155], v[60:63], a[216:219], v[152:155]
    v_mul_f32 v182, v182, v170
    v_mul_f32 v183, v183, v171
    v_mfma_f32_16x16x32_bf16 v[156:159], v[60:63], a[220:223], v[156:159]
    buffer_load_dwordx4 v[60:63], v9, s[40:43], s76 offen offset:1024 sc1
    v_cvt_pk_bf16_f32 v184, v180, v181
    v_cvt_pk_bf16_f32 v185, v182, v183
    s_waitcnt vmcnt(31)
    v_mfma_f32_16x16x32_bf16 v[144:147], v[64:67], a[224:227], v[144:147]
    ds_write_b64 v223, v[184:185] offset:12288
    v_mul_f32 v186, v172, v172
    v_mul_f32 v187, v173, v173
    v_mfma_f32_16x16x32_bf16 v[148:151], v[64:67], a[228:231], v[148:151]
    v_mul_f32 v188, v174, v174
    v_mul_f32 v189, v175, v175
    v_mfma_f32_16x16x32_bf16 v[152:155], v[64:67], a[232:235], v[152:155]
    v_fma_f32 v186, v186, v199, v195
    v_fma_f32 v187, v187, v199, v195
    v_mfma_f32_16x16x32_bf16 v[156:159], v[64:67], a[236:239], v[156:159]
    buffer_load_dwordx4 v[64:67], v9, s[40:43], s76 offen offset:2048 sc1
    v_fma_f32 v188, v188, v199, v195
    v_fma_f32 v189, v189, v199, v195
    v_mfma_f32_16x16x32_bf16 v[144:147], v[68:71], a[240:243], v[144:147]
    v_mul_f32 v186, v186, v172
    v_mul_f32 v187, v187, v173
    v_mfma_f32_16x16x32_bf16 v[148:151], v[68:71], a[244:247], v[148:151]
    v_mul_f32 v188, v188, v174
    v_mul_f32 v189, v189, v175
    v_mfma_f32_16x16x32_bf16 v[152:155], v[68:71], a[248:251], v[152:155]
    v_exp_f32 v186, v186
    v_mfma_f32_16x16x32_bf16 v[156:159], v[68:71], a[252:255], v[156:159]
    buffer_load_dwordx4 v[68:71], v9, s[40:43], s76 offen offset:3072 sc1
    v_exp_f32 v187, v187
    s_waitcnt vmcnt(31)
    v_mfma_f32_16x16x32_bf16 v[144:147], v[72:75], v[224:227], v[144:147]
    v_exp_f32 v188, v188
    v_mfma_f32_16x16x32_bf16 v[148:151], v[72:75], v[228:231], v[148:151]
    v_exp_f32 v189, v189
    v_mfma_f32_16x16x32_bf16 v[152:155], v[72:75], v[232:235], v[152:155]
    v_fma_f32 v186, v186, v203, v203
    v_fma_f32 v187, v187, v203, v203
    v_mfma_f32_16x16x32_bf16 v[156:159], v[72:75], v[236:239], v[156:159]
    buffer_load_dwordx4 v[72:75], v10, s[40:43], s76 offen offset:0 sc1
    v_fma_f32 v188, v188, v203, v203
    v_fma_f32 v189, v189, v203, v203
    v_mfma_f32_16x16x32_bf16 v[144:147], v[76:79], v[240:243], v[144:147]
    v_rcp_f32 v186, v186
    v_mfma_f32_16x16x32_bf16 v[148:151], v[76:79], v[244:247], v[148:151]
    v_rcp_f32 v187, v187
    v_mfma_f32_16x16x32_bf16 v[152:155], v[76:79], v[248:251], v[152:155]
    v_rcp_f32 v188, v188
    v_mfma_f32_16x16x32_bf16 v[156:159], v[76:79], v[252:255], v[156:159]
    buffer_load_dwordx4 v[76:79], v10, s[40:43], s76 offen offset:1024 sc1
    v_rcp_f32 v189, v189
    v_mul_f32 v186, v186, v172
    s_waitcnt vmcnt(18)
    v_mfma_f32_16x16x32_bf16 v[160:163], v[176:179], v[204:207], v[144:147]
    v_mul_f32 v187, v187, v173
    v_mul_f32 v188, v188, v174
    v_mfma_f32_16x16x32_bf16 v[164:167], v[176:179], v[208:211], v[148:151]
    v_mul_f32 v189, v189, v175
    v_cvt_pk_bf16_f32 v190, v186, v187
    v_mfma_f32_16x16x32_bf16 v[168:171], v[176:179], v[212:215], v[152:155]
    v_cvt_pk_bf16_f32 v191, v188, v189
    ds_write_b64 v223, v[190:191] offset:30720
    v_mfma_f32_16x16x32_bf16 v[172:175], v[176:179], v[216:219], v[156:159]
    s_add_u32 s91, s91, 1024
    buffer_load_dwordx4 v[176:179], v12, s[40:43], s91 offen
    v_mfma_f32_16x16x32_bf16 v[144:147], v[80:83], a[0:3], 0
    v_mul_f32 v180, v160, v160
    v_mul_f32 v181, v161, v161
    v_mfma_f32_16x16x32_bf16 v[148:151], v[80:83], a[4:7], 0
    v_mul_f32 v182, v162, v162
    v_mul_f32 v183, v163, v163
    v_mfma_f32_16x16x32_bf16 v[152:155], v[80:83], a[8:11], 0
    v_fma_f32 v180, v180, v196, v192
    v_fma_f32 v181, v181, v196, v192
    v_mfma_f32_16x16x32_bf16 v[156:159], v[80:83], a[12:15], 0
    buffer_load_dwordx4 v[80:83], v10, s[40:43], s76 offen offset:2048 sc1
    v_fma_f32 v182, v182, v196, v192
    v_fma_f32 v183, v183, v196, v192
    v_mfma_f32_16x16x32_bf16 v[144:147], v[84:87], a[16:19], v[144:147]
    v_mul_f32 v180, v180, v160
    v_mul_f32 v181, v181, v161
    v_mfma_f32_16x16x32_bf16 v[148:151], v[84:87], a[20:23], v[148:151]
    v_mul_f32 v182, v182, v162
    v_mul_f32 v183, v183, v163
    v_mfma_f32_16x16x32_bf16 v[152:155], v[84:87], a[24:27], v[152:155]
    v_exp_f32 v180, v180
    v_mfma_f32_16x16x32_bf16 v[156:159], v[84:87], a[28:31], v[156:159]
    buffer_load_dwordx4 v[84:87], v10, s[40:43], s76 offen offset:3072 sc1
    v_exp_f32 v181, v181
    v_mfma_f32_16x16x32_bf16 v[144:147], v[88:91], a[32:35], v[144:147]
    v_exp_f32 v182, v182
    v_mfma_f32_16x16x32_bf16 v[148:151], v[88:91], a[36:39], v[148:151]
    v_exp_f32 v183, v183
    v_fma_f32 v180, v180, v200, v200
    v_mfma_f32_16x16x32_bf16 v[152:155], v[88:91], a[40:43], v[152:155]
    v_fma_f32 v181, v181, v200, v200
    v_fma_f32 v182, v182, v200, v200
    v_mfma_f32_16x16x32_bf16 v[156:159], v[88:91], a[44:47], v[156:159]
    buffer_load_dwordx4 v[88:91], v11, s[40:43], s76 offen offset:0 sc1
    v_fma_f32 v183, v183, v200, v200
    v_mfma_f32_16x16x32_bf16 v[144:147], v[92:95], a[48:51], v[144:147]
    v_rcp_f32 v180, v180
    v_rcp_f32 v181, v181
    v_mfma_f32_16x16x32_bf16 v[148:151], v[92:95], a[52:55], v[148:151]
    v_rcp_f32 v182, v182
    v_mfma_f32_16x16x32_bf16 v[152:155], v[92:95], a[56:59], v[152:155]
    v_rcp_f32 v183, v183
    v_mfma_f32_16x16x32_bf16 v[156:159], v[92:95], a[60:63], v[156:159]
    buffer_load_dwordx4 v[92:95], v11, s[40:43], s76 offen offset:1024 sc1
    v_mul_f32 v180, v180, v160
    v_mfma_f32_16x16x32_bf16 v[144:147], v[96:99], a[64:67], v[144:147]
    v_mul_f32 v181, v181, v161
    v_mul_f32 v182, v182, v162
    v_mfma_f32_16x16x32_bf16 v[148:151], v[96:99], a[68:71], v[148:151]
    v_mul_f32 v183, v183, v163
    v_cvt_pk_bf16_f32 v184, v180, v181
    v_mfma_f32_16x16x32_bf16 v[152:155], v[96:99], a[72:75], v[152:155]
    v_cvt_pk_bf16_f32 v185, v182, v183
    ds_write_b64 v222, v[184:185] offset:14336
    v_mul_f32 v186, v164, v164
    v_mfma_f32_16x16x32_bf16 v[156:159], v[96:99], a[76:79], v[156:159]
    buffer_load_dwordx4 v[96:99], v7, s[40:43], s77 offen offset:0 sc1
    v_mul_f32 v187, v165, v165
    v_mul_f32 v188, v166, v166
    v_mfma_f32_16x16x32_bf16 v[144:147], v[100:103], a[80:83], v[144:147]
    v_mul_f32 v189, v167, v167
    v_fma_f32 v186, v186, v197, v193
    v_mfma_f32_16x16x32_bf16 v[148:151], v[100:103], a[84:87], v[148:151]
    v_fma_f32 v187, v187, v197, v193
    v_fma_f32 v188, v188, v197, v193
    v_mfma_f32_16x16x32_bf16 v[152:155], v[100:103], a[88:91], v[152:155]
    v_fma_f32 v189, v189, v197, v193
    v_mul_f32 v186, v186, v164
    v_mfma_f32_16x16x32_bf16 v[156:159], v[100:103], a[92:95], v[156:159]
    buffer_load_dwordx4 v[100:103], v7, s[40:43], s77 offen offset:1024 sc1
    v_mul_f32 v187, v187, v165
    v_mul_f32 v188, v188, v166
    v_mfma_f32_16x16x32_bf16 v[144:147], v[104:107], a[96:99], v[144:147]
    v_mul_f32 v189, v189, v167
    v_exp_f32 v186, v186
    v_mfma_f32_16x16x32_bf16 v[148:151], v[104:107], a[100:103], v[148:151]
    v_exp_f32 v187, v187
    v_mfma_f32_16x16x32_bf16 v[152:155], v[104:107], a[104:107], v[152:155]
    v_exp_f32 v188, v188
    v_mfma_f32_16x16x32_bf16 v[156:159], v[104:107], a[108:111], v[156:159]
    buffer_load_dwordx4 v[104:107], v7, s[40:43], s77 offen offset:2048 sc1
    v_exp_f32 v189, v189
    v_mfma_f32_16x16x32_bf16 v[144:147], v[108:111], a[112:115], v[144:147]
    v_fma_f32 v186, v186, v201, v201
    v_mfma_f32_16x16x32_bf16 v[148:151], v[108:111], a[116:119], v[148:151]
    v_fma_f32 v187, v187, v201, v201
    v_fma_f32 v188, v188, v201, v201
    v_mfma_f32_16x16x32_bf16 v[152:155], v[108:111], a[120:123], v[152:155]
    v_fma_f32 v189, v189, v201, v201
    v_rcp_f32 v186, v186
    v_mfma_f32_16x16x32_bf16 v[156:159], v[108:111], a[124:127], v[156:159]
    buffer_load_dwordx4 v[108:111], v7, s[40:43], s77 offen offset:3072 sc1
    v_rcp_f32 v187, v187
    v_mfma_f32_16x16x32_bf16 v[144:147], v[112:115], a[128:131], v[144:147]
    v_rcp_f32 v188, v188
    v_mfma_f32_16x16x32_bf16 v[148:151], v[112:115], a[132:135], v[148:151]
    v_rcp_f32 v189, v189
    v_mfma_f32_16x16x32_bf16 v[152:155], v[112:115], a[136:139], v[152:155]
    v_mul_f32 v186, v186, v164
    v_mul_f32 v187, v187, v165
    v_mfma_f32_16x16x32_bf16 v[156:159], v[112:115], a[140:143], v[156:159]
    buffer_load_dwordx4 v[112:115], v8, s[40:43], s77 offen offset:0 sc1
    v_mul_f32 v188, v188, v166
    v_mul_f32 v189, v189, v167
    v_mfma_f32_16x16x32_bf16 v[144:147], v[116:119], a[144:147], v[144:147]
    v_cvt_pk_bf16_f32 v190, v186, v187
    v_cvt_pk_bf16_f32 v191, v188, v189
    v_mfma_f32_16x16x32_bf16 v[148:151], v[116:119], a[148:151], v[148:151]
    ds_write_b64 v222, v[190:191] offset:32768
    v_mul_f32 v180, v168, v168
    v_mfma_f32_16x16x32_bf16 v[152:155], v[116:119], a[152:155], v[152:155]
    v_mul_f32 v181, v169, v169
    v_mul_f32 v182, v170, v170
    v_mfma_f32_16x16x32_bf16 v[156:159], v[116:119], a[156:159], v[156:159]
    buffer_load_dwordx4 v[116:119], v8, s[40:43], s77 offen offset:1024 sc1
    v_mul_f32 v183, v171, v171
    v_fma_f32 v180, v180, v198, v194
    v_mfma_f32_16x16x32_bf16 v[144:147], v[120:123], a[160:163], v[144:147]
    v_fma_f32 v181, v181, v198, v194
    v_fma_f32 v182, v182, v198, v194
    v_mfma_f32_16x16x32_bf16 v[148:151], v[120:123], a[164:167], v[148:151]
    v_fma_f32 v183, v183, v198, v194
    v_mul_f32 v180, v180, v168
    v_mfma_f32_16x16x32_bf16 v[152:155], v[120:123], a[168:171], v[152:155]
    v_mul_f32 v181, v181, v169
    v_mul_f32 v182, v182, v170
    v_mfma_f32_16x16x32_bf16 v[156:159], v[120:123], a[172:175], v[156:159]
    buffer_load_dwordx4 v[120:123], v8, s[40:43], s77 offen offset:2048 sc1
    v_mul_f32 v183, v183, v171
    v_exp_f32 v180, v180
    v_mfma_f32_16x16x32_bf16 v[144:147], v[124:127], a[176:179], v[144:147]
    v_exp_f32 v181, v181
    v_mfma_f32_16x16x32_bf16 v[148:151], v[124:127], a[180:183], v[148:151]
    v_exp_f32 v182, v182
    v_mfma_f32_16x16x32_bf16 v[152:155], v[124:127], a[184:187], v[152:155]
    v_exp_f32 v183, v183
    v_mfma_f32_16x16x32_bf16 v[156:159], v[124:127], a[188:191], v[156:159]
    buffer_load_dwordx4 v[124:127], v8, s[40:43], s77 offen offset:3072 sc1
    v_fma_f32 v180, v180, v202, v202
    v_fma_f32 v181, v181, v202, v202
    v_mfma_f32_16x16x32_bf16 v[144:147], v[128:131], a[192:195], v[144:147]
    v_fma_f32 v182, v182, v202, v202
    v_fma_f32 v183, v183, v202, v202
    v_mfma_f32_16x16x32_bf16 v[148:151], v[128:131], a[196:199], v[148:151]
    v_rcp_f32 v180, v180
    v_mfma_f32_16x16x32_bf16 v[152:155], v[128:131], a[200:203], v[152:155]
    v_rcp_f32 v181, v181
    v_mfma_f32_16x16x32_bf16 v[156:159], v[128:131], a[204:207], v[156:159]
    buffer_load_dwordx4 v[128:131], v9, s[40:43], s77 offen offset:0 sc1
    v_rcp_f32 v182, v182
    v_mfma_f32_16x16x32_bf16 v[144:147], v[132:135], a[208:211], v[144:147]
    v_rcp_f32 v183, v183
    v_mfma_f32_16x16x32_bf16 v[148:151], v[132:135], a[212:215], v[148:151]
    v_mul_f32 v180, v180, v168
    v_mul_f32 v181, v181, v169
    v_mfma_f32_16x16x32_bf16 v[152:155], v[132:135], a[216:219], v[152:155]
    v_mul_f32 v182, v182, v170
    v_mul_f32 v183, v183, v171
    v_mfma_f32_16x16x32_bf16 v[156:159], v[132:135], a[220:223], v[156:159]
    buffer_load_dwordx4 v[132:135], v9, s[40:43], s77 offen offset:1024 sc1
    v_cvt_pk_bf16_f32 v184, v180, v181
    v_cvt_pk_bf16_f32 v185, v182, v183
    s_waitcnt vmcnt(31)
    v_mfma_f32_16x16x32_bf16 v[144:147], v[136:139], a[224:227], v[144:147]
    ds_write_b64 v223, v[184:185] offset:14336
    v_mul_f32 v186, v172, v172
    v_mul_f32 v187, v173, v173
    v_mfma_f32_16x16x32_bf16 v[148:151], v[136:139], a[228:231], v[148:151]
    v_mul_f32 v188, v174, v174
    v_mul_f32 v189, v175, v175
    v_mfma_f32_16x16x32_bf16 v[152:155], v[136:139], a[232:235], v[152:155]
    v_fma_f32 v186, v186, v199, v195
    v_fma_f32 v187, v187, v199, v195
    v_mfma_f32_16x16x32_bf16 v[156:159], v[136:139], a[236:239], v[156:159]
    buffer_load_dwordx4 v[136:139], v9, s[40:43], s77 offen offset:2048 sc1
    v_fma_f32 v188, v188, v199, v195
    v_fma_f32 v189, v189, v199, v195
    v_mfma_f32_16x16x32_bf16 v[144:147], v[140:143], a[240:243], v[144:147]
    v_mul_f32 v186, v186, v172
    v_mul_f32 v187, v187, v173
    v_mfma_f32_16x16x32_bf16 v[148:151], v[140:143], a[244:247], v[148:151]
    v_mul_f32 v188, v188, v174
    v_mul_f32 v189, v189, v175
    v_mfma_f32_16x16x32_bf16 v[152:155], v[140:143], a[248:251], v[152:155]
    v_exp_f32 v186, v186
    v_mfma_f32_16x16x32_bf16 v[156:159], v[140:143], a[252:255], v[156:159]
    buffer_load_dwordx4 v[140:143], v9, s[40:43], s77 offen offset:3072 sc1
    v_exp_f32 v187, v187
    s_waitcnt vmcnt(31)
    v_mfma_f32_16x16x32_bf16 v[144:147], v[16:19], v[224:227], v[144:147]
    v_exp_f32 v188, v188
    v_mfma_f32_16x16x32_bf16 v[148:151], v[16:19], v[228:231], v[148:151]
    v_exp_f32 v189, v189
    v_mfma_f32_16x16x32_bf16 v[152:155], v[16:19], v[232:235], v[152:155]
    v_fma_f32 v186, v186, v203, v203
    v_fma_f32 v187, v187, v203, v203
    v_mfma_f32_16x16x32_bf16 v[156:159], v[16:19], v[236:239], v[156:159]
    buffer_load_dwordx4 v[16:19], v10, s[40:43], s77 offen offset:0 sc1
    v_fma_f32 v188, v188, v203, v203
    v_fma_f32 v189, v189, v203, v203
    v_mfma_f32_16x16x32_bf16 v[144:147], v[20:23], v[240:243], v[144:147]
    v_rcp_f32 v186, v186
    v_mfma_f32_16x16x32_bf16 v[148:151], v[20:23], v[244:247], v[148:151]
    v_rcp_f32 v187, v187
    v_mfma_f32_16x16x32_bf16 v[152:155], v[20:23], v[248:251], v[152:155]
    v_rcp_f32 v188, v188
    v_mfma_f32_16x16x32_bf16 v[156:159], v[20:23], v[252:255], v[156:159]
    buffer_load_dwordx4 v[20:23], v10, s[40:43], s77 offen offset:1024 sc1
    v_rcp_f32 v189, v189
    v_mul_f32 v186, v186, v172
    s_waitcnt vmcnt(18)
    v_mfma_f32_16x16x32_bf16 v[160:163], v[176:179], v[204:207], v[144:147]
    v_mul_f32 v187, v187, v173
    v_mul_f32 v188, v188, v174
    v_mfma_f32_16x16x32_bf16 v[164:167], v[176:179], v[208:211], v[148:151]
    v_mul_f32 v189, v189, v175
    v_cvt_pk_bf16_f32 v190, v186, v187
    v_mfma_f32_16x16x32_bf16 v[168:171], v[176:179], v[212:215], v[152:155]
    v_cvt_pk_bf16_f32 v191, v188, v189
    ds_write_b64 v223, v[190:191] offset:32768
    v_mfma_f32_16x16x32_bf16 v[172:175], v[176:179], v[216:219], v[156:159]
    s_waitcnt lgkmcnt(0)
    s_barrier
    ds_read_b128 a[0:3], v14 offset:0
    ds_read_b128 a[4:7], v14 offset:18432
    ds_read_b128 a[8:11], v15 offset:0
    ds_read_b128 a[12:15], v15 offset:18432
    ds_read_b128 a[16:19], v14 offset:1024
    ds_read_b128 a[20:23], v14 offset:19456
    ds_read_b128 a[24:27], v15 offset:1024
    ds_read_b128 a[28:31], v15 offset:19456
    ds_read_b128 a[32:35], v14 offset:2048
    ds_read_b128 a[36:39], v14 offset:20480
    ds_read_b128 a[40:43], v15 offset:2048
    ds_read_b128 a[44:47], v15 offset:20480
    s_waitcnt lgkmcnt(8)
    v_mfma_f32_16x16x32_bf16 v[144:147], v[24:27], a[0:3], 0
    ds_read_b128 a[48:51], v14 offset:3072
    v_mul_f32 v180, v160, v160
    v_mul_f32 v181, v161, v161
    v_mul_f32 v182, v162, v162
    v_mfma_f32_16x16x32_bf16 v[148:151], v[24:27], a[4:7], 0
    ds_read_b128 a[52:55], v14 offset:21504
    v_mul_f32 v183, v163, v163
    v_fma_f32 v180, v180, v196, v192
    v_fma_f32 v181, v181, v196, v192
    v_mfma_f32_16x16x32_bf16 v[152:155], v[24:27], a[8:11], 0
    ds_read_b128 a[56:59], v15 offset:3072
    v_fma_f32 v182, v182, v196, v192
    v_fma_f32 v183, v183, v196, v192
    v_mul_f32 v180, v180, v160
    v_mfma_f32_16x16x32_bf16 v[156:159], v[24:27], a[12:15], 0
    ds_read_b128 a[60:63], v15 offset:21504
    buffer_load_dwordx4 v[24:27], v10, s[40:43], s77 offen offset:2048 sc1
    v_mul_f32 v181, v181, v161
    v_mul_f32 v182, v182, v162
    v_mul_f32 v183, v183, v163
    s_waitcnt lgkmcnt(8)
    v_mfma_f32_16x16x32_bf16 v[144:147], v[28:31], a[16:19], v[144:147]
    ds_read_b128 a[64:67], v14 offset:4096
    v_exp_f32 v180, v180
    v_exp_f32 v181, v181
    v_mfma_f32_16x16x32_bf16 v[148:151], v[28:31], a[20:23], v[148:151]
    ds_read_b128 a[68:71], v14 offset:22528
    v_exp_f32 v182, v182
    v_mfma_f32_16x16x32_bf16 v[152:155], v[28:31], a[24:27], v[152:155]
    ds_read_b128 a[72:75], v15 offset:4096
    v_exp_f32 v183, v183
    v_fma_f32 v180, v180, v200, v200
    v_mfma_f32_16x16x32_bf16 v[156:159], v[28:31], a[28:31], v[156:159]
    ds_read_b128 a[76:79], v15 offset:22528
    buffer_load_dwordx4 v[28:31], v10, s[40:43], s77 offen offset:3072 sc1
    v_fma_f32 v181, v181, v200, v200
    v_fma_f32 v182, v182, v200, v200
    v_fma_f32 v183, v183, v200, v200
    s_waitcnt lgkmcnt(8)
    v_mfma_f32_16x16x32_bf16 v[144:147], v[32:35], a[32:35], v[144:147]
    ds_read_b128 a[80:83], v14 offset:5120
    v_rcp_f32 v180, v180
    v_rcp_f32 v181, v181
    v_mfma_f32_16x16x32_bf16 v[148:151], v[32:35], a[36:39], v[148:151]
    ds_read_b128 a[84:87], v14 offset:23552
    v_rcp_f32 v182, v182
    v_mfma_f32_16x16x32_bf16 v[152:155], v[32:35], a[40:43], v[152:155]
    ds_read_b128 a[88:91], v15 offset:5120
    v_rcp_f32 v183, v183
    v_mul_f32 v180, v180, v160
    v_mul_f32 v181, v181, v161
    v_mfma_f32_16x16x32_bf16 v[156:159], v[32:35], a[44:47], v[156:159]
    ds_read_b128 a[92:95], v15 offset:23552
    buffer_load_dwordx4 v[32:35], v11, s[40:43], s77 offen offset:0 sc1
    v_mul_f32 v182, v182, v162
    v_mul_f32 v183, v183, v163
    v_cvt_pk_bf16_f32 v184, v180, v181
    s_waitcnt lgkmcnt(8)
    v_mfma_f32_16x16x32_bf16 v[144:147], v[36:39], a[48:51], v[144:147]
    ds_read_b128 a[96:99], v14 offset:6144
    v_cvt_pk_bf16_f32 v185, v182, v183
    ds_write_b64 v222, v[184:185] offset:16384
    v_mul_f32 v186, v164, v164
    v_mfma_f32_16x16x32_bf16 v[148:151], v[36:39], a[52:55], v[148:151]
    ds_read_b128 a[100:103], v14 offset:24576
    v_mul_f32 v187, v165, v165
    v_mul_f32 v188, v166, v166
    v_mul_f32 v189, v167, v167
    v_mfma_f32_16x16x32_bf16 v[152:155], v[36:39], a[56:59], v[152:155]
    ds_read_b128 a[104:107], v15 offset:6144
    v_fma_f32 v186, v186, v197, v193
    v_fma_f32 v187, v187, v197, v193
    v_fma_f32 v188, v188, v197, v193
    v_mfma_f32_16x16x32_bf16 v[156:159], v[36:39], a[60:63], v[156:159]
    ds_read_b128 a[108:111], v15 offset:24576
    buffer_load_dwordx4 v[36:39], v11, s[40:43], s77 offen offset:1024 sc1
    v_fma_f32 v189, v189, v197, v193
    v_mul_f32 v186, v186, v164
    v_mul_f32 v187, v187, v165
    s_waitcnt lgkmcnt(9)
    v_mfma_f32_16x16x32_bf16 v[144:147], v[40:43], a[64:67], v[144:147]
    ds_read_b128 a[112:115], v14 offset:7168
    v_mul_f32 v188, v188, v166
    v_mul_f32 v189, v189, v167
    v_exp_f32 v186, v186
    v_mfma_f32_16x16x32_bf16 v[148:151], v[40:43], a[68:71], v[148:151]
    ds_read_b128 a[116:119], v14 offset:25600
    v_exp_f32 v187, v187
    v_mfma_f32_16x16x32_bf16 v[152:155], v[40:43], a[72:75], v[152:155]
    ds_read_b128 a[120:123], v15 offset:7168
    v_exp_f32 v188, v188
    v_exp_f32 v189, v189
    v_mfma_f32_16x16x32_bf16 v[156:159], v[40:43], a[76:79], v[156:159]
    ds_read_b128 a[124:127], v15 offset:25600
    buffer_load_dwordx4 v[40:43], v7, s[40:43], s78 offen offset:0 sc1
    v_fma_f32 v186, v186, v201, v201
    v_fma_f32 v187, v187, v201, v201
    s_waitcnt lgkmcnt(9)
    v_mfma_f32_16x16x32_bf16 v[144:147], v[44:47], a[80:83], v[144:147]
    ds_read_b128 a[128:131], v14 offset:8192
    v_fma_f32 v188, v188, v201, v201
    v_fma_f32 v189, v189, v201, v201
    v_rcp_f32 v186, v186
    v_mfma_f32_16x16x32_bf16 v[148:151], v[44:47], a[84:87], v[148:151]
    ds_read_b128 a[132:135], v14 offset:26624
    v_rcp_f32 v187, v187
    v_mfma_f32_16x16x32_bf16 v[152:155], v[44:47], a[88:91], v[152:155]
    ds_read_b128 a[136:139], v15 offset:8192
    v_rcp_f32 v188, v188
    v_rcp_f32 v189, v189
    v_mfma_f32_16x16x32_bf16 v[156:159], v[44:47], a[92:95], v[156:159]
    ds_read_b128 a[140:143], v15 offset:26624
    buffer_load_dwordx4 v[44:47], v7, s[40:43], s78 offen offset:1024 sc1
    v_mul_f32 v186, v186, v164
    v_mul_f32 v187, v187, v165
    s_waitcnt lgkmcnt(8)
    v_mfma_f32_16x16x32_bf16 v[144:147], v[48:51], a[96:99], v[144:147]
    ds_read_b128 a[144:147], v14 offset:9216
    v_mul_f32 v188, v188, v166
    v_mul_f32 v189, v189, v167
    v_cvt_pk_bf16_f32 v190, v186, v187
    v_mfma_f32_16x16x32_bf16 v[148:151], v[48:51], a[100:103], v[148:151]
    ds_read_b128 a[148:151], v14 offset:27648
    v_cvt_pk_bf16_f32 v191, v188, v189
    ds_write_b64 v222, v[190:191] offset:34816
    v_mul_f32 v180, v168, v168
    v_mul_f32 v181, v169, v169
    v_mfma_f32_16x16x32_bf16 v[152:155], v[48:51], a[104:107], v[152:155]
    ds_read_b128 a[152:155], v15 offset:9216
    v_mul_f32 v182, v170, v170
    v_mul_f32 v183, v171, v171
    v_fma_f32 v180, v180, v198, v194
    v_mfma_f32_16x16x32_bf16 v[156:159], v[48:51], a[108:111], v[156:159]
    ds_read_b128 a[156:159], v15 offset:27648
    buffer_load_dwordx4 v[48:51], v7, s[40:43], s78 offen offset:2048 sc1
    v_fma_f32 v181, v181, v198, v194
    v_fma_f32 v182, v182, v198, v194
    v_fma_f32 v183, v183, v198, v194
    s_waitcnt lgkmcnt(9)
    v_mfma_f32_16x16x32_bf16 v[144:147], v[52:55], a[112:115], v[144:147]
    ds_read_b128 a[160:163], v14 offset:10240
    v_mul_f32 v180, v180, v168
    v_mul_f32 v181, v181, v169
    v_mul_f32 v182, v182, v170
    v_mfma_f32_16x16x32_bf16 v[148:151], v[52:55], a[116:119], v[148:151]
    ds_read_b128 a[164:167], v14 offset:28672
    v_mul_f32 v183, v183, v171
    v_exp_f32 v180, v180
    v_mfma_f32_16x16x32_bf16 v[152:155], v[52:55], a[120:123], v[152:155]
    ds_read_b128 a[168:171], v15 offset:10240
    v_exp_f32 v181, v181
    v_mfma_f32_16x16x32_bf16 v[156:159], v[52:55], a[124:127], v[156:159]
    ds_read_b128 a[172:175], v15 offset:28672
    buffer_load_dwordx4 v[52:55], v7, s[40:43], s78 offen offset:3072 sc1
    v_exp_f32 v182, v182
    v_exp_f32 v183, v183
    s_waitcnt lgkmcnt(9)
    v_mfma_f32_16x16x32_bf16 v[144:147], v[56:59], a[128:131], v[144:147]
    ds_read_b128 a[176:179], v14 offset:11264
    v_fma_f32 v180, v180, v202, v202
    v_fma_f32 v181, v181, v202, v202
    v_fma_f32 v182, v182, v202, v202
    v_mfma_f32_16x16x32_bf16 v[148:151], v[56:59], a[132:135], v[148:151]
    ds_read_b128 a[180:183], v14 offset:29696
    v_fma_f32 v183, v183, v202, v202
    v_rcp_f32 v180, v180
    v_mfma_f32_16x16x32_bf16 v[152:155], v[56:59], a[136:139], v[152:155]
    ds_read_b128 a[184:187], v15 offset:11264
    v_rcp_f32 v181, v181
    v_rcp_f32 v182, v182
    v_mfma_f32_16x16x32_bf16 v[156:159], v[56:59], a[140:143], v[156:159]
    ds_read_b128 a[188:191], v15 offset:29696
    buffer_load_dwordx4 v[56:59], v8, s[40:43], s78 offen offset:0 sc1
    v_rcp_f32 v183, v183
    s_waitcnt lgkmcnt(8)
    v_mfma_f32_16x16x32_bf16 v[144:147], v[60:63], a[144:147], v[144:147]
    ds_read_b128 a[192:195], v14 offset:12288
    v_mul_f32 v180, v180, v168
    v_mul_f32 v181, v181, v169
    v_mul_f32 v182, v182, v170
    v_mfma_f32_16x16x32_bf16 v[148:151], v[60:63], a[148:151], v[148:151]
    ds_read_b128 a[196:199], v14 offset:30720
    v_mul_f32 v183, v183, v171
    v_cvt_pk_bf16_f32 v184, v180, v181
    v_cvt_pk_bf16_f32 v185, v182, v183
    v_mfma_f32_16x16x32_bf16 v[152:155], v[60:63], a[152:155], v[152:155]
    ds_read_b128 a[200:203], v15 offset:12288
    ds_write_b64 v223, v[184:185] offset:16384
    v_mul_f32 v186, v172, v172
    v_mul_f32 v187, v173, v173
    v_mfma_f32_16x16x32_bf16 v[156:159], v[60:63], a[156:159], v[156:159]
    ds_read_b128 a[204:207], v15 offset:30720
    buffer_load_dwordx4 v[60:63], v8, s[40:43], s78 offen offset:1024 sc1
    v_mul_f32 v188, v174, v174
    v_mul_f32 v189, v175, v175
    v_fma_f32 v186, v186, v199, v195
    s_waitcnt lgkmcnt(9)
    v_mfma_f32_16x16x32_bf16 v[144:147], v[64:67], a[160:163], v[144:147]
    ds_read_b128 a[208:211], v14 offset:13312
    v_fma_f32 v187, v187, v199, v195
    v_fma_f32 v188, v188, v199, v195
    v_fma_f32 v189, v189, v199, v195
    v_mfma_f32_16x16x32_bf16 v[148:151], v[64:67], a[164:167], v[148:151]
    ds_read_b128 a[212:215], v14 offset:31744
    v_mul_f32 v186, v186, v172
    v_mul_f32 v187, v187, v173
    v_mul_f32 v188, v188, v174
    v_mfma_f32_16x16x32_bf16 v[152:155], v[64:67], a[168:171], v[152:155]
    ds_read_b128 a[216:219], v15 offset:13312
    v_mul_f32 v189, v189, v175
    v_exp_f32 v186, v186
    v_mfma_f32_16x16x32_bf16 v[156:159], v[64:67], a[172:175], v[156:159]
    ds_read_b128 a[220:223], v15 offset:31744
    buffer_load_dwordx4 v[64:67], v8, s[40:43], s78 offen offset:2048 sc1
    v_exp_f32 v187, v187
    v_exp_f32 v188, v188
    s_waitcnt lgkmcnt(9)
    v_mfma_f32_16x16x32_bf16 v[144:147], v[68:71], a[176:179], v[144:147]
    ds_read_b128 a[224:227], v14 offset:14336
    v_exp_f32 v189, v189
    v_fma_f32 v186, v186, v203, v203
    v_mfma_f32_16x16x32_bf16 v[148:151], v[68:71], a[180:183], v[148:151]
    ds_read_b128 a[228:231], v14 offset:32768
    v_fma_f32 v187, v187, v203, v203
    v_fma_f32 v188, v188, v203, v203
    v_fma_f32 v189, v189, v203, v203
    v_mfma_f32_16x16x32_bf16 v[152:155], v[68:71], a[184:187], v[152:155]
    ds_read_b128 a[232:235], v15 offset:14336
    v_rcp_f32 v186, v186
    v_mfma_f32_16x16x32_bf16 v[156:159], v[68:71], a[188:191], v[156:159]
    ds_read_b128 a[236:239], v15 offset:32768
    buffer_load_dwordx4 v[68:71], v8, s[40:43], s78 offen offset:3072 sc1
    v_rcp_f32 v187, v187
    v_rcp_f32 v188, v188
    s_waitcnt lgkmcnt(8)
    v_mfma_f32_16x16x32_bf16 v[144:147], v[72:75], a[192:195], v[144:147]
    ds_read_b128 a[240:243], v14 offset:15360
    v_rcp_f32 v189, v189
    v_mul_f32 v186, v186, v172
    v_mfma_f32_16x16x32_bf16 v[148:151], v[72:75], a[196:199], v[148:151]
    ds_read_b128 a[244:247], v14 offset:33792
    v_mul_f32 v187, v187, v173
    v_mul_f32 v188, v188, v174
    v_mul_f32 v189, v189, v175
    v_mfma_f32_16x16x32_bf16 v[152:155], v[72:75], a[200:203], v[152:155]
    ds_read_b128 a[248:251], v15 offset:15360
    v_cvt_pk_bf16_f32 v190, v186, v187
    v_cvt_pk_bf16_f32 v191, v188, v189
    ds_write_b64 v223, v[190:191] offset:34816
    v_mfma_f32_16x16x32_bf16 v[156:159], v[72:75], a[204:207], v[156:159]
    ds_read_b128 a[252:255], v15 offset:33792
    buffer_load_dwordx4 v[72:75], v9, s[40:43], s78 offen offset:0 sc1
    s_waitcnt lgkmcnt(1)
    s_barrier
    v_mfma_f32_16x16x32_bf16 v[144:147], v[76:79], a[208:211], v[144:147]
    ds_read_b128 v[224:227], v14 offset:16384
    v_mfma_f32_16x16x32_bf16 v[148:151], v[76:79], a[212:215], v[148:151]
    ds_read_b128 v[228:231], v14 offset:34816
    v_mfma_f32_16x16x32_bf16 v[152:155], v[76:79], a[216:219], v[152:155]
    ds_read_b128 v[232:235], v15 offset:16384
    v_mfma_f32_16x16x32_bf16 v[156:159], v[76:79], a[220:223], v[156:159]
    ds_read_b128 v[236:239], v15 offset:34816
    buffer_load_dwordx4 v[76:79], v9, s[40:43], s78 offen offset:1024 sc1
    s_waitcnt vmcnt(30)
    v_mfma_f32_16x16x32_bf16 v[144:147], v[80:83], a[224:227], v[144:147]
    ds_read_b128 v[240:243], v14 offset:17408
    v_mfma_f32_16x16x32_bf16 v[148:151], v[80:83], a[228:231], v[148:151]
    ds_read_b128 v[244:247], v14 offset:35840
    v_mfma_f32_16x16x32_bf16 v[152:155], v[80:83], a[232:235], v[152:155]
    ds_read_b128 v[248:251], v15 offset:17408
    v_mfma_f32_16x16x32_bf16 v[156:159], v[80:83], a[236:239], v[156:159]
    ds_read_b128 v[252:255], v15 offset:35840
    buffer_load_dwordx4 v[80:83], v9, s[40:43], s78 offen offset:2048 sc1
    s_waitcnt lgkmcnt(8)
    v_mfma_f32_16x16x32_bf16 v[144:147], v[84:87], a[240:243], v[144:147]
    v_mfma_f32_16x16x32_bf16 v[148:151], v[84:87], a[244:247], v[148:151]
    v_mfma_f32_16x16x32_bf16 v[152:155], v[84:87], a[248:251], v[152:155]
    v_mfma_f32_16x16x32_bf16 v[156:159], v[84:87], a[252:255], v[156:159]
    buffer_load_dwordx4 v[84:87], v9, s[40:43], s78 offen offset:3072 sc1
    s_waitcnt lgkmcnt(4)
    s_waitcnt vmcnt(30)
    v_mfma_f32_16x16x32_bf16 v[144:147], v[88:91], v[224:227], v[144:147]
    v_mfma_f32_16x16x32_bf16 v[148:151], v[88:91], v[228:231], v[148:151]
    v_mfma_f32_16x16x32_bf16 v[152:155], v[88:91], v[232:235], v[152:155]
    v_mfma_f32_16x16x32_bf16 v[156:159], v[88:91], v[236:239], v[156:159]
    buffer_load_dwordx4 v[88:91], v10, s[40:43], s78 offen offset:0 sc1
    s_waitcnt lgkmcnt(0)
    v_mfma_f32_16x16x32_bf16 v[160:163], v[92:95], v[240:243], v[144:147]
    v_mfma_f32_16x16x32_bf16 v[164:167], v[92:95], v[244:247], v[148:151]
    v_mfma_f32_16x16x32_bf16 v[168:171], v[92:95], v[248:251], v[152:155]
    v_mfma_f32_16x16x32_bf16 v[172:175], v[92:95], v[252:255], v[156:159]
    buffer_load_dwordx4 v[92:95], v10, s[40:43], s78 offen offset:1024 sc1
    s_waitcnt vmcnt(30)
    v_mfma_f32_16x16x32_bf16 v[144:147], v[96:99], a[0:3], 0
    v_mfma_f32_16x16x32_bf16 v[148:151], v[96:99], a[4:7], 0
    v_mfma_f32_16x16x32_bf16 v[152:155], v[96:99], a[8:11], 0
    v_mfma_f32_16x16x32_bf16 v[156:159], v[96:99], a[12:15], 0
    buffer_load_dwordx4 v[96:99], v10, s[40:43], s78 offen offset:2048 sc1
    v_mfma_f32_16x16x32_bf16 v[144:147], v[100:103], a[16:19], v[144:147]
    v_mfma_f32_16x16x32_bf16 v[148:151], v[100:103], a[20:23], v[148:151]
    v_mfma_f32_16x16x32_bf16 v[152:155], v[100:103], a[24:27], v[152:155]
    v_mfma_f32_16x16x32_bf16 v[156:159], v[100:103], a[28:31], v[156:159]
    buffer_load_dwordx4 v[100:103], v10, s[40:43], s78 offen offset:3072 sc1
    s_waitcnt vmcnt(30)
    v_mfma_f32_16x16x32_bf16 v[144:147], v[104:107], a[32:35], v[144:147]
    v_bfe_u32 v216, v1, 3, 2
    s_and_b32 s6, s4, 3
    v_mfma_f32_16x16x32_bf16 v[148:151], v[104:107], a[36:39], v[148:151]
    v_cmp_eq_u32 vcc, s6, v216
    s_cmp_lt_u32 s4, 4
    v_mfma_f32_16x16x32_bf16 v[152:155], v[104:107], a[40:43], v[152:155]
    s_cselect_b64 s[6:7], vcc, 0
    v_mfma_f32_16x16x32_bf16 v[156:159], v[104:107], a[44:47], v[156:159]
    buffer_load_dwordx4 v[104:107], v11, s[40:43], s78 offen offset:0 sc1
    s_cselect_b64 s[10:11], 0, vcc
    v_mov_b32 v216, 0x40000000
    v_mfma_f32_16x16x32_bf16 v[144:147], v[108:111], a[48:51], v[144:147]
    v_cndmask_b32 v5, v5, v216, s[6:7]
    v_cndmask_b32 v6, v6, v216, s[10:11]
    v_mfma_f32_16x16x32_bf16 v[148:151], v[108:111], a[52:55], v[148:151]
    v_lshrrev_b32 v216, 5, v1
    v_and_b32 v217, 7, v1
    v_mfma_f32_16x16x32_bf16 v[152:155], v[108:111], a[56:59], v[152:155]
    v_lshlrev_b32 v217, 4, v217
    v_lshl_add_u32 v216, v216, 7, v217
    v_mfma_f32_16x16x32_bf16 v[156:159], v[108:111], a[60:63], v[156:159]
    buffer_load_dwordx4 v[108:111], v11, s[40:43], s78 offen offset:1024 sc1
    s_sub_u32 s14, s57, s90
    s_waitcnt vmcnt(30)
    v_mfma_f32_16x16x32_bf16 v[144:147], v[112:115], a[64:67], v[144:147]
    s_ashr_i32 s14, s14, 1
    s_add_u32 s14, s14, s8
    v_mfma_f32_16x16x32_bf16 v[148:151], v[112:115], a[68:71], v[148:151]
    s_add_u32 s15, s14, 10240
    s_add_u32 s14, s14, 6144
    v_mfma_f32_16x16x32_bf16 v[152:155], v[112:115], a[72:75], v[152:155]
    v_add_u32 v216, s14, v216
    v_mov_b32 v217, s15
    v_mfma_f32_16x16x32_bf16 v[156:159], v[112:115], a[76:79], v[156:159]
    buffer_load_dwordx4 v[112:115], v7, s[40:43], s79 offen offset:0 sc1
    v_cndmask_b32 v220, v217, v216, s[6:7]
    v_cndmask_b32 v221, v217, v216, s[10:11]
    v_mfma_f32_16x16x32_bf16 v[144:147], v[116:119], a[80:83], v[144:147]
    v_cvt_pk_bf16_f32 v192, v160, v161
    v_cvt_pk_bf16_f32 v193, v162, v163
    v_mfma_f32_16x16x32_bf16 v[148:151], v[116:119], a[84:87], v[148:151]
    v_cvt_pk_bf16_f32 v194, v164, v165
    v_mfma_f32_16x16x32_bf16 v[152:155], v[116:119], a[88:91], v[152:155]
    v_cvt_pk_bf16_f32 v195, v166, v167
    v_permlane16_swap_b32 v192, v194
    v_mfma_f32_16x16x32_bf16 v[156:159], v[116:119], a[92:95], v[156:159]
    buffer_load_dwordx4 v[116:119], v7, s[40:43], s79 offen offset:1024 sc1
    v_permlane16_swap_b32 v193, v195
    v_cvt_pk_bf16_f32 v196, v168, v169
    s_waitcnt vmcnt(30)
    v_mfma_f32_16x16x32_bf16 v[144:147], v[120:123], a[96:99], v[144:147]
    v_cvt_pk_bf16_f32 v197, v170, v171
    v_cvt_pk_bf16_f32 v198, v172, v173
    v_mfma_f32_16x16x32_bf16 v[148:151], v[120:123], a[100:103], v[148:151]
    v_cvt_pk_bf16_f32 v199, v174, v175
    v_permlane16_swap_b32 v196, v198
    v_mfma_f32_16x16x32_bf16 v[152:155], v[120:123], a[104:107], v[152:155]
    v_permlane16_swap_b32 v197, v199
    v_mfma_f32_16x16x32_bf16 v[156:159], v[120:123], a[108:111], v[156:159]
    buffer_load_dwordx4 v[120:123], v7, s[40:43], s79 offen offset:2048 sc1
    buffer_store_dwordx4 v[192:195], v5, s[40:43], s57 offen sc1
    buffer_store_dwordx4 v[196:199], v6, s[40:43], s57 offen sc1
    v_mfma_f32_16x16x32_bf16 v[144:147], v[124:127], a[112:115], v[144:147]
    ds_write_b128 v220, v[192:195]
    ds_write_b128 v221, v[196:199]
    v_mfma_f32_16x16x32_bf16 v[148:151], v[124:127], a[116:119], v[148:151]
    v_mfma_f32_16x16x32_bf16 v[152:155], v[124:127], a[120:123], v[152:155]
    v_mfma_f32_16x16x32_bf16 v[156:159], v[124:127], a[124:127], v[156:159]
    buffer_load_dwordx4 v[124:127], v7, s[40:43], s79 offen offset:3072 sc1
    s_waitcnt vmcnt(32)
    v_mfma_f32_16x16x32_bf16 v[144:147], v[128:131], a[128:131], v[144:147]
    v_mfma_f32_16x16x32_bf16 v[148:151], v[128:131], a[132:135], v[148:151]
    v_mfma_f32_16x16x32_bf16 v[152:155], v[128:131], a[136:139], v[152:155]
    v_mfma_f32_16x16x32_bf16 v[156:159], v[128:131], a[140:143], v[156:159]
    buffer_load_dwordx4 v[128:131], v8, s[40:43], s79 offen offset:0 sc1
    v_mfma_f32_16x16x32_bf16 v[144:147], v[132:135], a[144:147], v[144:147]
    v_mfma_f32_16x16x32_bf16 v[148:151], v[132:135], a[148:151], v[148:151]
    v_mfma_f32_16x16x32_bf16 v[152:155], v[132:135], a[152:155], v[152:155]
    v_mfma_f32_16x16x32_bf16 v[156:159], v[132:135], a[156:159], v[156:159]
    buffer_load_dwordx4 v[132:135], v8, s[40:43], s79 offen offset:1024 sc1
    s_waitcnt vmcnt(32)
    v_mfma_f32_16x16x32_bf16 v[144:147], v[136:139], a[160:163], v[144:147]
    v_mfma_f32_16x16x32_bf16 v[148:151], v[136:139], a[164:167], v[148:151]
    v_mfma_f32_16x16x32_bf16 v[152:155], v[136:139], a[168:171], v[152:155]
    v_mfma_f32_16x16x32_bf16 v[156:159], v[136:139], a[172:175], v[156:159]
    buffer_load_dwordx4 v[136:139], v8, s[40:43], s79 offen offset:2048 sc1
    v_mfma_f32_16x16x32_bf16 v[144:147], v[140:143], a[176:179], v[144:147]
    v_mfma_f32_16x16x32_bf16 v[148:151], v[140:143], a[180:183], v[148:151]
    v_mfma_f32_16x16x32_bf16 v[152:155], v[140:143], a[184:187], v[152:155]
    v_mfma_f32_16x16x32_bf16 v[156:159], v[140:143], a[188:191], v[156:159]
    buffer_load_dwordx4 v[140:143], v8, s[40:43], s79 offen offset:3072 sc1
    s_waitcnt vmcnt(32)
    v_mfma_f32_16x16x32_bf16 v[144:147], v[16:19], a[192:195], v[144:147]
    v_mfma_f32_16x16x32_bf16 v[148:151], v[16:19], a[196:199], v[148:151]
    v_mfma_f32_16x16x32_bf16 v[152:155], v[16:19], a[200:203], v[152:155]
    v_mfma_f32_16x16x32_bf16 v[156:159], v[16:19], a[204:207], v[156:159]
    buffer_load_dwordx4 v[16:19], v9, s[40:43], s79 offen offset:0 sc1
    v_mfma_f32_16x16x32_bf16 v[144:147], v[20:23], a[208:211], v[144:147]
    v_mfma_f32_16x16x32_bf16 v[148:151], v[20:23], a[212:215], v[148:151]
    v_mfma_f32_16x16x32_bf16 v[152:155], v[20:23], a[216:219], v[152:155]
    v_mfma_f32_16x16x32_bf16 v[156:159], v[20:23], a[220:223], v[156:159]
    buffer_load_dwordx4 v[20:23], v9, s[40:43], s79 offen offset:1024 sc1
    s_waitcnt vmcnt(32)
    v_mfma_f32_16x16x32_bf16 v[144:147], v[24:27], a[224:227], v[144:147]
    v_mfma_f32_16x16x32_bf16 v[148:151], v[24:27], a[228:231], v[148:151]
    v_mfma_f32_16x16x32_bf16 v[152:155], v[24:27], a[232:235], v[152:155]
    v_mfma_f32_16x16x32_bf16 v[156:159], v[24:27], a[236:239], v[156:159]
    buffer_load_dwordx4 v[24:27], v9, s[40:43], s79 offen offset:2048 sc1
    v_mfma_f32_16x16x32_bf16 v[144:147], v[28:31], a[240:243], v[144:147]
    v_mfma_f32_16x16x32_bf16 v[148:151], v[28:31], a[244:247], v[148:151]
    v_mfma_f32_16x16x32_bf16 v[152:155], v[28:31], a[248:251], v[152:155]
    v_mfma_f32_16x16x32_bf16 v[156:159], v[28:31], a[252:255], v[156:159]
    buffer_load_dwordx4 v[28:31], v9, s[40:43], s79 offen offset:3072 sc1
    s_waitcnt vmcnt(32)
    v_mfma_f32_16x16x32_bf16 v[144:147], v[32:35], v[224:227], v[144:147]
    v_mfma_f32_16x16x32_bf16 v[148:151], v[32:35], v[228:231], v[148:151]
    v_mfma_f32_16x16x32_bf16 v[152:155], v[32:35], v[232:235], v[152:155]
    v_mfma_f32_16x16x32_bf16 v[156:159], v[32:35], v[236:239], v[156:159]
    buffer_load_dwordx4 v[32:35], v10, s[40:43], s79 offen offset:0 sc1
    v_mfma_f32_16x16x32_bf16 v[160:163], v[36:39], v[240:243], v[144:147]
    v_mfma_f32_16x16x32_bf16 v[164:167], v[36:39], v[244:247], v[148:151]
    v_mfma_f32_16x16x32_bf16 v[168:171], v[36:39], v[248:251], v[152:155]
    v_mfma_f32_16x16x32_bf16 v[172:175], v[36:39], v[252:255], v[156:159]
    buffer_load_dwordx4 v[36:39], v10, s[40:43], s79 offen offset:1024 sc1
    s_waitcnt vmcnt(32)
    v_mfma_f32_16x16x32_bf16 v[144:147], v[40:43], a[0:3], 0
    v_mfma_f32_16x16x32_bf16 v[148:151], v[40:43], a[4:7], 0
    v_mfma_f32_16x16x32_bf16 v[152:155], v[40:43], a[8:11], 0
    v_mfma_f32_16x16x32_bf16 v[156:159], v[40:43], a[12:15], 0
    buffer_load_dwordx4 v[40:43], v10, s[40:43], s79 offen offset:2048 sc1
    v_mfma_f32_16x16x32_bf16 v[144:147], v[44:47], a[16:19], v[144:147]
    v_mfma_f32_16x16x32_bf16 v[148:151], v[44:47], a[20:23], v[148:151]
    v_mfma_f32_16x16x32_bf16 v[152:155], v[44:47], a[24:27], v[152:155]
    v_mfma_f32_16x16x32_bf16 v[156:159], v[44:47], a[28:31], v[156:159]
    buffer_load_dwordx4 v[44:47], v10, s[40:43], s79 offen offset:3072 sc1
    s_waitcnt vmcnt(32)
    v_mfma_f32_16x16x32_bf16 v[144:147], v[48:51], a[32:35], v[144:147]
    s_sub_u32 s14, s58, s57
    s_ashr_i32 s14, s14, 1
    v_mfma_f32_16x16x32_bf16 v[148:151], v[48:51], a[36:39], v[148:151]
    v_add_u32 v220, s14, v220
    v_mfma_f32_16x16x32_bf16 v[152:155], v[48:51], a[40:43], v[152:155]
    v_add_u32 v221, s14, v221
    v_mfma_f32_16x16x32_bf16 v[156:159], v[48:51], a[44:47], v[156:159]
    buffer_load_dwordx4 v[48:51], v11, s[40:43], s79 offen offset:0 sc1
    v_cvt_pk_bf16_f32 v200, v160, v161
    v_mfma_f32_16x16x32_bf16 v[144:147], v[52:55], a[48:51], v[144:147]
    v_cvt_pk_bf16_f32 v201, v162, v163
    v_mfma_f32_16x16x32_bf16 v[148:151], v[52:55], a[52:55], v[148:151]
    v_cvt_pk_bf16_f32 v202, v164, v165
    v_mfma_f32_16x16x32_bf16 v[152:155], v[52:55], a[56:59], v[152:155]
    v_cvt_pk_bf16_f32 v203, v166, v167
    v_mfma_f32_16x16x32_bf16 v[156:159], v[52:55], a[60:63], v[156:159]
    buffer_load_dwordx4 v[52:55], v11, s[40:43], s79 offen offset:1024 sc1
    v_permlane16_swap_b32 v200, v202
    s_waitcnt vmcnt(32)
    v_mfma_f32_16x16x32_bf16 v[144:147], v[56:59], a[64:67], v[144:147]
    v_mfma_f32_16x16x32_bf16 v[148:151], v[56:59], a[68:71], v[148:151]
    v_permlane16_swap_b32 v201, v203
    v_mfma_f32_16x16x32_bf16 v[152:155], v[56:59], a[72:75], v[152:155]
    v_cvt_pk_bf16_f32 v204, v168, v169
    v_mfma_f32_16x16x32_bf16 v[156:159], v[56:59], a[76:79], v[156:159]
    buffer_load_dwordx4 v[56:59], v7, s[40:43], s80 offen offset:0 sc1
    v_cvt_pk_bf16_f32 v205, v170, v171
    v_mfma_f32_16x16x32_bf16 v[144:147], v[60:63], a[80:83], v[144:147]
    v_cvt_pk_bf16_f32 v206, v172, v173
    v_mfma_f32_16x16x32_bf16 v[148:151], v[60:63], a[84:87], v[148:151]
    v_cvt_pk_bf16_f32 v207, v174, v175
    v_mfma_f32_16x16x32_bf16 v[152:155], v[60:63], a[88:91], v[152:155]
    v_permlane16_swap_b32 v204, v206
    v_mfma_f32_16x16x32_bf16 v[156:159], v[60:63], a[92:95], v[156:159]
    buffer_load_dwordx4 v[60:63], v7, s[40:43], s80 offen offset:1024 sc1
    v_permlane16_swap_b32 v205, v207
    s_waitcnt vmcnt(32)
    v_mfma_f32_16x16x32_bf16 v[144:147], v[64:67], a[96:99], v[144:147]
    v_mfma_f32_16x16x32_bf16 v[148:151], v[64:67], a[100:103], v[148:151]
    buffer_store_dwordx4 v[200:203], v5, s[40:43], s58 offen sc1
    v_mfma_f32_16x16x32_bf16 v[152:155], v[64:67], a[104:107], v[152:155]
    buffer_store_dwordx4 v[204:207], v6, s[40:43], s58 offen sc1
    v_mfma_f32_16x16x32_bf16 v[156:159], v[64:67], a[108:111], v[156:159]
    buffer_load_dwordx4 v[64:67], v7, s[40:43], s80 offen offset:2048 sc1
    ds_write_b128 v220, v[200:203]
    v_mfma_f32_16x16x32_bf16 v[144:147], v[68:71], a[112:115], v[144:147]
    ds_write_b128 v221, v[204:207]
    v_mfma_f32_16x16x32_bf16 v[148:151], v[68:71], a[116:119], v[148:151]
    v_mfma_f32_16x16x32_bf16 v[152:155], v[68:71], a[120:123], v[152:155]
    v_mfma_f32_16x16x32_bf16 v[156:159], v[68:71], a[124:127], v[156:159]
    buffer_load_dwordx4 v[68:71], v7, s[40:43], s80 offen offset:3072 sc1
    s_waitcnt vmcnt(34)
    v_mfma_f32_16x16x32_bf16 v[144:147], v[72:75], a[128:131], v[144:147]
    v_mfma_f32_16x16x32_bf16 v[148:151], v[72:75], a[132:135], v[148:151]
    v_mfma_f32_16x16x32_bf16 v[152:155], v[72:75], a[136:139], v[152:155]
    v_mfma_f32_16x16x32_bf16 v[156:159], v[72:75], a[140:143], v[156:159]
    buffer_load_dwordx4 v[72:75], v8, s[40:43], s80 offen offset:0 sc1
    v_mfma_f32_16x16x32_bf16 v[144:147], v[76:79], a[144:147], v[144:147]
    v_mfma_f32_16x16x32_bf16 v[148:151], v[76:79], a[148:151], v[148:151]
    v_mfma_f32_16x16x32_bf16 v[152:155], v[76:79], a[152:155], v[152:155]
    v_mfma_f32_16x16x32_bf16 v[156:159], v[76:79], a[156:159], v[156:159]
    buffer_load_dwordx4 v[76:79], v8, s[40:43], s80 offen offset:1024 sc1
    s_waitcnt vmcnt(34)
    v_mfma_f32_16x16x32_bf16 v[144:147], v[80:83], a[160:163], v[144:147]
    v_mfma_f32_16x16x32_bf16 v[148:151], v[80:83], a[164:167], v[148:151]
    v_mfma_f32_16x16x32_bf16 v[152:155], v[80:83], a[168:171], v[152:155]
    v_mfma_f32_16x16x32_bf16 v[156:159], v[80:83], a[172:175], v[156:159]
    buffer_load_dwordx4 v[80:83], v8, s[40:43], s80 offen offset:2048 sc1
    v_mfma_f32_16x16x32_bf16 v[144:147], v[84:87], a[176:179], v[144:147]
    v_mfma_f32_16x16x32_bf16 v[148:151], v[84:87], a[180:183], v[148:151]
    v_mfma_f32_16x16x32_bf16 v[152:155], v[84:87], a[184:187], v[152:155]
    v_mfma_f32_16x16x32_bf16 v[156:159], v[84:87], a[188:191], v[156:159]
    buffer_load_dwordx4 v[84:87], v8, s[40:43], s80 offen offset:3072 sc1
    s_waitcnt vmcnt(34)
    v_mfma_f32_16x16x32_bf16 v[144:147], v[88:91], a[192:195], v[144:147]
    v_mfma_f32_16x16x32_bf16 v[148:151], v[88:91], a[196:199], v[148:151]
    v_mfma_f32_16x16x32_bf16 v[152:155], v[88:91], a[200:203], v[152:155]
    v_mfma_f32_16x16x32_bf16 v[156:159], v[88:91], a[204:207], v[156:159]
    buffer_load_dwordx4 v[88:91], v9, s[40:43], s80 offen offset:0 sc1
    v_mfma_f32_16x16x32_bf16 v[144:147], v[92:95], a[208:211], v[144:147]
    v_mfma_f32_16x16x32_bf16 v[148:151], v[92:95], a[212:215], v[148:151]
    v_mfma_f32_16x16x32_bf16 v[152:155], v[92:95], a[216:219], v[152:155]
    v_mfma_f32_16x16x32_bf16 v[156:159], v[92:95], a[220:223], v[156:159]
    buffer_load_dwordx4 v[92:95], v9, s[40:43], s80 offen offset:1024 sc1
    s_waitcnt vmcnt(34)
    v_mfma_f32_16x16x32_bf16 v[144:147], v[96:99], a[224:227], v[144:147]
    v_mfma_f32_16x16x32_bf16 v[148:151], v[96:99], a[228:231], v[148:151]
    v_mfma_f32_16x16x32_bf16 v[152:155], v[96:99], a[232:235], v[152:155]
    v_mfma_f32_16x16x32_bf16 v[156:159], v[96:99], a[236:239], v[156:159]
    buffer_load_dwordx4 v[96:99], v9, s[40:43], s80 offen offset:2048 sc1
    v_mfma_f32_16x16x32_bf16 v[144:147], v[100:103], a[240:243], v[144:147]
    v_mfma_f32_16x16x32_bf16 v[148:151], v[100:103], a[244:247], v[148:151]
    v_mfma_f32_16x16x32_bf16 v[152:155], v[100:103], a[248:251], v[152:155]
    v_mfma_f32_16x16x32_bf16 v[156:159], v[100:103], a[252:255], v[156:159]
    buffer_load_dwordx4 v[100:103], v9, s[40:43], s80 offen offset:3072 sc1
    s_waitcnt vmcnt(34)
    v_mfma_f32_16x16x32_bf16 v[144:147], v[104:107], v[224:227], v[144:147]
    v_mfma_f32_16x16x32_bf16 v[148:151], v[104:107], v[228:231], v[148:151]
    v_mfma_f32_16x16x32_bf16 v[152:155], v[104:107], v[232:235], v[152:155]
    v_mfma_f32_16x16x32_bf16 v[156:159], v[104:107], v[236:239], v[156:159]
    buffer_load_dwordx4 v[104:107], v10, s[40:43], s80 offen offset:0 sc1
    v_mfma_f32_16x16x32_bf16 v[160:163], v[108:111], v[240:243], v[144:147]
    v_mfma_f32_16x16x32_bf16 v[164:167], v[108:111], v[244:247], v[148:151]
    v_mfma_f32_16x16x32_bf16 v[168:171], v[108:111], v[248:251], v[152:155]
    v_mfma_f32_16x16x32_bf16 v[172:175], v[108:111], v[252:255], v[156:159]
    buffer_load_dwordx4 v[108:111], v10, s[40:43], s80 offen offset:1024 sc1
    s_waitcnt vmcnt(34)
    v_mfma_f32_16x16x32_bf16 v[144:147], v[112:115], a[0:3], 0
    v_mfma_f32_16x16x32_bf16 v[148:151], v[112:115], a[4:7], 0
    v_mfma_f32_16x16x32_bf16 v[152:155], v[112:115], a[8:11], 0
    v_mfma_f32_16x16x32_bf16 v[156:159], v[112:115], a[12:15], 0
    buffer_load_dwordx4 v[112:115], v10, s[40:43], s80 offen offset:2048 sc1
    v_mfma_f32_16x16x32_bf16 v[144:147], v[116:119], a[16:19], v[144:147]
    v_mfma_f32_16x16x32_bf16 v[148:151], v[116:119], a[20:23], v[148:151]
    v_mfma_f32_16x16x32_bf16 v[152:155], v[116:119], a[24:27], v[152:155]
    v_mfma_f32_16x16x32_bf16 v[156:159], v[116:119], a[28:31], v[156:159]
    buffer_load_dwordx4 v[116:119], v10, s[40:43], s80 offen offset:3072 sc1
    s_waitcnt vmcnt(32)
    v_mfma_f32_16x16x32_bf16 v[144:147], v[120:123], a[32:35], v[144:147]
    s_sub_u32 s14, s59, s58
    s_ashr_i32 s14, s14, 1
    v_mfma_f32_16x16x32_bf16 v[148:151], v[120:123], a[36:39], v[148:151]
    v_add_u32 v220, s14, v220
    v_mfma_f32_16x16x32_bf16 v[152:155], v[120:123], a[40:43], v[152:155]
    v_add_u32 v221, s14, v221
    v_mfma_f32_16x16x32_bf16 v[156:159], v[120:123], a[44:47], v[156:159]
    buffer_load_dwordx4 v[120:123], v11, s[40:43], s80 offen offset:0 sc1
    v_cvt_pk_bf16_f32 v208, v160, v161
    v_mfma_f32_16x16x32_bf16 v[144:147], v[124:127], a[48:51], v[144:147]
    v_cvt_pk_bf16_f32 v209, v162, v163
    v_mfma_f32_16x16x32_bf16 v[148:151], v[124:127], a[52:55], v[148:151]
    v_cvt_pk_bf16_f32 v210, v164, v165
    v_mfma_f32_16x16x32_bf16 v[152:155], v[124:127], a[56:59], v[152:155]
    v_cvt_pk_bf16_f32 v211, v166, v167
    v_mfma_f32_16x16x32_bf16 v[156:159], v[124:127], a[60:63], v[156:159]
    buffer_load_dwordx4 v[124:127], v11, s[40:43], s80 offen offset:1024 sc1
    v_permlane16_swap_b32 v208, v210
    s_waitcnt vmcnt(32)
    v_mfma_f32_16x16x32_bf16 v[144:147], v[128:131], a[64:67], v[144:147]
    v_mfma_f32_16x16x32_bf16 v[148:151], v[128:131], a[68:71], v[148:151]
    v_permlane16_swap_b32 v209, v211
    v_mfma_f32_16x16x32_bf16 v[152:155], v[128:131], a[72:75], v[152:155]
    v_cvt_pk_bf16_f32 v212, v168, v169
    v_mfma_f32_16x16x32_bf16 v[156:159], v[128:131], a[76:79], v[156:159]
    buffer_load_dwordx4 v[128:131], v7, s[40:43], s81 offen offset:0 sc1
    v_cvt_pk_bf16_f32 v213, v170, v171
    v_mfma_f32_16x16x32_bf16 v[144:147], v[132:135], a[80:83], v[144:147]
    v_cvt_pk_bf16_f32 v214, v172, v173
    v_mfma_f32_16x16x32_bf16 v[148:151], v[132:135], a[84:87], v[148:151]
    v_cvt_pk_bf16_f32 v215, v174, v175
    v_mfma_f32_16x16x32_bf16 v[152:155], v[132:135], a[88:91], v[152:155]
    v_permlane16_swap_b32 v212, v214
    v_mfma_f32_16x16x32_bf16 v[156:159], v[132:135], a[92:95], v[156:159]
    buffer_load_dwordx4 v[132:135], v7, s[40:43], s81 offen offset:1024 sc1
    v_permlane16_swap_b32 v213, v215
    s_waitcnt vmcnt(32)
    v_mfma_f32_16x16x32_bf16 v[144:147], v[136:139], a[96:99], v[144:147]
    v_mfma_f32_16x16x32_bf16 v[148:151], v[136:139], a[100:103], v[148:151]
    buffer_store_dwordx4 v[208:211], v5, s[40:43], s59 offen sc1
    v_mfma_f32_16x16x32_bf16 v[152:155], v[136:139], a[104:107], v[152:155]
    buffer_store_dwordx4 v[212:215], v6, s[40:43], s59 offen sc1
    v_mfma_f32_16x16x32_bf16 v[156:159], v[136:139], a[108:111], v[156:159]
    buffer_load_dwordx4 v[136:139], v7, s[40:43], s81 offen offset:2048 sc1
    ds_write_b128 v220, v[208:211]
    v_mfma_f32_16x16x32_bf16 v[144:147], v[140:143], a[112:115], v[144:147]
    ds_write_b128 v221, v[212:215]
    v_mfma_f32_16x16x32_bf16 v[148:151], v[140:143], a[116:119], v[148:151]
    v_mfma_f32_16x16x32_bf16 v[152:155], v[140:143], a[120:123], v[152:155]
    v_mfma_f32_16x16x32_bf16 v[156:159], v[140:143], a[124:127], v[156:159]
    buffer_load_dwordx4 v[140:143], v7, s[40:43], s81 offen offset:3072 sc1
    s_waitcnt vmcnt(34)
    v_mfma_f32_16x16x32_bf16 v[144:147], v[16:19], a[128:131], v[144:147]
    v_mfma_f32_16x16x32_bf16 v[148:151], v[16:19], a[132:135], v[148:151]
    v_mfma_f32_16x16x32_bf16 v[152:155], v[16:19], a[136:139], v[152:155]
    v_mfma_f32_16x16x32_bf16 v[156:159], v[16:19], a[140:143], v[156:159]
    buffer_load_dwordx4 v[16:19], v8, s[40:43], s81 offen offset:0 sc1
    v_mfma_f32_16x16x32_bf16 v[144:147], v[20:23], a[144:147], v[144:147]
    v_mfma_f32_16x16x32_bf16 v[148:151], v[20:23], a[148:151], v[148:151]
    v_mfma_f32_16x16x32_bf16 v[152:155], v[20:23], a[152:155], v[152:155]
    v_mfma_f32_16x16x32_bf16 v[156:159], v[20:23], a[156:159], v[156:159]
    buffer_load_dwordx4 v[20:23], v8, s[40:43], s81 offen offset:1024 sc1
    s_waitcnt vmcnt(34)
    v_mfma_f32_16x16x32_bf16 v[144:147], v[24:27], a[160:163], v[144:147]
    v_mfma_f32_16x16x32_bf16 v[148:151], v[24:27], a[164:167], v[148:151]
    v_mfma_f32_16x16x32_bf16 v[152:155], v[24:27], a[168:171], v[152:155]
    v_mfma_f32_16x16x32_bf16 v[156:159], v[24:27], a[172:175], v[156:159]
    buffer_load_dwordx4 v[24:27], v8, s[40:43], s81 offen offset:2048 sc1
    v_mfma_f32_16x16x32_bf16 v[144:147], v[28:31], a[176:179], v[144:147]
    v_mfma_f32_16x16x32_bf16 v[148:151], v[28:31], a[180:183], v[148:151]
    v_mfma_f32_16x16x32_bf16 v[152:155], v[28:31], a[184:187], v[152:155]
    v_mfma_f32_16x16x32_bf16 v[156:159], v[28:31], a[188:191], v[156:159]
    buffer_load_dwordx4 v[28:31], v8, s[40:43], s81 offen offset:3072 sc1
    s_waitcnt vmcnt(34)
    v_mfma_f32_16x16x32_bf16 v[144:147], v[32:35], a[192:195], v[144:147]
    v_mfma_f32_16x16x32_bf16 v[148:151], v[32:35], a[196:199], v[148:151]
    v_mfma_f32_16x16x32_bf16 v[152:155], v[32:35], a[200:203], v[152:155]
    v_mfma_f32_16x16x32_bf16 v[156:159], v[32:35], a[204:207], v[156:159]
    buffer_load_dwordx4 v[32:35], v9, s[40:43], s81 offen offset:0 sc1
    v_mfma_f32_16x16x32_bf16 v[144:147], v[36:39], a[208:211], v[144:147]
    v_mfma_f32_16x16x32_bf16 v[148:151], v[36:39], a[212:215], v[148:151]
    v_mfma_f32_16x16x32_bf16 v[152:155], v[36:39], a[216:219], v[152:155]
    v_mfma_f32_16x16x32_bf16 v[156:159], v[36:39], a[220:223], v[156:159]
    buffer_load_dwordx4 v[36:39], v9, s[40:43], s81 offen offset:1024 sc1
    s_waitcnt vmcnt(34)
    v_mfma_f32_16x16x32_bf16 v[144:147], v[40:43], a[224:227], v[144:147]
    v_mfma_f32_16x16x32_bf16 v[148:151], v[40:43], a[228:231], v[148:151]
    v_mfma_f32_16x16x32_bf16 v[152:155], v[40:43], a[232:235], v[152:155]
    v_mfma_f32_16x16x32_bf16 v[156:159], v[40:43], a[236:239], v[156:159]
    buffer_load_dwordx4 v[40:43], v9, s[40:43], s81 offen offset:2048 sc1
    v_mfma_f32_16x16x32_bf16 v[144:147], v[44:47], a[240:243], v[144:147]
    v_mfma_f32_16x16x32_bf16 v[148:151], v[44:47], a[244:247], v[148:151]
    v_mfma_f32_16x16x32_bf16 v[152:155], v[44:47], a[248:251], v[152:155]
    v_mfma_f32_16x16x32_bf16 v[156:159], v[44:47], a[252:255], v[156:159]
    buffer_load_dwordx4 v[44:47], v9, s[40:43], s81 offen offset:3072 sc1
    s_waitcnt vmcnt(34)
    v_mfma_f32_16x16x32_bf16 v[144:147], v[48:51], v[224:227], v[144:147]
    v_mfma_f32_16x16x32_bf16 v[148:151], v[48:51], v[228:231], v[148:151]
    v_mfma_f32_16x16x32_bf16 v[152:155], v[48:51], v[232:235], v[152:155]
    v_mfma_f32_16x16x32_bf16 v[156:159], v[48:51], v[236:239], v[156:159]
    buffer_load_dwordx4 v[48:51], v10, s[40:43], s81 offen offset:0 sc1
    v_mfma_f32_16x16x32_bf16 v[160:163], v[52:55], v[240:243], v[144:147]
    v_mfma_f32_16x16x32_bf16 v[164:167], v[52:55], v[244:247], v[148:151]
    v_mfma_f32_16x16x32_bf16 v[168:171], v[52:55], v[248:251], v[152:155]
    v_mfma_f32_16x16x32_bf16 v[172:175], v[52:55], v[252:255], v[156:159]
    buffer_load_dwordx4 v[52:55], v10, s[40:43], s81 offen offset:1024 sc1
    s_waitcnt vmcnt(34)
    v_mfma_f32_16x16x32_bf16 v[144:147], v[56:59], a[0:3], 0
    v_mfma_f32_16x16x32_bf16 v[148:151], v[56:59], a[4:7], 0
    v_mfma_f32_16x16x32_bf16 v[152:155], v[56:59], a[8:11], 0
    v_mfma_f32_16x16x32_bf16 v[156:159], v[56:59], a[12:15], 0
    buffer_load_dwordx4 v[56:59], v10, s[40:43], s81 offen offset:2048 sc1
    v_mfma_f32_16x16x32_bf16 v[144:147], v[60:63], a[16:19], v[144:147]
    v_mfma_f32_16x16x32_bf16 v[148:151], v[60:63], a[20:23], v[148:151]
    v_mfma_f32_16x16x32_bf16 v[152:155], v[60:63], a[24:27], v[152:155]
    v_mfma_f32_16x16x32_bf16 v[156:159], v[60:63], a[28:31], v[156:159]
    buffer_load_dwordx4 v[60:63], v10, s[40:43], s81 offen offset:3072 sc1
    s_waitcnt vmcnt(32)
    v_mfma_f32_16x16x32_bf16 v[144:147], v[64:67], a[32:35], v[144:147]
    s_sub_u32 s14, s85, s59
    s_ashr_i32 s14, s14, 1
    v_mfma_f32_16x16x32_bf16 v[148:151], v[64:67], a[36:39], v[148:151]
    v_add_u32 v220, s14, v220
    v_mfma_f32_16x16x32_bf16 v[152:155], v[64:67], a[40:43], v[152:155]
    v_add_u32 v221, s14, v221
    v_mfma_f32_16x16x32_bf16 v[156:159], v[64:67], a[44:47], v[156:159]
    buffer_load_dwordx4 v[64:67], v11, s[40:43], s81 offen offset:0 sc1
    v_cvt_pk_bf16_f32 v192, v160, v161
    v_mfma_f32_16x16x32_bf16 v[144:147], v[68:71], a[48:51], v[144:147]
    v_cvt_pk_bf16_f32 v193, v162, v163
    v_mfma_f32_16x16x32_bf16 v[148:151], v[68:71], a[52:55], v[148:151]
    v_cvt_pk_bf16_f32 v194, v164, v165
    v_mfma_f32_16x16x32_bf16 v[152:155], v[68:71], a[56:59], v[152:155]
    v_cvt_pk_bf16_f32 v195, v166, v167
    v_mfma_f32_16x16x32_bf16 v[156:159], v[68:71], a[60:63], v[156:159]
    buffer_load_dwordx4 v[68:71], v11, s[40:43], s81 offen offset:1024 sc1
    v_permlane16_swap_b32 v192, v194
    s_waitcnt vmcnt(32)
    v_mfma_f32_16x16x32_bf16 v[144:147], v[72:75], a[64:67], v[144:147]
    v_mfma_f32_16x16x32_bf16 v[148:151], v[72:75], a[68:71], v[148:151]
    v_permlane16_swap_b32 v193, v195
    v_mfma_f32_16x16x32_bf16 v[152:155], v[72:75], a[72:75], v[152:155]
    v_cvt_pk_bf16_f32 v196, v168, v169
    v_mfma_f32_16x16x32_bf16 v[156:159], v[72:75], a[76:79], v[156:159]
    buffer_load_dwordx4 v[72:75], v7, s[40:43], s82 offen offset:0 sc1
    v_cvt_pk_bf16_f32 v197, v170, v171
    v_mfma_f32_16x16x32_bf16 v[144:147], v[76:79], a[80:83], v[144:147]
    v_cvt_pk_bf16_f32 v198, v172, v173
    v_mfma_f32_16x16x32_bf16 v[148:151], v[76:79], a[84:87], v[148:151]
    v_cvt_pk_bf16_f32 v199, v174, v175
    v_mfma_f32_16x16x32_bf16 v[152:155], v[76:79], a[88:91], v[152:155]
    v_permlane16_swap_b32 v196, v198
    v_mfma_f32_16x16x32_bf16 v[156:159], v[76:79], a[92:95], v[156:159]
    buffer_load_dwordx4 v[76:79], v7, s[40:43], s82 offen offset:1024 sc1
    v_permlane16_swap_b32 v197, v199
    s_waitcnt vmcnt(32)
    v_mfma_f32_16x16x32_bf16 v[144:147], v[80:83], a[96:99], v[144:147]
    v_mfma_f32_16x16x32_bf16 v[148:151], v[80:83], a[100:103], v[148:151]
    buffer_store_dwordx4 v[192:195], v5, s[40:43], s85 offen sc1
    v_mfma_f32_16x16x32_bf16 v[152:155], v[80:83], a[104:107], v[152:155]
    buffer_store_dwordx4 v[196:199], v6, s[40:43], s85 offen sc1
    v_mfma_f32_16x16x32_bf16 v[156:159], v[80:83], a[108:111], v[156:159]
    buffer_load_dwordx4 v[80:83], v7, s[40:43], s82 offen offset:2048 sc1
    ds_write_b128 v220, v[192:195]
    v_mfma_f32_16x16x32_bf16 v[144:147], v[84:87], a[112:115], v[144:147]
    ds_write_b128 v221, v[196:199]
    v_mfma_f32_16x16x32_bf16 v[148:151], v[84:87], a[116:119], v[148:151]
    v_mfma_f32_16x16x32_bf16 v[152:155], v[84:87], a[120:123], v[152:155]
    v_mfma_f32_16x16x32_bf16 v[156:159], v[84:87], a[124:127], v[156:159]
    buffer_load_dwordx4 v[84:87], v7, s[40:43], s82 offen offset:3072 sc1
    s_waitcnt vmcnt(34)
    v_mfma_f32_16x16x32_bf16 v[144:147], v[88:91], a[128:131], v[144:147]
    v_mfma_f32_16x16x32_bf16 v[148:151], v[88:91], a[132:135], v[148:151]
    v_mfma_f32_16x16x32_bf16 v[152:155], v[88:91], a[136:139], v[152:155]
    v_mfma_f32_16x16x32_bf16 v[156:159], v[88:91], a[140:143], v[156:159]
    buffer_load_dwordx4 v[88:91], v8, s[40:43], s82 offen offset:0 sc1
    v_mfma_f32_16x16x32_bf16 v[144:147], v[92:95], a[144:147], v[144:147]
    v_mfma_f32_16x16x32_bf16 v[148:151], v[92:95], a[148:151], v[148:151]
    v_mfma_f32_16x16x32_bf16 v[152:155], v[92:95], a[152:155], v[152:155]
    v_mfma_f32_16x16x32_bf16 v[156:159], v[92:95], a[156:159], v[156:159]
    buffer_load_dwordx4 v[92:95], v8, s[40:43], s82 offen offset:1024 sc1
    s_waitcnt vmcnt(34)
    v_mfma_f32_16x16x32_bf16 v[144:147], v[96:99], a[160:163], v[144:147]
    v_mfma_f32_16x16x32_bf16 v[148:151], v[96:99], a[164:167], v[148:151]
    v_mfma_f32_16x16x32_bf16 v[152:155], v[96:99], a[168:171], v[152:155]
    v_mfma_f32_16x16x32_bf16 v[156:159], v[96:99], a[172:175], v[156:159]
    buffer_load_dwordx4 v[96:99], v8, s[40:43], s82 offen offset:2048 sc1
    v_mfma_f32_16x16x32_bf16 v[144:147], v[100:103], a[176:179], v[144:147]
    v_mfma_f32_16x16x32_bf16 v[148:151], v[100:103], a[180:183], v[148:151]
    v_mfma_f32_16x16x32_bf16 v[152:155], v[100:103], a[184:187], v[152:155]
    v_mfma_f32_16x16x32_bf16 v[156:159], v[100:103], a[188:191], v[156:159]
    buffer_load_dwordx4 v[100:103], v8, s[40:43], s82 offen offset:3072 sc1
    s_waitcnt vmcnt(34)
    v_mfma_f32_16x16x32_bf16 v[144:147], v[104:107], a[192:195], v[144:147]
    v_mfma_f32_16x16x32_bf16 v[148:151], v[104:107], a[196:199], v[148:151]
    v_mfma_f32_16x16x32_bf16 v[152:155], v[104:107], a[200:203], v[152:155]
    v_mfma_f32_16x16x32_bf16 v[156:159], v[104:107], a[204:207], v[156:159]
    buffer_load_dwordx4 v[104:107], v9, s[40:43], s82 offen offset:0 sc1
    v_mfma_f32_16x16x32_bf16 v[144:147], v[108:111], a[208:211], v[144:147]
    v_mfma_f32_16x16x32_bf16 v[148:151], v[108:111], a[212:215], v[148:151]
    v_mfma_f32_16x16x32_bf16 v[152:155], v[108:111], a[216:219], v[152:155]
    v_mfma_f32_16x16x32_bf16 v[156:159], v[108:111], a[220:223], v[156:159]
    buffer_load_dwordx4 v[108:111], v9, s[40:43], s82 offen offset:1024 sc1
    s_waitcnt vmcnt(34)
    v_mfma_f32_16x16x32_bf16 v[144:147], v[112:115], a[224:227], v[144:147]
    v_mfma_f32_16x16x32_bf16 v[148:151], v[112:115], a[228:231], v[148:151]
    v_mfma_f32_16x16x32_bf16 v[152:155], v[112:115], a[232:235], v[152:155]
    v_mfma_f32_16x16x32_bf16 v[156:159], v[112:115], a[236:239], v[156:159]
    buffer_load_dwordx4 v[112:115], v9, s[40:43], s82 offen offset:2048 sc1
    v_mfma_f32_16x16x32_bf16 v[144:147], v[116:119], a[240:243], v[144:147]
    v_mfma_f32_16x16x32_bf16 v[148:151], v[116:119], a[244:247], v[148:151]
    v_mfma_f32_16x16x32_bf16 v[152:155], v[116:119], a[248:251], v[152:155]
    v_mfma_f32_16x16x32_bf16 v[156:159], v[116:119], a[252:255], v[156:159]
    buffer_load_dwordx4 v[116:119], v9, s[40:43], s82 offen offset:3072 sc1
    s_waitcnt vmcnt(34)
    v_mfma_f32_16x16x32_bf16 v[144:147], v[120:123], v[224:227], v[144:147]
    v_mfma_f32_16x16x32_bf16 v[148:151], v[120:123], v[228:231], v[148:151]
    v_mfma_f32_16x16x32_bf16 v[152:155], v[120:123], v[232:235], v[152:155]
    v_mfma_f32_16x16x32_bf16 v[156:159], v[120:123], v[236:239], v[156:159]
    buffer_load_dwordx4 v[120:123], v10, s[40:43], s82 offen offset:0 sc1
    v_mfma_f32_16x16x32_bf16 v[160:163], v[124:127], v[240:243], v[144:147]
    v_mfma_f32_16x16x32_bf16 v[164:167], v[124:127], v[244:247], v[148:151]
    v_mfma_f32_16x16x32_bf16 v[168:171], v[124:127], v[248:251], v[152:155]
    v_mfma_f32_16x16x32_bf16 v[172:175], v[124:127], v[252:255], v[156:159]
    buffer_load_dwordx4 v[124:127], v10, s[40:43], s82 offen offset:1024 sc1
    s_waitcnt vmcnt(34)
    v_mfma_f32_16x16x32_bf16 v[144:147], v[128:131], a[0:3], 0
    v_mfma_f32_16x16x32_bf16 v[148:151], v[128:131], a[4:7], 0
    v_mfma_f32_16x16x32_bf16 v[152:155], v[128:131], a[8:11], 0
    v_mfma_f32_16x16x32_bf16 v[156:159], v[128:131], a[12:15], 0
    buffer_load_dwordx4 v[128:131], v10, s[40:43], s82 offen offset:2048 sc1
    v_mfma_f32_16x16x32_bf16 v[144:147], v[132:135], a[16:19], v[144:147]
    v_mfma_f32_16x16x32_bf16 v[148:151], v[132:135], a[20:23], v[148:151]
    v_mfma_f32_16x16x32_bf16 v[152:155], v[132:135], a[24:27], v[152:155]
    v_mfma_f32_16x16x32_bf16 v[156:159], v[132:135], a[28:31], v[156:159]
    buffer_load_dwordx4 v[132:135], v10, s[40:43], s82 offen offset:3072 sc1
    s_waitcnt vmcnt(32)
    v_mfma_f32_16x16x32_bf16 v[144:147], v[136:139], a[32:35], v[144:147]
    s_sub_u32 s14, s86, s85
    s_ashr_i32 s14, s14, 1
    v_mfma_f32_16x16x32_bf16 v[148:151], v[136:139], a[36:39], v[148:151]
    v_add_u32 v220, s14, v220
    v_mfma_f32_16x16x32_bf16 v[152:155], v[136:139], a[40:43], v[152:155]
    v_add_u32 v221, s14, v221
    v_mfma_f32_16x16x32_bf16 v[156:159], v[136:139], a[44:47], v[156:159]
    buffer_load_dwordx4 v[136:139], v11, s[40:43], s82 offen offset:0 sc1
    v_cvt_pk_bf16_f32 v200, v160, v161
    v_mfma_f32_16x16x32_bf16 v[144:147], v[140:143], a[48:51], v[144:147]
    v_cvt_pk_bf16_f32 v201, v162, v163
    v_mfma_f32_16x16x32_bf16 v[148:151], v[140:143], a[52:55], v[148:151]
    v_cvt_pk_bf16_f32 v202, v164, v165
    v_mfma_f32_16x16x32_bf16 v[152:155], v[140:143], a[56:59], v[152:155]
    v_cvt_pk_bf16_f32 v203, v166, v167
    v_mfma_f32_16x16x32_bf16 v[156:159], v[140:143], a[60:63], v[156:159]
    buffer_load_dwordx4 v[140:143], v11, s[40:43], s82 offen offset:1024 sc1
    v_permlane16_swap_b32 v200, v202
    s_waitcnt vmcnt(32)
    v_mfma_f32_16x16x32_bf16 v[144:147], v[16:19], a[64:67], v[144:147]
    v_mfma_f32_16x16x32_bf16 v[148:151], v[16:19], a[68:71], v[148:151]
    v_permlane16_swap_b32 v201, v203
    v_mfma_f32_16x16x32_bf16 v[152:155], v[16:19], a[72:75], v[152:155]
    v_cvt_pk_bf16_f32 v204, v168, v169
    v_mfma_f32_16x16x32_bf16 v[156:159], v[16:19], a[76:79], v[156:159]
    buffer_load_dwordx4 v[16:19], v7, s[40:43], s83 offen offset:0 sc1
    v_cvt_pk_bf16_f32 v205, v170, v171
    v_mfma_f32_16x16x32_bf16 v[144:147], v[20:23], a[80:83], v[144:147]
    v_cvt_pk_bf16_f32 v206, v172, v173
    v_mfma_f32_16x16x32_bf16 v[148:151], v[20:23], a[84:87], v[148:151]
    v_cvt_pk_bf16_f32 v207, v174, v175
    v_mfma_f32_16x16x32_bf16 v[152:155], v[20:23], a[88:91], v[152:155]
    v_permlane16_swap_b32 v204, v206
    v_mfma_f32_16x16x32_bf16 v[156:159], v[20:23], a[92:95], v[156:159]
    buffer_load_dwordx4 v[20:23], v7, s[40:43], s83 offen offset:1024 sc1
    v_permlane16_swap_b32 v205, v207
    s_waitcnt vmcnt(32)
    v_mfma_f32_16x16x32_bf16 v[144:147], v[24:27], a[96:99], v[144:147]
    v_mfma_f32_16x16x32_bf16 v[148:151], v[24:27], a[100:103], v[148:151]
    buffer_store_dwordx4 v[200:203], v5, s[40:43], s86 offen sc1
    v_mfma_f32_16x16x32_bf16 v[152:155], v[24:27], a[104:107], v[152:155]
    buffer_store_dwordx4 v[204:207], v6, s[40:43], s86 offen sc1
    v_mfma_f32_16x16x32_bf16 v[156:159], v[24:27], a[108:111], v[156:159]
    buffer_load_dwordx4 v[24:27], v7, s[40:43], s83 offen offset:2048 sc1
    ds_write_b128 v220, v[200:203]
    v_mfma_f32_16x16x32_bf16 v[144:147], v[28:31], a[112:115], v[144:147]
    ds_write_b128 v221, v[204:207]
    v_mfma_f32_16x16x32_bf16 v[148:151], v[28:31], a[116:119], v[148:151]
    v_mfma_f32_16x16x32_bf16 v[152:155], v[28:31], a[120:123], v[152:155]
    v_mfma_f32_16x16x32_bf16 v[156:159], v[28:31], a[124:127], v[156:159]
    buffer_load_dwordx4 v[28:31], v7, s[40:43], s83 offen offset:3072 sc1
    s_waitcnt vmcnt(34)
    v_mfma_f32_16x16x32_bf16 v[144:147], v[32:35], a[128:131], v[144:147]
    v_mfma_f32_16x16x32_bf16 v[148:151], v[32:35], a[132:135], v[148:151]
    v_mfma_f32_16x16x32_bf16 v[152:155], v[32:35], a[136:139], v[152:155]
    v_mfma_f32_16x16x32_bf16 v[156:159], v[32:35], a[140:143], v[156:159]
    buffer_load_dwordx4 v[32:35], v8, s[40:43], s83 offen offset:0 sc1
    v_mfma_f32_16x16x32_bf16 v[144:147], v[36:39], a[144:147], v[144:147]
    v_mfma_f32_16x16x32_bf16 v[148:151], v[36:39], a[148:151], v[148:151]
    v_mfma_f32_16x16x32_bf16 v[152:155], v[36:39], a[152:155], v[152:155]
    v_mfma_f32_16x16x32_bf16 v[156:159], v[36:39], a[156:159], v[156:159]
    buffer_load_dwordx4 v[36:39], v8, s[40:43], s83 offen offset:1024 sc1
    s_waitcnt vmcnt(34)
    v_mfma_f32_16x16x32_bf16 v[144:147], v[40:43], a[160:163], v[144:147]
    v_mfma_f32_16x16x32_bf16 v[148:151], v[40:43], a[164:167], v[148:151]
    v_mfma_f32_16x16x32_bf16 v[152:155], v[40:43], a[168:171], v[152:155]
    v_mfma_f32_16x16x32_bf16 v[156:159], v[40:43], a[172:175], v[156:159]
    buffer_load_dwordx4 v[40:43], v8, s[40:43], s83 offen offset:2048 sc1
    v_mfma_f32_16x16x32_bf16 v[144:147], v[44:47], a[176:179], v[144:147]
    v_mfma_f32_16x16x32_bf16 v[148:151], v[44:47], a[180:183], v[148:151]
    v_mfma_f32_16x16x32_bf16 v[152:155], v[44:47], a[184:187], v[152:155]
    v_mfma_f32_16x16x32_bf16 v[156:159], v[44:47], a[188:191], v[156:159]
    buffer_load_dwordx4 v[44:47], v8, s[40:43], s83 offen offset:3072 sc1
    s_waitcnt vmcnt(34)
    v_mfma_f32_16x16x32_bf16 v[144:147], v[48:51], a[192:195], v[144:147]
    v_mfma_f32_16x16x32_bf16 v[148:151], v[48:51], a[196:199], v[148:151]
    v_mfma_f32_16x16x32_bf16 v[152:155], v[48:51], a[200:203], v[152:155]
    v_mfma_f32_16x16x32_bf16 v[156:159], v[48:51], a[204:207], v[156:159]
    buffer_load_dwordx4 v[48:51], v9, s[40:43], s83 offen offset:0 sc1
    v_mfma_f32_16x16x32_bf16 v[144:147], v[52:55], a[208:211], v[144:147]
    v_mfma_f32_16x16x32_bf16 v[148:151], v[52:55], a[212:215], v[148:151]
    v_mfma_f32_16x16x32_bf16 v[152:155], v[52:55], a[216:219], v[152:155]
    v_mfma_f32_16x16x32_bf16 v[156:159], v[52:55], a[220:223], v[156:159]
    buffer_load_dwordx4 v[52:55], v9, s[40:43], s83 offen offset:1024 sc1
    s_waitcnt vmcnt(34)
    v_mfma_f32_16x16x32_bf16 v[144:147], v[56:59], a[224:227], v[144:147]
    v_mfma_f32_16x16x32_bf16 v[148:151], v[56:59], a[228:231], v[148:151]
    v_mfma_f32_16x16x32_bf16 v[152:155], v[56:59], a[232:235], v[152:155]
    v_mfma_f32_16x16x32_bf16 v[156:159], v[56:59], a[236:239], v[156:159]
    buffer_load_dwordx4 v[56:59], v9, s[40:43], s83 offen offset:2048 sc1
    v_mfma_f32_16x16x32_bf16 v[144:147], v[60:63], a[240:243], v[144:147]
    v_mfma_f32_16x16x32_bf16 v[148:151], v[60:63], a[244:247], v[148:151]
    v_mfma_f32_16x16x32_bf16 v[152:155], v[60:63], a[248:251], v[152:155]
    v_mfma_f32_16x16x32_bf16 v[156:159], v[60:63], a[252:255], v[156:159]
    buffer_load_dwordx4 v[60:63], v9, s[40:43], s83 offen offset:3072 sc1
    s_waitcnt vmcnt(34)
    v_mfma_f32_16x16x32_bf16 v[144:147], v[64:67], v[224:227], v[144:147]
    v_mfma_f32_16x16x32_bf16 v[148:151], v[64:67], v[228:231], v[148:151]
    v_mfma_f32_16x16x32_bf16 v[152:155], v[64:67], v[232:235], v[152:155]
    v_mfma_f32_16x16x32_bf16 v[156:159], v[64:67], v[236:239], v[156:159]
    buffer_load_dwordx4 v[64:67], v10, s[40:43], s83 offen offset:0 sc1
    v_mfma_f32_16x16x32_bf16 v[160:163], v[68:71], v[240:243], v[144:147]
    v_mfma_f32_16x16x32_bf16 v[164:167], v[68:71], v[244:247], v[148:151]
    v_mfma_f32_16x16x32_bf16 v[168:171], v[68:71], v[248:251], v[152:155]
    v_mfma_f32_16x16x32_bf16 v[172:175], v[68:71], v[252:255], v[156:159]
    buffer_load_dwordx4 v[68:71], v10, s[40:43], s83 offen offset:1024 sc1
    s_waitcnt vmcnt(34)
    v_mfma_f32_16x16x32_bf16 v[144:147], v[72:75], a[0:3], 0
    v_mfma_f32_16x16x32_bf16 v[148:151], v[72:75], a[4:7], 0
    v_mfma_f32_16x16x32_bf16 v[152:155], v[72:75], a[8:11], 0
    v_mfma_f32_16x16x32_bf16 v[156:159], v[72:75], a[12:15], 0
    buffer_load_dwordx4 v[72:75], v10, s[40:43], s83 offen offset:2048 sc1
    v_mfma_f32_16x16x32_bf16 v[144:147], v[76:79], a[16:19], v[144:147]
    v_mfma_f32_16x16x32_bf16 v[148:151], v[76:79], a[20:23], v[148:151]
    v_mfma_f32_16x16x32_bf16 v[152:155], v[76:79], a[24:27], v[152:155]
    v_mfma_f32_16x16x32_bf16 v[156:159], v[76:79], a[28:31], v[156:159]
    buffer_load_dwordx4 v[76:79], v10, s[40:43], s83 offen offset:3072 sc1
    s_waitcnt vmcnt(32)
    v_mfma_f32_16x16x32_bf16 v[144:147], v[80:83], a[32:35], v[144:147]
    s_sub_u32 s14, s87, s86
    s_ashr_i32 s14, s14, 1
    v_add_u32 v220, s14, v220
    v_mfma_f32_16x16x32_bf16 v[148:151], v[80:83], a[36:39], v[148:151]
    v_add_u32 v221, s14, v221
    v_mfma_f32_16x16x32_bf16 v[152:155], v[80:83], a[40:43], v[152:155]
    v_cvt_pk_bf16_f32 v208, v160, v161
    v_mfma_f32_16x16x32_bf16 v[156:159], v[80:83], a[44:47], v[156:159]
    buffer_load_dwordx4 v[80:83], v11, s[40:43], s83 offen offset:0 sc1
    v_cvt_pk_bf16_f32 v209, v162, v163
    v_cvt_pk_bf16_f32 v210, v164, v165
    v_mfma_f32_16x16x32_bf16 v[144:147], v[84:87], a[48:51], v[144:147]
    v_cvt_pk_bf16_f32 v211, v166, v167
    v_mfma_f32_16x16x32_bf16 v[148:151], v[84:87], a[52:55], v[148:151]
    v_permlane16_swap_b32 v208, v210
    v_mfma_f32_16x16x32_bf16 v[152:155], v[84:87], a[56:59], v[152:155]
    v_permlane16_swap_b32 v209, v211
    v_cvt_pk_bf16_f32 v212, v168, v169
    v_mfma_f32_16x16x32_bf16 v[156:159], v[84:87], a[60:63], v[156:159]
    buffer_load_dwordx4 v[84:87], v11, s[40:43], s83 offen offset:1024 sc1
    v_cvt_pk_bf16_f32 v213, v170, v171
    s_waitcnt vmcnt(32)
    v_mfma_f32_16x16x32_bf16 v[144:147], v[88:91], a[64:67], v[144:147]
    v_cvt_pk_bf16_f32 v214, v172, v173
    v_mfma_f32_16x16x32_bf16 v[148:151], v[88:91], a[68:71], v[148:151]
    v_cvt_pk_bf16_f32 v215, v174, v175
    v_permlane16_swap_b32 v212, v214
    v_mfma_f32_16x16x32_bf16 v[152:155], v[88:91], a[72:75], v[152:155]
    v_permlane16_swap_b32 v213, v215
    v_mfma_f32_16x16x32_bf16 v[156:159], v[88:91], a[76:79], v[156:159]
    buffer_load_dwordx4 v[88:91], v7, s[40:43], s84 offen offset:0 sc1
    buffer_store_dwordx4 v[208:211], v5, s[40:43], s87 offen sc1
    v_mfma_f32_16x16x32_bf16 v[144:147], v[92:95], a[80:83], v[144:147]
    buffer_store_dwordx4 v[212:215], v6, s[40:43], s87 offen sc1
    ds_write_b128 v220, v[208:211]
    v_mfma_f32_16x16x32_bf16 v[148:151], v[92:95], a[84:87], v[148:151]
    ds_write_b128 v221, v[212:215]
    v_mfma_f32_16x16x32_bf16 v[152:155], v[92:95], a[88:91], v[152:155]
    s_lshr_b32 s6, s4, 1
    v_mfma_f32_16x16x32_bf16 v[156:159], v[92:95], a[92:95], v[156:159]
    buffer_load_dwordx4 v[92:95], v7, s[40:43], s84 offen offset:1024 sc1
    s_mul_i32 s6, s6, 18432
    s_and_b32 s7, s4, 1
    s_waitcnt vmcnt(34)
    v_mfma_f32_16x16x32_bf16 v[144:147], v[96:99], a[96:99], v[144:147]
    s_lshl_b32 s7, s7, 7
    v_mfma_f32_16x16x32_bf16 v[148:151], v[96:99], a[100:103], v[148:151]
    s_add_u32 s6, s6, s7
    v_mfma_f32_16x16x32_bf16 v[152:155], v[96:99], a[104:107], v[152:155]
    s_mul_i32 s7, s3, 4608
    s_add_u32 s6, s6, s7
    v_mfma_f32_16x16x32_bf16 v[156:159], v[96:99], a[108:111], v[156:159]
    buffer_load_dwordx4 v[96:99], v7, s[40:43], s84 offen offset:2048 sc1
    s_add_u32 s6, s6, s44
    v_mfma_f32_16x16x32_bf16 v[144:147], v[100:103], a[112:115], v[144:147]
    s_lshl_b32 s7, s47, 3
    v_mfma_f32_16x16x32_bf16 v[148:151], v[100:103], a[116:119], v[148:151]
    s_add_u32 s48, s6, s7
    s_add_u32 s48, s48, 0x920000
    v_mfma_f32_16x16x32_bf16 v[152:155], v[100:103], a[120:123], v[152:155]
    s_add_u32 s49, s48, 294912
    v_mfma_f32_16x16x32_bf16 v[156:159], v[100:103], a[124:127], v[156:159]
    buffer_load_dwordx4 v[100:103], v7, s[40:43], s84 offen offset:3072 sc1
    s_add_u32 s50, s48, 4096
    s_waitcnt vmcnt(34)
    v_mfma_f32_16x16x32_bf16 v[144:147], v[104:107], a[128:131], v[144:147]
    s_add_u32 s51, s49, 4096
    v_mfma_f32_16x16x32_bf16 v[148:151], v[104:107], a[132:135], v[148:151]
    s_add_u32 s6, s6, s47
    s_add_u32 s52, s6, 0x6c0000
    v_mfma_f32_16x16x32_bf16 v[152:155], v[104:107], a[136:139], v[152:155]
    s_add_u32 s53, s52, 4096
    v_mfma_f32_16x16x32_bf16 v[156:159], v[104:107], a[140:143], v[156:159]
    buffer_load_dwordx4 v[104:107], v8, s[40:43], s84 offen offset:0 sc1
    s_add_u32 s54, s6, 0x1fa0000
    v_mfma_f32_16x16x32_bf16 v[144:147], v[108:111], a[144:147], v[144:147]
    s_add_u32 s55, s6, 0x1b20000
    v_and_b32 v176, 7, v1
    v_mfma_f32_16x16x32_bf16 v[148:151], v[108:111], a[148:151], v[148:151]
    v_bfe_u32 v177, v1, 3, 1
    v_mfma_f32_16x16x32_bf16 v[152:155], v[108:111], a[152:155], v[152:155]
    v_lshlrev_b32 v178, 4, v176
    v_mfma_f32_16x16x32_bf16 v[156:159], v[108:111], a[156:159], v[156:159]
    buffer_load_dwordx4 v[108:111], v8, s[40:43], s84 offen offset:1024 sc1
    v_lshl_add_u32 v178, v177, 8, v178
    v_mul_u32_u24 v179, 73728, v3
    s_waitcnt vmcnt(34)
    v_mfma_f32_16x16x32_bf16 v[144:147], v[112:115], a[160:163], v[144:147]
    v_add_u32 v179, v179, v178
    v_mfma_f32_16x16x32_bf16 v[148:151], v[112:115], a[164:167], v[148:151]
    s_and_b32 s7, s4, 3
    v_mfma_f32_16x16x32_bf16 v[152:155], v[112:115], a[168:171], v[152:155]
    v_cmp_eq_u32 vcc, s7, v3
    s_cmp_lt_u32 s4, 4
    v_mfma_f32_16x16x32_bf16 v[156:159], v[112:115], a[172:175], v[156:159]
    buffer_load_dwordx4 v[112:115], v8, s[40:43], s84 offen offset:2048 sc1
    s_cselect_b64 s[10:11], 0, vcc
    v_mfma_f32_16x16x32_bf16 v[144:147], v[116:119], a[176:179], v[144:147]
    s_cselect_b64 vcc, vcc, 0
    v_mfma_f32_16x16x32_bf16 v[148:151], v[116:119], a[180:183], v[148:151]
    v_mov_b32 v218, 0x80000000
    v_cndmask_b32 v219, v179, v218, s[10:11]
    v_mfma_f32_16x16x32_bf16 v[152:155], v[116:119], a[184:187], v[152:155]
    v_cndmask_b32 v179, v179, v218, vcc
    v_mfma_f32_16x16x32_bf16 v[156:159], v[116:119], a[188:191], v[156:159]
    buffer_load_dwordx4 v[116:119], v8, s[40:43], s84 offen offset:3072 sc1
    v_and_b32 v180, 1, v3
    s_waitcnt vmcnt(34)
    v_mfma_f32_16x16x32_bf16 v[144:147], v[120:123], a[192:195], v[144:147]
    v_lshrrev_b32 v181, 1, v3
    v_lshl_add_u32 v182, v181, 9, v178
    v_mfma_f32_16x16x32_bf16 v[148:151], v[120:123], a[196:199], v[148:151]
    v_lshl_add_u32 v183, v180, 10, v182
    v_mfma_f32_16x16x32_bf16 v[152:155], v[120:123], a[200:203], v[152:155]
    v_lshl_add_u32 v182, v180, 3, v182
    v_mfma_f32_16x16x32_bf16 v[156:159], v[120:123], a[204:207], v[156:159]
    buffer_load_dwordx4 v[120:123], v9, s[40:43], s84 offen offset:0 sc1
    v_lshlrev_b32 v218, 4, v4
    v_lshl_add_u32 v218, v181, 8, v218
    v_mfma_f32_16x16x32_bf16 v[144:147], v[124:127], a[208:211], v[144:147]
    v_lshl_add_u32 v218, v180, 3, v218
    v_mfma_f32_16x16x32_bf16 v[148:151], v[124:127], a[212:215], v[148:151]
    v_add_u32 v218, s8, v218
    v_mfma_f32_16x16x32_bf16 v[152:155], v[124:127], a[216:219], v[152:155]
    v_lshlrev_b32 v184, 4, v177
    v_lshl_add_u32 v184, v181, 5, v184
    v_mfma_f32_16x16x32_bf16 v[156:159], v[124:127], a[220:223], v[156:159]
    buffer_load_dwordx4 v[124:127], v9, s[40:43], s84 offen offset:1024 sc1
    v_mul_u32_u24 v185, 1152, v176
    s_waitcnt vmcnt(34)
    v_mfma_f32_16x16x32_bf16 v[144:147], v[128:131], a[224:227], v[144:147]
    v_add_u32 v185, v185, v184
    v_mfma_f32_16x16x32_bf16 v[148:151], v[128:131], a[228:231], v[148:151]
    v_lshl_add_u32 v185, v180, 6, v185
    v_mfma_f32_16x16x32_bf16 v[152:155], v[128:131], a[232:235], v[152:155]
    v_lshl_add_u32 v184, v180, 3, v184
    v_mov_b32 v188, 0x80000000
    v_mfma_f32_16x16x32_bf16 v[156:159], v[128:131], a[236:239], v[156:159]
    buffer_load_dwordx4 v[128:131], v9, s[40:43], s84 offen offset:2048 sc1
    v_cmp_eq_u32 vcc, 0, v3
    v_mfma_f32_16x16x32_bf16 v[144:147], v[132:135], a[240:243], v[144:147]
    v_add_u32 v186, 4096, v183
    v_mfma_f32_16x16x32_bf16 v[148:151], v[132:135], a[244:247], v[148:151]
    v_cndmask_b32 v186, v188, v186, vcc
    v_cndmask_b32 v187, v188, v185, vcc
    v_mfma_f32_16x16x32_bf16 v[152:155], v[132:135], a[248:251], v[152:155]
    v_cmp_gt_u32 vcc, 2, v3
    v_mfma_f32_16x16x32_bf16 v[156:159], v[132:135], a[252:255], v[156:159]
    buffer_load_dwordx4 v[132:135], v9, s[40:43], s84 offen offset:3072 sc1
    v_cndmask_b32 v188, 0, -1, vcc
    s_waitcnt vmcnt(34)
    v_mfma_f32_16x16x32_bf16 v[144:147], v[136:139], v[224:227], v[144:147]
    s_lshl_b32 s66, s45, 30
    s_add_u32 s60, s60, s66
    v_mfma_f32_16x16x32_bf16 v[148:151], v[136:139], v[228:231], v[148:151]
    s_add_u32 s67, s66, 10752
    v_mfma_f32_16x16x32_bf16 v[152:155], v[136:139], v[232:235], v[152:155]
    s_add_u32 s68, s66, 21504
    v_mfma_f32_16x16x32_bf16 v[156:159], v[136:139], v[236:239], v[156:159]
    buffer_load_dwordx4 v[136:139], v10, s[40:43], s84 offen offset:0 sc1
    s_add_u32 s69, s66, 32256
    s_add_u32 s70, s66, 43008
    v_mfma_f32_16x16x32_bf16 v[160:163], v[140:143], v[240:243], v[144:147]
    s_add_u32 s71, s66, 53760
    v_mfma_f32_16x16x32_bf16 v[164:167], v[140:143], v[244:247], v[148:151]
    v_mfma_f32_16x16x32_bf16 v[168:171], v[140:143], v[248:251], v[152:155]
    v_mfma_f32_16x16x32_bf16 v[172:175], v[140:143], v[252:255], v[156:159]
    buffer_load_dwordx4 v[140:143], v10, s[40:43], s84 offen offset:1024 sc1
    s_waitcnt vmcnt(34)
    v_mfma_f32_16x16x32_bf16 v[144:147], v[16:19], a[0:3], 0
    v_mfma_f32_16x16x32_bf16 v[148:151], v[16:19], a[4:7], 0
    v_mfma_f32_16x16x32_bf16 v[152:155], v[16:19], a[8:11], 0
    v_mfma_f32_16x16x32_bf16 v[156:159], v[16:19], a[12:15], 0
    buffer_load_dwordx4 v[16:19], v10, s[40:43], s84 offen offset:2048 sc1
    v_mfma_f32_16x16x32_bf16 v[144:147], v[20:23], a[16:19], v[144:147]
    v_mfma_f32_16x16x32_bf16 v[148:151], v[20:23], a[20:23], v[148:151]
    v_mfma_f32_16x16x32_bf16 v[152:155], v[20:23], a[24:27], v[152:155]
    v_mfma_f32_16x16x32_bf16 v[156:159], v[20:23], a[28:31], v[156:159]
    buffer_load_dwordx4 v[20:23], v10, s[40:43], s84 offen offset:3072 sc1
    s_waitcnt vmcnt(32)
    v_mfma_f32_16x16x32_bf16 v[144:147], v[24:27], a[32:35], v[144:147]
    s_sub_u32 s14, s88, s87
    s_ashr_i32 s14, s14, 1
    v_mfma_f32_16x16x32_bf16 v[148:151], v[24:27], a[36:39], v[148:151]
    v_add_u32 v220, s14, v220
    v_mfma_f32_16x16x32_bf16 v[152:155], v[24:27], a[40:43], v[152:155]
    v_add_u32 v221, s14, v221
    v_mfma_f32_16x16x32_bf16 v[156:159], v[24:27], a[44:47], v[156:159]
    buffer_load_dwordx4 v[24:27], v11, s[40:43], s84 offen offset:0 sc1
    v_cvt_pk_bf16_f32 v192, v160, v161
    v_mfma_f32_16x16x32_bf16 v[144:147], v[28:31], a[48:51], v[144:147]
    v_cvt_pk_bf16_f32 v193, v162, v163
    v_mfma_f32_16x16x32_bf16 v[148:151], v[28:31], a[52:55], v[148:151]
    v_cvt_pk_bf16_f32 v194, v164, v165
    v_mfma_f32_16x16x32_bf16 v[152:155], v[28:31], a[56:59], v[152:155]
    v_cvt_pk_bf16_f32 v195, v166, v167
    v_mfma_f32_16x16x32_bf16 v[156:159], v[28:31], a[60:63], v[156:159]
    buffer_load_dwordx4 v[28:31], v11, s[40:43], s84 offen offset:1024 sc1
    v_permlane16_swap_b32 v192, v194
    s_waitcnt vmcnt(32)
    v_mfma_f32_16x16x32_bf16 v[144:147], v[32:35], a[64:67], v[144:147]
    v_mfma_f32_16x16x32_bf16 v[148:151], v[32:35], a[68:71], v[148:151]
    v_permlane16_swap_b32 v193, v195
    v_mfma_f32_16x16x32_bf16 v[152:155], v[32:35], a[72:75], v[152:155]
    v_cvt_pk_bf16_f32 v196, v168, v169
    v_mfma_f32_16x16x32_bf16 v[156:159], v[32:35], a[76:79], v[156:159]
    s_add_u32 m0, s13, 0
    s_add_u32 s15, s60, 0
    buffer_load_dwordx4 v2, s[40:43], s15 offen offset:0 lds
    v_cvt_pk_bf16_f32 v197, v170, v171
    v_mfma_f32_16x16x32_bf16 v[144:147], v[36:39], a[80:83], v[144:147]
    v_cvt_pk_bf16_f32 v198, v172, v173
    v_mfma_f32_16x16x32_bf16 v[148:151], v[36:39], a[84:87], v[148:151]
    v_cvt_pk_bf16_f32 v199, v174, v175
    v_mfma_f32_16x16x32_bf16 v[152:155], v[36:39], a[88:91], v[152:155]
    v_permlane16_swap_b32 v196, v198
    v_mfma_f32_16x16x32_bf16 v[156:159], v[36:39], a[92:95], v[156:159]
    s_add_u32 m0, s13, 0
    s_add_u32 s15, s60, 0
    buffer_load_dwordx4 v2, s[40:43], s15 offen offset:1024 lds
    v_permlane16_swap_b32 v197, v199
    s_waitcnt vmcnt(32)
    v_mfma_f32_16x16x32_bf16 v[144:147], v[40:43], a[96:99], v[144:147]
    v_mfma_f32_16x16x32_bf16 v[148:151], v[40:43], a[100:103], v[148:151]
    buffer_store_dwordx4 v[192:195], v5, s[40:43], s88 offen sc1
    v_mfma_f32_16x16x32_bf16 v[152:155], v[40:43], a[104:107], v[152:155]
    buffer_store_dwordx4 v[196:199], v6, s[40:43], s88 offen sc1
    v_mfma_f32_16x16x32_bf16 v[156:159], v[40:43], a[108:111], v[156:159]
    s_add_u32 m0, s13, 0
    s_add_u32 s15, s60, 0
    buffer_load_dwordx4 v2, s[40:43], s15 offen offset:2048 lds
    ds_write_b128 v220, v[192:195]
    v_mfma_f32_16x16x32_bf16 v[144:147], v[44:47], a[112:115], v[144:147]
    ds_write_b128 v221, v[196:199]
    v_mfma_f32_16x16x32_bf16 v[148:151], v[44:47], a[116:119], v[148:151]
    v_mfma_f32_16x16x32_bf16 v[152:155], v[44:47], a[120:123], v[152:155]
    v_mfma_f32_16x16x32_bf16 v[156:159], v[44:47], a[124:127], v[156:159]
    s_add_u32 m0, s13, 0
    s_add_u32 s15, s60, 0
    buffer_load_dwordx4 v2, s[40:43], s15 offen offset:3072 lds
    s_waitcnt vmcnt(34)
    v_mfma_f32_16x16x32_bf16 v[144:147], v[48:51], a[128:131], v[144:147]
    v_mfma_f32_16x16x32_bf16 v[148:151], v[48:51], a[132:135], v[148:151]
    v_mfma_f32_16x16x32_bf16 v[152:155], v[48:51], a[136:139], v[152:155]
    v_mfma_f32_16x16x32_bf16 v[156:159], v[48:51], a[140:143], v[156:159]
    s_add_u32 m0, s13, 4096
    s_add_u32 s15, s60, 4096
    buffer_load_dwordx4 v2, s[40:43], s15 offen offset:0 lds
    v_mfma_f32_16x16x32_bf16 v[144:147], v[52:55], a[144:147], v[144:147]
    v_mfma_f32_16x16x32_bf16 v[148:151], v[52:55], a[148:151], v[148:151]
    v_mfma_f32_16x16x32_bf16 v[152:155], v[52:55], a[152:155], v[152:155]
    v_mfma_f32_16x16x32_bf16 v[156:159], v[52:55], a[156:159], v[156:159]
    s_add_u32 m0, s13, 4096
    s_add_u32 s15, s60, 4096
    buffer_load_dwordx4 v2, s[40:43], s15 offen offset:1024 lds
    s_waitcnt vmcnt(34)
    v_mfma_f32_16x16x32_bf16 v[144:147], v[56:59], a[160:163], v[144:147]
    v_mfma_f32_16x16x32_bf16 v[148:151], v[56:59], a[164:167], v[148:151]
    v_mfma_f32_16x16x32_bf16 v[152:155], v[56:59], a[168:171], v[152:155]
    v_mfma_f32_16x16x32_bf16 v[156:159], v[56:59], a[172:175], v[156:159]
    s_add_u32 m0, s13, 4096
    s_add_u32 s15, s60, 4096
    buffer_load_dwordx4 v2, s[40:43], s15 offen offset:2048 lds
    v_mfma_f32_16x16x32_bf16 v[144:147], v[60:63], a[176:179], v[144:147]
    v_mfma_f32_16x16x32_bf16 v[148:151], v[60:63], a[180:183], v[148:151]
    v_mfma_f32_16x16x32_bf16 v[152:155], v[60:63], a[184:187], v[152:155]
    v_mfma_f32_16x16x32_bf16 v[156:159], v[60:63], a[188:191], v[156:159]
    s_add_u32 m0, s13, 4096
    s_add_u32 s15, s60, 4096
    buffer_load_dwordx4 v2, s[40:43], s15 offen offset:3072 lds
    s_waitcnt vmcnt(34)
    v_mfma_f32_16x16x32_bf16 v[144:147], v[64:67], a[192:195], v[144:147]
    v_mfma_f32_16x16x32_bf16 v[148:151], v[64:67], a[196:199], v[148:151]
    v_mfma_f32_16x16x32_bf16 v[152:155], v[64:67], a[200:203], v[152:155]
    v_mfma_f32_16x16x32_bf16 v[156:159], v[64:67], a[204:207], v[156:159]
    s_add_u32 m0, s13, 8192
    s_add_u32 s15, s60, 8192
    buffer_load_dwordx4 v2, s[40:43], s15 offen offset:0 lds
    v_mfma_f32_16x16x32_bf16 v[144:147], v[68:71], a[208:211], v[144:147]
    v_mfma_f32_16x16x32_bf16 v[148:151], v[68:71], a[212:215], v[148:151]
    v_mfma_f32_16x16x32_bf16 v[152:155], v[68:71], a[216:219], v[152:155]
    v_mfma_f32_16x16x32_bf16 v[156:159], v[68:71], a[220:223], v[156:159]
    s_add_u32 m0, s13, 8192
    s_add_u32 s15, s60, 8192
    buffer_load_dwordx4 v2, s[40:43], s15 offen offset:1024 lds
    s_waitcnt vmcnt(34)
    v_mfma_f32_16x16x32_bf16 v[144:147], v[72:75], a[224:227], v[144:147]
    v_mfma_f32_16x16x32_bf16 v[148:151], v[72:75], a[228:231], v[148:151]
    v_mfma_f32_16x16x32_bf16 v[152:155], v[72:75], a[232:235], v[152:155]
    v_mfma_f32_16x16x32_bf16 v[156:159], v[72:75], a[236:239], v[156:159]
    s_add_u32 m0, s13, 8192
    s_add_u32 s15, s60, 8192
    buffer_load_dwordx4 v2, s[40:43], s15 offen offset:2048 lds
    v_mfma_f32_16x16x32_bf16 v[144:147], v[76:79], a[240:243], v[144:147]
    v_mfma_f32_16x16x32_bf16 v[148:151], v[76:79], a[244:247], v[148:151]
    v_mfma_f32_16x16x32_bf16 v[152:155], v[76:79], a[248:251], v[152:155]
    v_mfma_f32_16x16x32_bf16 v[156:159], v[76:79], a[252:255], v[156:159]
    s_add_u32 m0, s13, 8192
    s_add_u32 s15, s60, 8192
    buffer_load_dwordx4 v2, s[40:43], s15 offen offset:3072 lds
    s_waitcnt vmcnt(34)
    v_mfma_f32_16x16x32_bf16 v[144:147], v[80:83], v[224:227], v[144:147]
    v_mfma_f32_16x16x32_bf16 v[148:151], v[80:83], v[228:231], v[148:151]
    v_mfma_f32_16x16x32_bf16 v[152:155], v[80:83], v[232:235], v[152:155]
    v_mfma_f32_16x16x32_bf16 v[156:159], v[80:83], v[236:239], v[156:159]
    s_lshl_b32 s12, s4, 2
    s_add_u32 s12, s12, s3
    s_mul_i32 s12, s12, 64512
    v_add_u32 v9, s12, v2
    v_add_u32 v10, 3072, v9
    v_add_u32 v11, 6144, v9
    s_add_u32 s12, s12, 9216
    v_lshlrev_b32 v12, 28, v4
    v_and_b32 v12, 0x80000000, v12
    v_lshl_add_u32 v12, v4, 4, v12
    v_lshl_add_u32 v12, v3, 7, v12
    v_add_u32 v12, s12, v12
    v_mfma_f32_16x16x32_bf16 v[160:163], v[84:87], v[240:243], v[144:147]
    v_mfma_f32_16x16x32_bf16 v[164:167], v[84:87], v[244:247], v[148:151]
    v_mfma_f32_16x16x32_bf16 v[168:171], v[84:87], v[248:251], v[152:155]
    v_mfma_f32_16x16x32_bf16 v[172:175], v[84:87], v[252:255], v[156:159]
    s_waitcnt lgkmcnt(0)
    s_waitcnt vmcnt(10)
    s_atomic_add s27, s[20:21], s22
    v_mfma_f32_16x16x32_bf16 v[144:147], v[88:91], a[0:3], 0
    v_mfma_f32_16x16x32_bf16 v[148:151], v[88:91], a[4:7], 0
    v_mfma_f32_16x16x32_bf16 v[152:155], v[88:91], a[8:11], 0
    v_mfma_f32_16x16x32_bf16 v[156:159], v[88:91], a[12:15], 0
    v_mfma_f32_16x16x32_bf16 v[144:147], v[92:95], a[16:19], v[144:147]
    v_mfma_f32_16x16x32_bf16 v[148:151], v[92:95], a[20:23], v[148:151]
    v_mfma_f32_16x16x32_bf16 v[152:155], v[92:95], a[24:27], v[152:155]
    v_mfma_f32_16x16x32_bf16 v[156:159], v[92:95], a[28:31], v[156:159]
    buffer_load_dwordx4 a[0:3], v9, s[40:43], s66 offen offset:0
    v_mfma_f32_16x16x32_bf16 v[144:147], v[96:99], a[32:35], v[144:147]
    s_sub_u32 s14, s89, s88
    s_ashr_i32 s14, s14, 1
    v_mfma_f32_16x16x32_bf16 v[148:151], v[96:99], a[36:39], v[148:151]
    v_add_u32 v220, s14, v220
    v_mfma_f32_16x16x32_bf16 v[152:155], v[96:99], a[40:43], v[152:155]
    v_add_u32 v221, s14, v221
    v_mfma_f32_16x16x32_bf16 v[156:159], v[96:99], a[44:47], v[156:159]
    v_cvt_pk_bf16_f32 v200, v160, v161
    v_mfma_f32_16x16x32_bf16 v[144:147], v[100:103], a[48:51], v[144:147]
    v_cvt_pk_bf16_f32 v201, v162, v163
    v_mfma_f32_16x16x32_bf16 v[148:151], v[100:103], a[52:55], v[148:151]
    v_cvt_pk_bf16_f32 v202, v164, v165
    v_mfma_f32_16x16x32_bf16 v[152:155], v[100:103], a[56:59], v[152:155]
    v_cvt_pk_bf16_f32 v203, v166, v167
    v_mfma_f32_16x16x32_bf16 v[156:159], v[100:103], a[60:63], v[156:159]
    buffer_load_dwordx4 a[4:7], v9, s[40:43], s66 offen offset:1024
    v_permlane16_swap_b32 v200, v202
    v_mfma_f32_16x16x32_bf16 v[144:147], v[104:107], a[64:67], v[144:147]
    v_mfma_f32_16x16x32_bf16 v[148:151], v[104:107], a[68:71], v[148:151]
    v_permlane16_swap_b32 v201, v203
    v_mfma_f32_16x16x32_bf16 v[152:155], v[104:107], a[72:75], v[152:155]
    v_cvt_pk_bf16_f32 v204, v168, v169
    v_mfma_f32_16x16x32_bf16 v[156:159], v[104:107], a[76:79], v[156:159]
    v_cvt_pk_bf16_f32 v205, v170, v171
    v_mfma_f32_16x16x32_bf16 v[144:147], v[108:111], a[80:83], v[144:147]
    v_cvt_pk_bf16_f32 v206, v172, v173
    v_mfma_f32_16x16x32_bf16 v[148:151], v[108:111], a[84:87], v[148:151]
    v_cvt_pk_bf16_f32 v207, v174, v175
    v_mfma_f32_16x16x32_bf16 v[152:155], v[108:111], a[88:91], v[152:155]
    v_permlane16_swap_b32 v204, v206
    v_mfma_f32_16x16x32_bf16 v[156:159], v[108:111], a[92:95], v[156:159]
    buffer_load_dwordx4 a[8:11], v9, s[40:43], s66 offen offset:2048
    v_permlane16_swap_b32 v205, v207
    v_mfma_f32_16x16x32_bf16 v[144:147], v[112:115], a[96:99], v[144:147]
    v_mfma_f32_16x16x32_bf16 v[148:151], v[112:115], a[100:103], v[148:151]
    buffer_store_dwordx4 v[200:203], v5, s[40:43], s89 offen sc1
    v_mfma_f32_16x16x32_bf16 v[152:155], v[112:115], a[104:107], v[152:155]
    buffer_store_dwordx4 v[204:207], v6, s[40:43], s89 offen sc1
    v_mfma_f32_16x16x32_bf16 v[156:159], v[112:115], a[108:111], v[156:159]
    ds_write_b128 v220, v[200:203]
    v_mfma_f32_16x16x32_bf16 v[144:147], v[116:119], a[112:115], v[144:147]
    ds_write_b128 v221, v[204:207]
    v_mfma_f32_16x16x32_bf16 v[148:151], v[116:119], a[116:119], v[148:151]
    v_mfma_f32_16x16x32_bf16 v[152:155], v[116:119], a[120:123], v[152:155]
    v_mfma_f32_16x16x32_bf16 v[156:159], v[116:119], a[124:127], v[156:159]
    buffer_load_dwordx4 a[12:15], v12, s[40:43], s66 offen offset:0
    v_mfma_f32_16x16x32_bf16 v[144:147], v[120:123], a[128:131], v[144:147]
    v_mfma_f32_16x16x32_bf16 v[148:151], v[120:123], a[132:135], v[148:151]
    v_mfma_f32_16x16x32_bf16 v[152:155], v[120:123], a[136:139], v[152:155]
    v_mfma_f32_16x16x32_bf16 v[156:159], v[120:123], a[140:143], v[156:159]
    v_mfma_f32_16x16x32_bf16 v[144:147], v[124:127], a[144:147], v[144:147]
    v_mfma_f32_16x16x32_bf16 v[148:151], v[124:127], a[148:151], v[148:151]
    v_mfma_f32_16x16x32_bf16 v[152:155], v[124:127], a[152:155], v[152:155]
    v_mfma_f32_16x16x32_bf16 v[156:159], v[124:127], a[156:159], v[156:159]
    buffer_load_dwordx4 a[16:19], v10, s[40:43], s66 offen offset:0
    v_mfma_f32_16x16x32_bf16 v[144:147], v[128:131], a[160:163], v[144:147]
    v_mfma_f32_16x16x32_bf16 v[148:151], v[128:131], a[164:167], v[148:151]
    v_mfma_f32_16x16x32_bf16 v[152:155], v[128:131], a[168:171], v[152:155]
    v_mfma_f32_16x16x32_bf16 v[156:159], v[128:131], a[172:175], v[156:159]
    v_mfma_f32_16x16x32_bf16 v[144:147], v[132:135], a[176:179], v[144:147]
    v_mfma_f32_16x16x32_bf16 v[148:151], v[132:135], a[180:183], v[148:151]
    v_mfma_f32_16x16x32_bf16 v[152:155], v[132:135], a[184:187], v[152:155]
    v_mfma_f32_16x16x32_bf16 v[156:159], v[132:135], a[188:191], v[156:159]
    buffer_load_dwordx4 a[20:23], v10, s[40:43], s66 offen offset:1024
    v_mfma_f32_16x16x32_bf16 v[144:147], v[136:139], a[192:195], v[144:147]
    v_mfma_f32_16x16x32_bf16 v[148:151], v[136:139], a[196:199], v[148:151]
    v_mfma_f32_16x16x32_bf16 v[152:155], v[136:139], a[200:203], v[152:155]
    v_mfma_f32_16x16x32_bf16 v[156:159], v[136:139], a[204:207], v[156:159]
    v_mfma_f32_16x16x32_bf16 v[144:147], v[140:143], a[208:211], v[144:147]
    v_mfma_f32_16x16x32_bf16 v[148:151], v[140:143], a[212:215], v[148:151]
    v_mfma_f32_16x16x32_bf16 v[152:155], v[140:143], a[216:219], v[152:155]
    v_mfma_f32_16x16x32_bf16 v[156:159], v[140:143], a[220:223], v[156:159]
    buffer_load_dwordx4 a[24:27], v10, s[40:43], s66 offen offset:2048
    v_mfma_f32_16x16x32_bf16 v[144:147], v[16:19], a[224:227], v[144:147]
    v_mfma_f32_16x16x32_bf16 v[148:151], v[16:19], a[228:231], v[148:151]
    v_mfma_f32_16x16x32_bf16 v[152:155], v[16:19], a[232:235], v[152:155]
    v_mfma_f32_16x16x32_bf16 v[156:159], v[16:19], a[236:239], v[156:159]
    v_mfma_f32_16x16x32_bf16 v[144:147], v[20:23], a[240:243], v[144:147]
    v_mfma_f32_16x16x32_bf16 v[148:151], v[20:23], a[244:247], v[148:151]
    v_mfma_f32_16x16x32_bf16 v[152:155], v[20:23], a[248:251], v[152:155]
    v_mfma_f32_16x16x32_bf16 v[156:159], v[20:23], a[252:255], v[156:159]
    buffer_load_dwordx4 a[28:31], v12, s[40:43], s66 offen offset:512
    v_mfma_f32_16x16x32_bf16 v[144:147], v[24:27], v[224:227], v[144:147]
    v_mfma_f32_16x16x32_bf16 v[148:151], v[24:27], v[228:231], v[148:151]
    v_mfma_f32_16x16x32_bf16 v[152:155], v[24:27], v[232:235], v[152:155]
    v_mfma_f32_16x16x32_bf16 v[156:159], v[24:27], v[236:239], v[156:159]
    v_mfma_f32_16x16x32_bf16 v[160:163], v[28:31], v[240:243], v[144:147]
    v_mfma_f32_16x16x32_bf16 v[164:167], v[28:31], v[244:247], v[148:151]
    v_mfma_f32_16x16x32_bf16 v[168:171], v[28:31], v[248:251], v[152:155]
    v_mfma_f32_16x16x32_bf16 v[172:175], v[28:31], v[252:255], v[156:159]
    buffer_load_dwordx4 a[32:35], v11, s[40:43], s66 offen offset:0
    s_sub_u32 s14, s90, s89
    s_ashr_i32 s14, s14, 1
    v_add_u32 v220, s14, v220
    v_add_u32 v221, s14, v221
    v_cvt_pk_bf16_f32 v208, v160, v161
    v_cvt_pk_bf16_f32 v209, v162, v163
    v_cvt_pk_bf16_f32 v210, v164, v165
    v_cvt_pk_bf16_f32 v211, v166, v167
    s_nop 0
    v_permlane16_swap_b32 v208, v210
    v_permlane16_swap_b32 v209, v211
    v_cvt_pk_bf16_f32 v212, v168, v169
    v_cvt_pk_bf16_f32 v213, v170, v171
    v_cvt_pk_bf16_f32 v214, v172, v173
    v_cvt_pk_bf16_f32 v215, v174, v175
    s_nop 0
    v_permlane16_swap_b32 v212, v214
    v_permlane16_swap_b32 v213, v215
    buffer_store_dwordx4 v[208:211], v5, s[40:43], s90 offen sc1
    buffer_store_dwordx4 v[212:215], v6, s[40:43], s90 offen sc1
    ds_write_b128 v220, v[208:211]
    ds_write_b128 v221, v[212:215]
    s_mov_b32 s16, 0
    s_atomic_add s16, s[20:21], s22 glc
    s_mov_b32 s36, s28
    s_mov_b32 s37, s29
    s_mov_b32 s38, 0x480
    s_mov_b32 s39, 0x20000
    s_mul_i32 s56, s3, 288
    buffer_load_dwordx2 v[156:157], v182, s[40:43], s52 offen offset:0 sc1
    buffer_load_dwordx2 v[166:167], v184, s[36:39], s56 offen offset:0
    buffer_load_dwordx2 v[158:159], v182, s[40:43], s52 offen offset:1024 sc1
    buffer_load_dwordx2 v[168:169], v184, s[36:39], s56 offen offset:64
    buffer_load_dwordx2 v[160:161], v182, s[40:43], s52 offen offset:2048 sc1
    buffer_load_dwordx2 v[170:171], v184, s[36:39], s56 offen offset:128
    buffer_load_dwordx2 v[162:163], v182, s[40:43], s52 offen offset:3072 sc1
    buffer_load_dwordx2 v[172:173], v184, s[36:39], s56 offen offset:192
    buffer_load_dwordx2 v[164:165], v182, s[40:43], s53 offen offset:0 sc1
    buffer_load_dwordx2 v[174:175], v184, s[36:39], s56 offen offset:256
    v_and_b32 v189, 1, v4
    v_lshlrev_b32 v189, 4, v189
    v_mov_b32 v190, 0x3f80
    v_lshlrev_b32 v189, v189, v190
    v_lshrrev_b32 v190, 1, v4
    v_cmp_eq_u32 vcc, 0, v190
    s_nop 1
    v_cndmask_b32 v148, 0, v189, vcc
    v_cmp_eq_u32 vcc, 1, v190
    s_nop 1
    v_cndmask_b32 v149, 0, v189, vcc
    v_cmp_eq_u32 vcc, 2, v190
    s_nop 1
    v_cndmask_b32 v150, 0, v189, vcc
    v_cmp_eq_u32 vcc, 3, v190
    s_nop 1
    v_cndmask_b32 v151, 0, v189, vcc
    v_cmp_eq_u32 vcc, 4, v190
    s_nop 1
    v_cndmask_b32 v152, 0, v189, vcc
    v_cmp_eq_u32 vcc, 5, v190
    s_nop 1
    v_cndmask_b32 v153, 0, v189, vcc
    v_cmp_eq_u32 vcc, 6, v190
    s_nop 1
    v_cndmask_b32 v154, 0, v189, vcc
    v_cmp_eq_u32 vcc, 7, v190
    s_nop 1
    v_cndmask_b32 v155, 0, v189, vcc
    ds_read_b64 v[224:225], v218 offset:4096
    ds_read_b64 v[226:227], v218 offset:4608
    ds_read_b64 v[228:229], v218 offset:5120
    ds_read_b64 v[230:231], v218 offset:5632
    ds_read_b64 v[232:233], v218 offset:6144
    v_lshlrev_b32 v190, 5, v176
    s_lshl_b32 s7, s3, 3
    v_add_u32 v191, s7, v190
    s_mov_b32 s18, 262144
    s_waitcnt lgkmcnt(0)
H4_l:
    s_cmp_ge_u32 s16, s46
    s_cbranch_scc1 H4_b
    s_sub_u32 s18, s18, 1
    s_cbranch_scc1 H4_b
    s_mov_b32 s16, 0
    s_atomic_add s16, s[20:21], s22 glc
    s_waitcnt lgkmcnt(0)
    s_branch H4_l
H4_b:
    s_add_u32 s46, s46, 8
    buffer_load_dwordx4 v[32:35], v179, s[40:43], s48 offen offset:0 sc1
    buffer_load_dwordx4 v[36:39], v219, s[40:43], s49 offen offset:0 sc1
    buffer_load_dwordx4 v[40:43], v179, s[40:43], s48 offen offset:512 sc1
    buffer_load_dwordx4 v[44:47], v219, s[40:43], s49 offen offset:512 sc1
    buffer_load_dwordx4 v[48:51], v179, s[40:43], s48 offen offset:1024 sc1
    buffer_load_dwordx4 v[52:55], v219, s[40:43], s49 offen offset:1024 sc1
    s_waitcnt vmcnt(16)
    s_waitcnt lgkmcnt(0)
    s_mov_b32 s16, 1
    s_atomic_add s16, s[20:21], s22 glc
    buffer_load_dwordx4 v[56:59], v179, s[40:43], s48 offen offset:1536 sc1
    buffer_load_dwordx4 v[60:63], v219, s[40:43], s49 offen offset:1536 sc1
    buffer_load_dwordx4 v[64:67], v179, s[40:43], s48 offen offset:2048 sc1
    buffer_load_dwordx4 v[68:71], v219, s[40:43], s49 offen offset:2048 sc1
    s_mov_b32 s17, 0
    s_atomic_add s17, s[20:21], s22 glc
    buffer_load_dwordx4 v[72:75], v179, s[40:43], s48 offen offset:2560 sc1
    buffer_load_dwordx4 v[76:79], v219, s[40:43], s49 offen offset:2560 sc1
    buffer_load_dwordx4 v[80:83], v179, s[40:43], s48 offen offset:3072 sc1
    buffer_load_dwordx4 v[84:87], v219, s[40:43], s49 offen offset:3072 sc1
    s_waitcnt vmcnt(14)
    v_and_b32 v164, v164, v188
    v_and_b32 v174, v174, v188
    v_and_b32 v165, v165, v188
    v_and_b32 v175, v175, v188
    v_lshlrev_b32 v108, 16, v156
    v_and_b32 v109, 0xffff0000, v156
    v_lshlrev_b32 v128, 16, v166
    v_and_b32 v129, 0xffff0000, v166
    v_lshlrev_b32 v110, 16, v157
    v_and_b32 v111, 0xffff0000, v157
    v_lshlrev_b32 v130, 16, v167
    v_and_b32 v131, 0xffff0000, v167
    v_lshlrev_b32 v112, 16, v158
    v_and_b32 v113, 0xffff0000, v158
    v_lshlrev_b32 v132, 16, v168
    v_and_b32 v133, 0xffff0000, v168
    v_lshlrev_b32 v114, 16, v159
    v_and_b32 v115, 0xffff0000, v159
    v_lshlrev_b32 v134, 16, v169
    v_and_b32 v135, 0xffff0000, v169
    v_lshlrev_b32 v116, 16, v160
    v_and_b32 v117, 0xffff0000, v160
    v_lshlrev_b32 v136, 16, v170
    v_and_b32 v137, 0xffff0000, v170
    v_lshlrev_b32 v118, 16, v161
    v_and_b32 v119, 0xffff0000, v161
    v_lshlrev_b32 v138, 16, v171
    v_and_b32 v139, 0xffff0000, v171
    v_lshlrev_b32 v120, 16, v162
    v_and_b32 v121, 0xffff0000, v162
    v_lshlrev_b32 v140, 16, v172
    v_and_b32 v141, 0xffff0000, v172
    v_lshlrev_b32 v122, 16, v163
    v_and_b32 v123, 0xffff0000, v163
    v_lshlrev_b32 v142, 16, v173
    v_and_b32 v143, 0xffff0000, v173
    v_lshlrev_b32 v124, 16, v164
    v_and_b32 v125, 0xffff0000, v164
    v_lshlrev_b32 v144, 16, v174
    v_and_b32 v145, 0xffff0000, v174
    v_lshlrev_b32 v126, 16, v165
    v_and_b32 v127, 0xffff0000, v165
    v_lshlrev_b32 v146, 16, v175
    v_and_b32 v147, 0xffff0000, v175
    v_and_b32 v232, v232, v188
    v_and_b32 v233, v233, v188
    v_lshlrev_b32 v234, 16, v224
    v_and_b32 v235, 0xffff0000, v224
    v_lshlrev_b32 v236, 16, v225
    v_and_b32 v237, 0xffff0000, v225
    v_lshlrev_b32 v238, 16, v226
    v_and_b32 v239, 0xffff0000, v226
    v_lshlrev_b32 v240, 16, v227
    v_and_b32 v241, 0xffff0000, v227
    v_lshlrev_b32 v242, 16, v228
    v_and_b32 v243, 0xffff0000, v228
    v_lshlrev_b32 v244, 16, v229
    v_and_b32 v245, 0xffff0000, v229
    v_lshlrev_b32 v246, 16, v230
    v_and_b32 v247, 0xffff0000, v230
    v_lshlrev_b32 v248, 16, v231
    v_and_b32 v249, 0xffff0000, v231
    v_lshlrev_b32 v250, 16, v232
    v_and_b32 v251, 0xffff0000, v232
    v_lshlrev_b32 v252, 16, v233
    v_and_b32 v253, 0xffff0000, v233
    v_pk_add_f32 v[128:129], v[128:129], v[234:235]
    v_pk_add_f32 v[130:131], v[130:131], v[236:237]
    v_pk_add_f32 v[132:133], v[132:133], v[238:239]
    v_pk_add_f32 v[134:135], v[134:135], v[240:241]
    v_pk_add_f32 v[136:137], v[136:137], v[242:243]
    v_pk_add_f32 v[138:139], v[138:139], v[244:245]
    v_pk_add_f32 v[140:141], v[140:141], v[246:247]
    v_pk_add_f32 v[142:143], v[142:143], v[248:249]
    v_pk_add_f32 v[144:145], v[144:145], v[250:251]
    v_pk_add_f32 v[146:147], v[146:147], v[252:253]
    s_mov_b32 s18, 262144
    s_waitcnt lgkmcnt(0)
    s_add_u32 s16, s16, 1
    s_max_u32 s16, s16, s17
H5_l:
    s_cmp_ge_u32 s16, s46
    s_cbranch_scc1 H5_b
    s_sub_u32 s18, s18, 1
    s_cbranch_scc1 H5_b
    s_mov_b32 s16, 0
    s_atomic_add s16, s[20:21], s22 glc
    s_waitcnt lgkmcnt(0)
    s_branch H5_l
H5_b:
    s_add_u32 s46, s46, 8
    buffer_load_dwordx4 v[16:19], v179, s[40:43], s48 offen offset:3584 sc1
    buffer_load_dwordx4 v[20:23], v219, s[40:43], s49 offen offset:3584 sc1
    buffer_load_dwordx4 v[24:27], v179, s[40:43], s50 offen offset:0 sc1
    buffer_load_dwordx4 v[28:31], v219, s[40:43], s51 offen offset:0 sc1
    s_waitcnt vmcnt(17)
    v_mfma_f32_16x16x32_bf16 v[88:91], v[148:151], v[32:35], v[128:131]
    s_waitcnt vmcnt(16)
    v_mfma_f32_16x16x32_bf16 v[88:91], v[148:151], v[36:39], v[88:91]
    s_waitcnt vmcnt(15)
    v_mfma_f32_16x16x32_bf16 v[88:91], v[152:155], v[40:43], v[88:91]
    s_waitcnt vmcnt(14)
    v_mfma_f32_16x16x32_bf16 v[88:91], v[152:155], v[44:47], v[88:91]
    s_waitcnt vmcnt(13)
    v_mfma_f32_16x16x32_bf16 v[92:95], v[148:151], v[48:51], v[132:135]
    s_waitcnt vmcnt(12)
    v_mfma_f32_16x16x32_bf16 v[92:95], v[148:151], v[52:55], v[92:95]
    s_waitcnt vmcnt(11)
    v_mfma_f32_16x16x32_bf16 v[92:95], v[152:155], v[56:59], v[92:95]
    s_waitcnt vmcnt(10)
    v_mfma_f32_16x16x32_bf16 v[92:95], v[152:155], v[60:63], v[92:95]
    s_waitcnt vmcnt(9)
    v_mfma_f32_16x16x32_bf16 v[96:99], v[148:151], v[64:67], v[136:139]
    s_waitcnt vmcnt(8)
    v_mfma_f32_16x16x32_bf16 v[96:99], v[148:151], v[68:71], v[96:99]
    s_waitcnt vmcnt(7)
    v_mfma_f32_16x16x32_bf16 v[96:99], v[152:155], v[72:75], v[96:99]
    s_waitcnt vmcnt(6)
    v_mfma_f32_16x16x32_bf16 v[96:99], v[152:155], v[76:79], v[96:99]
    s_waitcnt vmcnt(5)
    v_mfma_f32_16x16x32_bf16 v[100:103], v[148:151], v[80:83], v[140:143]
    s_waitcnt vmcnt(4)
    v_mfma_f32_16x16x32_bf16 v[100:103], v[148:151], v[84:87], v[100:103]
    s_waitcnt vmcnt(3)
    v_mfma_f32_16x16x32_bf16 v[100:103], v[152:155], v[16:19], v[100:103]
    s_waitcnt vmcnt(2)
    v_mfma_f32_16x16x32_bf16 v[100:103], v[152:155], v[20:23], v[100:103]
    s_waitcnt vmcnt(1)
    v_mfma_f32_16x16x32_bf16 v[104:107], v[148:151], v[24:27], v[144:147]
    s_waitcnt vmcnt(0)
    v_mfma_f32_16x16x32_bf16 v[104:107], v[148:151], v[28:31], v[104:107]
    v_cvt_pk_bf16_f32 v192, v88, v89
    v_cvt_pk_bf16_f32 v193, v90, v91
    v_cvt_pk_bf16_f32 v194, v92, v93
    v_cvt_pk_bf16_f32 v195, v94, v95
    v_cvt_pk_bf16_f32 v196, v96, v97
    v_cvt_pk_bf16_f32 v197, v98, v99
    v_cvt_pk_bf16_f32 v198, v100, v101
    v_cvt_pk_bf16_f32 v199, v102, v103
    v_cvt_pk_bf16_f32 v200, v104, v105
    v_cvt_pk_bf16_f32 v201, v106, v107
    v_lshlrev_b32 v88, 16, v192
    v_and_b32 v89, 0xffff0000, v192
    v_lshlrev_b32 v90, 16, v193
    v_and_b32 v91, 0xffff0000, v193
    v_lshlrev_b32 v92, 16, v194
    v_and_b32 v93, 0xffff0000, v194
    v_lshlrev_b32 v94, 16, v195
    v_and_b32 v95, 0xffff0000, v195
    v_lshlrev_b32 v96, 16, v196
    v_and_b32 v97, 0xffff0000, v196
    v_lshlrev_b32 v98, 16, v197
    v_and_b32 v99, 0xffff0000, v197
    v_lshlrev_b32 v100, 16, v198
    v_and_b32 v101, 0xffff0000, v198
    v_lshlrev_b32 v102, 16, v199
    v_and_b32 v103, 0xffff0000, v199
    v_lshlrev_b32 v104, 16, v200
    v_and_b32 v105, 0xffff0000, v200
    v_lshlrev_b32 v106, 16, v201
    v_and_b32 v107, 0xffff0000, v201
    v_pk_add_f32 v[88:89], v[88:89], v[108:109]
    v_pk_add_f32 v[90:91], v[90:91], v[110:111]
    v_pk_add_f32 v[92:93], v[92:93], v[112:113]
    v_pk_add_f32 v[94:95], v[94:95], v[114:115]
    v_pk_add_f32 v[96:97], v[96:97], v[116:117]
    v_pk_add_f32 v[98:99], v[98:99], v[118:119]
    v_pk_add_f32 v[100:101], v[100:101], v[120:121]
    v_pk_add_f32 v[102:103], v[102:103], v[122:123]
    v_pk_add_f32 v[104:105], v[104:105], v[124:125]
    v_pk_add_f32 v[106:107], v[106:107], v[126:127]
    v_cvt_pk_bf16_f32 v192, v88, v89
    v_cvt_pk_bf16_f32 v193, v90, v91
    v_cvt_pk_bf16_f32 v194, v92, v93
    v_cvt_pk_bf16_f32 v195, v94, v95
    v_cvt_pk_bf16_f32 v196, v96, v97
    v_cvt_pk_bf16_f32 v197, v98, v99
    v_cvt_pk_bf16_f32 v198, v100, v101
    v_cvt_pk_bf16_f32 v199, v102, v103
    v_cvt_pk_bf16_f32 v200, v104, v105
    v_cvt_pk_bf16_f32 v201, v106, v107
    v_lshlrev_b32 v88, 16, v192
    v_and_b32 v89, 0xffff0000, v192
    v_lshlrev_b32 v90, 16, v193
    v_and_b32 v91, 0xffff0000, v193
    v_lshlrev_b32 v92, 16, v194
    v_and_b32 v93, 0xffff0000, v194
    v_lshlrev_b32 v94, 16, v195
    v_and_b32 v95, 0xffff0000, v195
    v_lshlrev_b32 v96, 16, v196
    v_and_b32 v97, 0xffff0000, v196
    v_lshlrev_b32 v98, 16, v197
    v_and_b32 v99, 0xffff0000, v197
    v_lshlrev_b32 v100, 16, v198
    v_and_b32 v101, 0xffff0000, v198
    v_lshlrev_b32 v102, 16, v199
    v_and_b32 v103, 0xffff0000, v199
    v_lshlrev_b32 v104, 16, v200
    v_and_b32 v105, 0xffff0000, v200
    v_lshlrev_b32 v106, 16, v201
    v_and_b32 v107, 0xffff0000, v201
    v_permlane16_swap_b32 v192, v194
    v_permlane16_swap_b32 v193, v195
    v_permlane16_swap_b32 v196, v198
    v_permlane16_swap_b32 v197, v199
    v_permlane16_swap_b32 v200, v202
    v_permlane16_swap_b32 v201, v203
    s_cmp_eq_u32 s45, 0
    s_cbranch_scc1 R_mid
    s_mov_b32 s36, s30
    s_mov_b32 s37, s31
    s_mov_b32 s38, 0x240000
    s_mov_b32 s39, 0x20000
    s_lshl_b32 s6, s5, 3
    s_add_u32 s6, s6, s4
    s_mul_i32 s6, s6, 9216
    s_add_u32 s6, s6, s56
    buffer_store_dwordx4 v[192:195], v185, s[36:39], s6 offen offset:0
    buffer_store_dwordx4 v[196:199], v185, s[36:39], s6 offen offset:128
    buffer_store_dwordx4 v[200:203], v187, s[36:39], s6 offen offset:256
L_exit2:
    s_endpgm
R_mid:
    buffer_store_dwordx4 v[192:195], v183, s[40:43], s54 offen offset:0 sc1
    buffer_store_dwordx4 v[196:199], v183, s[40:43], s54 offen offset:2048 sc1
    buffer_store_dwordx4 v[200:203], v186, s[40:43], s54 offen offset:0 sc1
    v_pk_add_f32 v[108:109], v[88:89], v[90:91]
    v_pk_add_f32 v[110:111], v[92:93], v[94:95]
    v_pk_add_f32 v[108:109], v[108:109], v[96:97]
    v_pk_add_f32 v[110:111], v[110:111], v[98:99]
    v_pk_add_f32 v[108:109], v[108:109], v[100:101]
    v_pk_add_f32 v[110:111], v[110:111], v[102:103]
    v_pk_add_f32 v[108:109], v[108:109], v[104:105]
    v_pk_add_f32 v[110:111], v[110:111], v[106:107]
    v_pk_add_f32 v[108:109], v[108:109], v[110:111]
    v_add_f32 v108, v108, v109
    s_nop 1
    v_add_f32_dpp v108, v108, v108 row_ror:8 row_mask:0xf bank_mask:0xf
    v_mov_b32 v109, v108
    s_nop 1
    v_permlane16_swap_b32 v108, v109
    v_add_f32 v108, v108, v109
    v_mov_b32 v109, v108
    s_nop 1
    v_permlane32_swap_b32 v108, v109
    v_add_f32 v108, v108, v109
    v_mul_f32 v122, 0xbbe38e39, v108
    v_mov_b32 v123, v122
    v_and_b32 v124, v122, v188
    v_mov_b32 v125, v124
    v_pk_add_f32 v[128:129], v[88:89], v[122:123]
    v_pk_add_f32 v[130:131], v[90:91], v[122:123]
    v_pk_add_f32 v[132:133], v[92:93], v[122:123]
    v_pk_add_f32 v[134:135], v[94:95], v[122:123]
    v_pk_add_f32 v[136:137], v[96:97], v[122:123]
    v_pk_add_f32 v[138:139], v[98:99], v[122:123]
    v_pk_add_f32 v[140:141], v[100:101], v[122:123]
    v_pk_add_f32 v[142:143], v[102:103], v[122:123]
    v_pk_add_f32 v[144:145], v[104:105], v[124:125]
    v_pk_add_f32 v[146:147], v[106:107], v[124:125]
    v_pk_mul_f32 v[108:109], v[128:129], v[128:129]
    v_pk_mul_f32 v[110:111], v[130:131], v[130:131]
    v_pk_fma_f32 v[108:109], v[132:133], v[132:133], v[108:109]
    v_pk_fma_f32 v[110:111], v[134:135], v[134:135], v[110:111]
    v_pk_fma_f32 v[108:109], v[136:137], v[136:137], v[108:109]
    v_pk_fma_f32 v[110:111], v[138:139], v[138:139], v[110:111]
    v_pk_fma_f32 v[108:109], v[140:141], v[140:141], v[108:109]
    v_pk_fma_f32 v[110:111], v[142:143], v[142:143], v[110:111]
    v_pk_fma_f32 v[108:109], v[144:145], v[144:145], v[108:109]
    v_pk_fma_f32 v[110:111], v[146:147], v[146:147], v[110:111]
    v_pk_add_f32 v[108:109], v[108:109], v[110:111]
    v_add_f32 v123, v108, v109
    s_nop 1
    v_add_f32_dpp v123, v123, v123 row_ror:8 row_mask:0xf bank_mask:0xf
    v_mov_b32 v109, v123
    s_nop 1
    v_permlane16_swap_b32 v123, v109
    v_add_f32 v123, v123, v109
    v_mov_b32 v109, v123
    s_nop 1
    v_permlane32_swap_b32 v123, v109
    v_add_f32 v123, v123, v109
    ds_write_b64 v191, v[122:123]
    s_waitcnt lgkmcnt(0)
    s_barrier
    ds_read_b128 v[108:111], v190
    ds_read_b128 v[112:115], v190 offset:16
    s_waitcnt lgkmcnt(0)
    v_pk_add_f32 v[116:117], v[108:109], v[110:111]
    v_pk_add_f32 v[118:119], v[112:113], v[114:115]
    v_pk_add_f32 v[116:117], v[116:117], v[118:119]
    v_mul_f32 v116, 0xbe800000, v116
    v_mul_f32 v117, 0x3be38e39, v117
    v_add_f32 v108, v108, v116
    v_add_f32 v110, v110, v116
    v_add_f32 v112, v112, v116
    v_add_f32 v114, v114, v116
    v_fmac_f32 v117, v108, v108
    v_fmac_f32 v117, v110, v110
    v_fmac_f32 v117, v112, v112
    v_fmac_f32 v117, v114, v114
    v_mul_f32 v117, 0x3e800000, v117
    v_cvt_pk_bf16_f32 v118, v117, v116
    v_lshlrev_b32 v120, 16, v118
    v_and_b32 v118, 0xffff0000, v118
    v_add_f32 v120, 0x3727c5ac, v120
    v_cvt_pk_bf16_f32 v120, v120, v120
    v_and_b32 v120, 0xffff0000, v120
    v_sqrt_f32 v120, v120
    s_nop 0
    v_cvt_pk_bf16_f32 v120, v120, v120
    v_and_b32 v120, 0xffff0000, v120
    v_rcp_f32 v120, v120
    v_sub_f32 v118, 0, v118
    v_mov_b32 v119, v118
    v_mov_b32 v121, v120
    v_pk_add_f32 v[88:89], v[88:89], v[118:119]
    v_pk_add_f32 v[90:91], v[90:91], v[118:119]
    v_pk_add_f32 v[92:93], v[92:93], v[118:119]
    v_pk_add_f32 v[94:95], v[94:95], v[118:119]
    v_pk_add_f32 v[96:97], v[96:97], v[118:119]
    v_pk_add_f32 v[98:99], v[98:99], v[118:119]
    v_pk_add_f32 v[100:101], v[100:101], v[118:119]
    v_pk_add_f32 v[102:103], v[102:103], v[118:119]
    v_pk_add_f32 v[104:105], v[104:105], v[118:119]
    v_pk_add_f32 v[106:107], v[106:107], v[118:119]
    v_cvt_pk_bf16_f32 v204, v88, v89
    v_cvt_pk_bf16_f32 v205, v90, v91
    v_cvt_pk_bf16_f32 v206, v92, v93
    v_cvt_pk_bf16_f32 v207, v94, v95
    v_cvt_pk_bf16_f32 v208, v96, v97
    v_cvt_pk_bf16_f32 v209, v98, v99
    v_cvt_pk_bf16_f32 v210, v100, v101
    v_cvt_pk_bf16_f32 v211, v102, v103
    v_cvt_pk_bf16_f32 v212, v104, v105
    v_cvt_pk_bf16_f32 v213, v106, v107
    v_lshlrev_b32 v88, 16, v204
    v_and_b32 v89, 0xffff0000, v204
    v_lshlrev_b32 v90, 16, v205
    v_and_b32 v91, 0xffff0000, v205
    v_lshlrev_b32 v92, 16, v206
    v_and_b32 v93, 0xffff0000, v206
    v_lshlrev_b32 v94, 16, v207
    v_and_b32 v95, 0xffff0000, v207
    v_lshlrev_b32 v96, 16, v208
    v_and_b32 v97, 0xffff0000, v208
    v_lshlrev_b32 v98, 16, v209
    v_and_b32 v99, 0xffff0000, v209
    v_lshlrev_b32 v100, 16, v210
    v_and_b32 v101, 0xffff0000, v210
    v_lshlrev_b32 v102, 16, v211
    v_and_b32 v103, 0xffff0000, v211
    v_lshlrev_b32 v104, 16, v212
    v_and_b32 v105, 0xffff0000, v212
    v_lshlrev_b32 v106, 16, v213
    v_and_b32 v107, 0xffff0000, v213
    v_pk_mul_f32 v[88:89], v[88:89], v[120:121]
    v_pk_mul_f32 v[90:91], v[90:91], v[120:121]
    v_pk_mul_f32 v[92:93], v[92:93], v[120:121]
    v_pk_mul_f32 v[94:95], v[94:95], v[120:121]
    v_pk_mul_f32 v[96:97], v[96:97], v[120:121]
    v_pk_mul_f32 v[98:99], v[98:99], v[120:121]
    v_pk_mul_f32 v[100:101], v[100:101], v[120:121]
    v_pk_mul_f32 v[102:103], v[102:103], v[120:121]
    v_pk_mul_f32 v[104:105], v[104:105], v[120:121]
    v_pk_mul_f32 v[106:107], v[106:107], v[120:121]
    v_cvt_pk_bf16_f32 v204, v88, v89
    v_cvt_pk_bf16_f32 v205, v90, v91
    v_cvt_pk_bf16_f32 v206, v92, v93
    v_cvt_pk_bf16_f32 v207, v94, v95
    v_cvt_pk_bf16_f32 v208, v96, v97
    v_cvt_pk_bf16_f32 v209, v98, v99
    v_cvt_pk_bf16_f32 v210, v100, v101
    v_cvt_pk_bf16_f32 v211, v102, v103
    v_cvt_pk_bf16_f32 v212, v104, v105
    v_cvt_pk_bf16_f32 v213, v106, v107
    v_permlane16_swap_b32 v204, v206
    v_permlane16_swap_b32 v205, v207
    v_permlane16_swap_b32 v208, v210
    v_permlane16_swap_b32 v209, v211
    v_permlane16_swap_b32 v212, v214
    v_permlane16_swap_b32 v213, v215
    buffer_store_dwordx4 v[204:207], v183, s[40:43], s55 offen offset:0 sc1
    buffer_store_dwordx4 v[208:211], v183, s[40:43], s55 offen offset:2048 sc1
    buffer_store_dwordx4 v[212:215], v186, s[40:43], s55 offen offset:0 sc1
    s_lshr_b32 s6, s4, 1
    s_lshl_b32 s7, s5, 2
    s_add_u32 s6, s6, s7
    s_mul_i32 s6, s6, 128
    s_add_u32 s19, s6, 16384
    s_add_u32 s23, s22, 16384
    s_max_u32 s7, s7, 1
    s_mul_i32 s7, s7, 128
    s_add_u32 s26, s7, 16256
    buffer_load_dwordx4 a[36:39], v11, s[40:43], s66 offen offset:1024
    buffer_load_dwordx4 a[40:43], v11, s[40:43], s66 offen offset:2048
    buffer_load_dwordx4 a[44:47], v12, s[40:43], s66 offen offset:1024
    buffer_load_dwordx4 a[48:51], v9, s[40:43], s67 offen offset:0
    buffer_load_dwordx4 a[52:55], v9, s[40:43], s67 offen offset:1024
    buffer_load_dwordx4 a[56:59], v9, s[40:43], s67 offen offset:2048
    buffer_load_dwordx4 a[60:63], v12, s[40:43], s67 offen offset:0
    buffer_load_dwordx4 a[64:67], v10, s[40:43], s67 offen offset:0
    buffer_load_dwordx4 a[68:71], v10, s[40:43], s67 offen offset:1024
    buffer_load_dwordx4 a[72:75], v10, s[40:43], s67 offen offset:2048
    s_waitcnt vmcnt(10)
    s_atomic_add s27, s[20:21], s19
    buffer_load_dwordx4 a[76:79], v12, s[40:43], s67 offen offset:512
    buffer_load_dwordx4 a[80:83], v11, s[40:43], s67 offen offset:0
    buffer_load_dwordx4 a[84:87], v11, s[40:43], s67 offen offset:1024
    buffer_load_dwordx4 a[88:91], v11, s[40:43], s67 offen offset:2048
    buffer_load_dwordx4 a[92:95], v12, s[40:43], s67 offen offset:1024
    buffer_load_dwordx4 a[96:99], v9, s[40:43], s68 offen offset:0
    buffer_load_dwordx4 a[100:103], v9, s[40:43], s68 offen offset:1024
    buffer_load_dwordx4 a[104:107], v9, s[40:43], s68 offen offset:2048
    buffer_load_dwordx4 a[108:111], v12, s[40:43], s68 offen offset:0
    buffer_load_dwordx4 a[112:115], v10, s[40:43], s68 offen offset:0
    buffer_load_dwordx4 a[116:119], v10, s[40:43], s68 offen offset:1024
    buffer_load_dwordx4 a[120:123], v10, s[40:43], s68 offen offset:2048
    buffer_load_dwordx4 a[124:127], v12, s[40:43], s68 offen offset:512
    buffer_load_dwordx4 a[128:131], v11, s[40:43], s68 offen offset:0
    buffer_load_dwordx4 a[132:135], v11, s[40:43], s68 offen offset:1024
    buffer_load_dwordx4 a[136:139], v11, s[40:43], s68 offen offset:2048
    buffer_load_dwordx4 a[140:143], v12, s[40:43], s68 offen offset:1024
    s_mov_b32 s16, 0
    s_atomic_add s16, s[20:21], s23 glc
    s_mov_b32 s17, 0
    s_atomic_add s17, s[20:21], s26 glc
    s_add_u32 s44, s44, 0x1b20000
    s_mov_b32 s45, 1
    s_add_u32 s32, s24, 0x2cc5000
    s_addc_u32 s33, s25, 0
    s_mov_b32 s6, 0
    s_mul_i32 s48, s6, 3072
    s_add_u32 s48, s48, s44
    s_mul_i32 s54, s6, 10752
    s_add_u32 s6, s6, 1
    s_cmp_eq_u32 s6, 6
    s_cselect_b32 s6, 0, s6
    s_mul_i32 s49, s6, 3072
    s_add_u32 s49, s49, s44
    s_mul_i32 s55, s6, 10752
    s_add_u32 s6, s6, 1
    s_cmp_eq_u32 s6, 6
    s_cselect_b32 s6, 0, s6
    s_mul_i32 s50, s6, 3072
    s_add_u32 s50, s50, s44
    s_mul_i32 s56, s6, 10752
    s_add_u32 s6, s6, 1
    s_cmp_eq_u32 s6, 6
    s_cselect_b32 s6, 0, s6
    s_mul_i32 s51, s6, 3072
    s_add_u32 s51, s51, s44
    s_mul_i32 s57, s6, 10752
    s_add_u32 s6, s6, 1
    s_cmp_eq_u32 s6, 6
    s_cselect_b32 s6, 0, s6
    s_mul_i32 s52, s6, 3072
    s_add_u32 s52, s52, s44
    s_mul_i32 s58, s6, 10752
    s_add_u32 s6, s6, 1
    s_cmp_eq_u32 s6, 6
    s_cselect_b32 s6, 0, s6
    s_mul_i32 s53, s6, 3072
    s_add_u32 s53, s53, s44
    s_mul_i32 s59, s6, 10752
    s_mul_i32 s8, s3, 18432
    s_add_u32 s8, s8, s47
    v_add_u32 v7, s8, v2
    s_min_u32 s9, s3, 2
    s_lshl_b32 s11, s9, 10
    s_add_u32 s8, s47, s11
    s_sub_u32 s8, s8, 18432
    s_cmp_eq_u32 s5, 0
    s_cselect_b32 s8, 0x80000000, s8
    v_add_u32 v8, s8, v2
    s_add_u32 s11, s11, 20480
    s_mul_i32 s10, s3, 18432
    s_add_u32 s10, s10, 38912
    v_add_u32 v5, 20480, v2
    v_add_u32 v6, 66560, v2
    s_mul_i32 s62, s3, 18432
    s_add_u32 s62, s62, s47
    s_add_u32 s62, s62, s44
    s_mul_i32 s63, s4, 2304
    s_add_u32 s63, s63, s62
    v_and_b32 v220, 1, v3
    v_lshlrev_b32 v220, 9, v220
    v_lshl_add_u32 v220, v4, 4, v220
    v_lshrrev_b32 v221, 5, v1
    v_lshl_add_u32 v220, v221, 8, v220
    v_mov_b32 v221, 0x80000000
    v_cmp_eq_u32 vcc, 0, v3
    s_nop 1
    v_cndmask_b32 v221, v221, v220, vcc
    v_cndmask_b32 v222, 0, -1, vcc
    s_add_u32 s65, s63, 0x6c0000
    s_sub_u32 s64, s63, s44
    s_mul_i32 s6, s4, 144
    s_sub_u32 s7, s62, s44
    s_add_u32 s6, s6, s7
    v_lshrrev_b32 v206, 4, v220
    v_and_b32 v206, 0x30, v206
    v_mad_u32_u24 v206, v4, s97, v206
    s_cmp_eq_u32 s45, 0
    s_cselect_b32 s64, s6, s64
    s_cselect_b32 s6, 64, 1024
    s_cselect_b64 s[8:9], -1, 0
    v_cndmask_b32 v206, v220, v206, s[8:9]
    v_add_u32 v207, s6, v206
    v_add_u32 v223, s6, v207
    v_cndmask_b32 v223, v221, v223, vcc
    v_and_b32 v13, 1, v4
    v_cmp_eq_u32 s[70:71], 1, v13
    v_lshl_add_u32 v14, v3, 2, v13
    v_cmp_ge_u32 s[72:73], v4, v14
    v_add_u32 v14, 2, v14
    v_cmp_ge_u32 s[74:75], v4, v14
    v_mov_b32 v13, 0xffff
    v_mov_b32 v14, 0xffff0000
    v_cndmask_b32 v13, v13, v14, s[70:71]
    v_cndmask_b32 v132, v13, 0, s[72:73]
    v_cndmask_b32 v133, v13, 0, s[74:75]
    v_cndmask_b32 v134, 0, v13, s[72:73]
    v_cndmask_b32 v135, 0, v13, s[74:75]
    s_cmp_eq_u32 s5, 0
    s_cselect_b32 s14, 0xcf7ce18f, 0
    v_mov_b32 v136, s14
    v_mov_b32 v137, s14
    v_mov_b32 v138, s14
    v_mov_b32 v139, s14
    s_lshl_b32 s14, s3, 11
    v_lshlrev_b32 v141, 9, v3
    v_lshl_add_u32 v141, v4, 1, v141
    v_add_u32 v141, s14, v141
    v_and_b32 v142, 1, v4
    v_mul_u32_u24 v142, 160, v142
    v_lshl_add_u32 v142, v3, 3, v142
    s_add_u32 s14, s14, 512
    v_add_u32 v142, s14, v142
    s_lshr_b32 s14, s3, 1
    s_lshl_b32 s14, s14, 10
    s_and_b32 s15, s3, 1
    s_lshl_b32 s15, s15, 3
    s_add_u32 s14, s14, s15
    s_add_u32 s14, s14, 8192
    v_add_u32 v143, s14, v2
    s_lshl_b32 s14, s3, 2
    s_add_u32 s14, s14, 10240
    v_add_u32 v144, s14, v2
    s_mul_i32 s14, s3, 3072
    s_add_u32 s14, s14, 8192
    v_add_u32 v145, s14, v2
    s_mul_i32 s60, s4, 82944
    s_add_u32 s60, s60, 0x240000
    s_mul_i32 s14, s3, 9216
    s_add_u32 s61, s60, s14
    s_add_u32 s61, s61, 46080
    s_mul_i32 s14, s3, 18432
    s_add_u32 s14, s14, 20480
    s_mul_i32 s13, s3, 12288
    s_add_u32 s60, s60, s13
    s_add_u32 s13, s13, 112640
    s_mov_b32 s76, 0x80000000
    s_mov_b32 s77, 0x80000000
    s_mov_b32 s78, 0x80000000
    s_mov_b32 s79, 0x80000000
    v_mov_b32 v236, 0
    s_mov_b32 s18, 262144
    s_waitcnt lgkmcnt(0)
H6_l:
    s_min_u32 s16, s16, s17
    s_cmp_ge_u32 s16, 8
    s_cbranch_scc1 H6_b
    s_sub_u32 s18, s18, 1
    s_cbranch_scc1 H6_b
    s_mov_b32 s16, 0
    s_atomic_add s16, s[20:21], s23 glc
    s_mov_b32 s17, 0
    s_atomic_add s17, s[20:21], s26 glc
    s_waitcnt lgkmcnt(0)
    s_branch H6_l
H6_b:
    s_branch K1_second
L_code_end:
    s_endpgm
.section .rodata,"a"
.p2align 6
.amdhsa_kernel p_kernel
  .amdhsa_next_free_vgpr 64
  .amdhsa_next_free_sgpr 64
  .amdhsa_accum_offset 64
  .amdhsa_group_segment_fixed_size 0
  .amdhsa_kernarg_size 88
  .amdhsa_user_sgpr_count 2
  .amdhsa_user_sgpr_kernarg_segment_ptr 1
  .amdhsa_system_sgpr_workgroup_id_x 1
.end_amdhsa_kernel
.p2align 6
.amdhsa_kernel main_kernel
  .amdhsa_next_free_vgpr 512
  .amdhsa_next_free_sgpr 102
  .amdhsa_accum_offset 256
  .amdhsa_group_segment_fixed_size 0
  .amdhsa_kernarg_size 88
  .amdhsa_user_sgpr_count 2
  .amdhsa_user_sgpr_kernarg_segment_ptr 1
  .amdhsa_system_sgpr_workgroup_id_x 1
.end_amdhsa_kernel
```
